```python
import torch

def _softmax(x, axis=-1):
    return torch.softmax(x, dim=axis)

def _gelu(x):
    return torch.nn.functional.gelu(x, approximate='tanh')

def _silu(x):
    return torch.nn.functional.silu(x)

def _sigmoid(x):
    return torch.sigmoid(x)

def _layernorm(x, axis=-1, eps=1e-05):
    m = x.mean(dim=axis, keepdim=True)
    v = x.var(dim=axis, keepdim=True, unbiased=False)
    return (x - m) / torch.sqrt(v + eps)

def _scatter_add(tgt, idx, src, axis=0):
    return tgt.clone().index_add_(axis, idx, src)

def _segment_sum(src, seg, n):
    out = torch.zeros((n,) + src.shape[1:], dtype=src.dtype)
    return out.index_add_(0, seg, src)

def _pad(x, pw):
    flat = tuple((v for pair in reversed(pw) for v in pair))
    return torch.nn.functional.pad(x, flat)
kernel_name = 'gated_mix__memory_aug_recurrent_mem_tr__swiglu_ffn__prompt'

def setup_inputs():

    _w = lambda a: (lambda t: t.to(torch.bfloat16) if t.is_floating_point() else t)(torch.as_tensor(a))

    def _A_setup():
        B, S, Dm = (1, 2048, 576)
        H, Dh = (32, 128)
        M, seg = (8, 32)
        seg = min(seg, S)
        S = S // seg * seg
        return {'x': _w((lambda *s: torch.randn(*s, dtype=torch.bfloat16) * 0.05)(B, S, Dm)), 'mem0': _w((lambda *s: torch.randn(*s, dtype=torch.bfloat16) * 0.4)(B, M, Dm)), 'Wq': _w((lambda *s: torch.randn(*s, dtype=torch.bfloat16) * 6.4)(Dm, H, Dh) * Dm ** (-0.5)), 'Wk': _w((lambda *s: torch.randn(*s, dtype=torch.bfloat16) * 6.4)(Dm, H, Dh) * Dm ** (-0.5)), 'Wv': _w((lambda *s: torch.randn(*s, dtype=torch.bfloat16) * 0.4)(Dm, H, Dh) * Dm ** (-0.5)), 'Wo': _w((lambda *s: torch.randn(*s, dtype=torch.bfloat16) * 0.4)(H, Dh, Dm) * (H * Dh) ** (-0.5)), 'seg_len': seg}
    _A_in = _A_setup()

    def _B_setup():
        B, S, D, F = (1, 2048, 576, 4608)
        return {'x': _w((lambda *s: torch.randn(*s, dtype=torch.bfloat16) * 0.05)(B, S, D)), 'w_gate': _w((lambda *s: torch.randn(*s, dtype=torch.bfloat16) * 0.05)(D, F)), 'w_up': _w((lambda *s: torch.randn(*s, dtype=torch.bfloat16) * 0.05)(D, F)), 'w_down': _w((lambda *s: torch.randn(*s, dtype=torch.bfloat16) * 0.05)(F, D))}
    _B_in = _B_setup()
    return {'A_x': _A_in['x'], 'A_mem0': _A_in['mem0'], 'A_Wq': _A_in['Wq'], 'A_Wk': _A_in['Wk'], 'A_Wv': _A_in['Wv'], 'A_Wo': _A_in['Wo'], 'A_seg_len': _A_in['seg_len'], 'B_x': _B_in['x'], 'B_w_gate': _B_in['w_gate'], 'B_w_up': _B_in['w_up'], 'B_w_down': _B_in['w_down'], 'gate_w': _w((lambda *s: torch.randn(*s, dtype=torch.bfloat16) * 0.05)(576) * 16.0)}

def reference(A_x, A_mem0, A_Wq, A_Wk, A_Wv, A_Wo, A_seg_len, B_x, B_w_gate, B_w_up, B_w_down, gate_w):

    def _A_ref(x, mem0, Wq, Wk, Wv, Wo, seg_len):
        B, S, Dm = x.shape
        H, Dh = (Wq.shape[1], Wq.shape[2])
        M = mem0.shape[1]
        scale = Dh ** (-0.5)
        n_seg = S // seg_len
        L = M + seg_len
        idx = torch.arange(L)
        mask = (idx[:, None] < M) | (idx[:, None] >= idx[None, :])
        mem = mem0
        outs = []
        for s in range(n_seg):
            xs = x[:, s * seg_len:(s + 1) * seg_len, :].clone()
            h = torch.concatenate([mem, xs], axis=1)
            q = torch.einsum('btd,dhe->bhte', h, Wq)
            k = torch.einsum('btd,dhe->bhte', h, Wk)
            v = torch.einsum('btd,dhe->bhte', h, Wv)
            scores = torch.einsum('bhqe,bhke->bhqk', q, k) * scale
            scores = torch.where(mask[None, None], scores, -1000000000.0)
            p = _softmax(scores, axis=-1)
            o = torch.einsum('bhqk,bhke->bhqe', p, v)
            o = torch.einsum('bhte,hed->btd', o, Wo)
            mem = o[:, :M, :].clone()
            outs.append(o[:, M:, :])
        return torch.concatenate(outs, axis=1)

    def _B_ref(x, w_gate, w_up, w_down):
        g = _silu(x @ w_gate)
        u = x @ w_up
        return g * u @ w_down
    x = A_x
    g = _sigmoid((x * gate_w).sum(-1, keepdims=True))
    a = _A_ref(x, A_mem0, A_Wq, A_Wk, A_Wv, A_Wo, A_seg_len)
    b = _B_ref(x, B_w_gate, B_w_up, B_w_down)
    return g * a + (1 - g) * b
```

```asm
; @launch grid=(256,1,1) block=(256,1,1) lds=163840
.amdgcn_target "amdgcn-amd-amdhsa--gfx950"
.text
.globl gated_mix__memory_aug_recurrent_mem_tr__swiglu_ffn__prompt_kernel
.p2align 8
.type gated_mix__memory_aug_recurrent_mem_tr__swiglu_ffn__prompt_kernel,@function
gated_mix__memory_aug_recurrent_mem_tr__swiglu_ffn__prompt_kernel:
    s_cmp_ge_u32 s2, 256
    s_cbranch_scc1 L_end
    s_load_dwordx2 s[4:5], s[0:1], 112
    s_load_dwordx2 s[6:7], s[0:1], 104
    v_lshrrev_b32 v1, 6, v0
    s_nop 0
    v_readfirstlane_b32 s8, v1
    s_mov_b32 s36, 400000
    s_waitcnt lgkmcnt(0)
    s_getreg_b32 s3, hwreg(HW_REG_XCC_ID, 0, 4)
    s_cmp_lg_u32 s8, 0
    s_cbranch_scc1 L_form_done_1
    s_lshl_b32 s38, s3, 2
    v_mov_b32 v2, s38
    v_mov_b32 v3, 1
    s_mov_b64 exec, 1
    global_atomic_add v4, v2, v3, s[6:7] sc0
    s_waitcnt vmcnt(0)
    v_readfirstlane_b32 s39, v4
    s_lshl_b32 s40, s3, 5
    s_add_u32 s40, s40, s39
    s_cmp_ge_u32 s39, 32
    s_cselect_b32 s40, 999, s40
    v_mov_b32 v2, 160256
    v_mov_b32 v3, s40
    ds_write_b32 v2, v3
    s_mov_b64 exec, -1
    s_waitcnt lgkmcnt(0)
L_form_done_1:
    s_barrier
    v_mov_b32 v2, 160256
    ds_read_b32 v3, v2
    s_waitcnt lgkmcnt(0)
    v_readfirstlane_b32 s9, v3
    s_barrier
    s_cmp_lt_u32 s9, 32
    s_cbranch_scc1 L_team
    s_cmp_ge_u32 s9, 256
    s_cbranch_scc1 L_bail
    s_sub_u32 s9, s9, 32
    s_mov_b32 s43, 400000
    s_load_dwordx2 s[26:27], s[0:1], 16
    s_load_dwordx2 s[28:29], s[0:1], 24
    s_load_dwordx2 s[30:31], s[0:1], 32
    s_load_dwordx2 s[32:33], s[0:1], 64
    s_load_dwordx2 s[34:35], s[0:1], 72
    s_load_dwordx2 s[36:37], s[0:1], 88
    s_load_dwordx2 s[14:15], s[0:1], 0
    s_lshr_b32 s11, s9, 5
    s_lshl_b32 s11, s11, 2
    s_and_b32 s22, s9, 3
    s_add_u32 s11, s11, s22
    s_bfe_u32 s10, s9, 0x30002
    s_cmp_ge_u32 s11, 9
    s_cselect_b32 s38, 1, 0
    s_mov_b32 s62, 0
    s_mov_b32 s63, s11
    s_mov_b32 s67, 0
    s_cmp_eq_u32 s10, 0
    s_cselect_b32 s62, 1, 0
    s_cmp_lt_u32 s10, 2
    s_cbranch_scc1 L_nh_5
    s_cmp_lt_u32 s10, 4
    s_cbranch_scc1 L_nh2_6
    s_sub_u32 s22, s10, 3
    s_mul_i32 s22, s22, 28
    s_add_u32 s63, s22, s11
    s_cmp_lt_u32 s63, 128
    s_cselect_b32 s62, 1, 0
    s_branch L_nh_5
L_nh2_6:
    s_sub_u32 s22, s10, 2
    s_mul_i32 s22, s22, 28
    s_add_u32 s63, s22, s11
    s_mov_b32 s62, 1
    s_mov_b32 s67, 1
L_nh_5:
    s_cmp_lt_u32 s11, 16
    s_cselect_b32 s65, 5, 4
    s_mov_b32 s66, 0
    s_cmp_eq_u32 s10, 1
    s_cselect_b32 s66, 56, 0
    s_cselect_b32 s22, 2, 0
    s_sub_u32 s65, s65, s22
    s_cmp_eq_u32 s10, 0
    s_cselect_b32 s65, 0, s65
    s_add_u32 s65, s65, s62
    s_cmp_lt_u32 s11, 1
    s_cselect_b32 s49, 8, 7
    s_cmp_ge_u32 s11, 9
    s_cselect_b32 s22, 1, 0
    s_cmp_lt_u32 s11, 20
    s_cselect_b32 s22, s22, 0
    s_add_u32 s49, s49, s22
    s_add_u32 s49, s49, s65
    s_cmp_eq_u32 s62, 1
    s_cselect_b32 s64, s67, s10
    s_mov_b32 s42, 0xbfb8aa3b
    s_waitcnt lgkmcnt(0)
    v_and_b32 v6, 63, v0
    s_load_dwordx2 s[44:45], s[0:1], 40
    s_mul_i32 s22, s9, 256
    v_add_u32 v7, s22, v0
    v_lshlrev_b32 v7, 7, v7
    v_min_u32 v7, 4718588, v7
    global_load_dword v122, v7, s[26:27]
    s_waitcnt lgkmcnt(0)
    global_load_dword v123, v7, s[44:45]
    s_mov_b32 s12, 0
    s_mov_b32 s41, 0
    s_cmp_lt_u32 s12, s62
    s_cbranch_scc1 L_d0_7
    s_cmp_ge_u32 s12, s65
    s_cbranch_scc1 L_dB_8
    s_sub_u32 s22, s12, s62
    s_mul_i32 s22, s22, 28
    s_add_u32 s22, s22, s11
    s_add_u32 s22, s22, s66
    s_branch L_dq_11
L_d0_7:
    s_mov_b32 s22, s63
L_dq_11:
    s_lshr_b32 s13, s22, 6
    s_and_b32 s60, s22, 63
    s_branch L_dD_10
L_dB_8:
    s_sub_u32 s22, s12, s65
    s_cmp_eq_u32 s38, 1
    s_cbranch_scc1 L_dF_9
    s_mul_i32 s22, s22, 9
    s_add_u32 s60, s22, s11
    s_mov_b32 s13, 2
    s_branch L_dD_10
L_dF_9:
    s_mul_i32 s22, s22, 19
    s_add_u32 s60, s22, s11
    s_sub_u32 s60, s60, 9
    s_mov_b32 s13, 3
L_dD_10:
    s_cmp_eq_u32 s13, 3
    s_cbranch_scc1 L_p1f_12
    s_cmp_eq_u32 s13, 0
    s_cselect_b32 s16, s28, s30
    s_cselect_b32 s17, s29, s31
    s_cmp_eq_u32 s13, 2
    s_cselect_b32 s16, s26, s16
    s_cselect_b32 s17, s27, s17
    s_lshl_b32 s23, s60, 7
    s_lshr_b32 s24, s8, 1
    s_lshl_b32 s24, s24, 6
    s_add_u32 s23, s23, s24
    s_mov_b32 s18, 8192
    s_branch L_p1d_13
L_p1f_12:
    s_cmp_lt_u32 s8, 2
    s_cselect_b32 s16, s32, s34
    s_cselect_b32 s17, s33, s35
    s_lshl_b32 s23, s60, 6
    s_mov_b32 s18, 9216
L_p1d_13:
    s_add_u32 s16, s16, s23
    s_addc_u32 s17, s17, 0
    s_lshl_b32 s39, s18, 4
    v_lshrrev_b32 v3, 2, v6
    v_mul_lo_u32 v3, v3, s18
    v_and_b32 v7, 3, v6
    v_lshl_add_u32 v3, v7, 4, v3
    s_and_b32 s22, s8, 1
    s_mul_i32 s22, s22, 18
    s_mul_i32 s22, s22, s39
    v_add_u32 v3, s22, v3
    s_lshr_b32 s22, s8, 1
    s_mul_i32 s22, s22, 36864
    s_and_b32 s23, s8, 1
    s_mul_i32 s23, s23, 18432
    s_add_u32 s40, s22, s23
    s_add_u32 s40, s40, s41
    s_mov_b32 m0, s40
    s_add_u32 s40, s40, 1024
    global_load_lds_dwordx4 v3, s[16:17]
    v_add_u32 v3, s39, v3
    s_mov_b32 m0, s40
    s_add_u32 s40, s40, 1024
    global_load_lds_dwordx4 v3, s[16:17]
    v_add_u32 v3, s39, v3
    s_mov_b32 m0, s40
    s_add_u32 s40, s40, 1024
    global_load_lds_dwordx4 v3, s[16:17]
    v_add_u32 v3, s39, v3
    s_mov_b32 m0, s40
    s_add_u32 s40, s40, 1024
    global_load_lds_dwordx4 v3, s[16:17]
    v_add_u32 v3, s39, v3
    s_mov_b32 m0, s40
    s_add_u32 s40, s40, 1024
    global_load_lds_dwordx4 v3, s[16:17]
    v_add_u32 v3, s39, v3
    s_mov_b32 m0, s40
    s_add_u32 s40, s40, 1024
    global_load_lds_dwordx4 v3, s[16:17]
    v_add_u32 v3, s39, v3
    s_mov_b32 m0, s40
    s_add_u32 s40, s40, 1024
    global_load_lds_dwordx4 v3, s[16:17]
    v_add_u32 v3, s39, v3
    s_mov_b32 m0, s40
    s_add_u32 s40, s40, 1024
    global_load_lds_dwordx4 v3, s[16:17]
    v_add_u32 v3, s39, v3
    s_mov_b32 m0, s40
    s_add_u32 s40, s40, 1024
    global_load_lds_dwordx4 v3, s[16:17]
    v_add_u32 v3, s39, v3
    s_mov_b32 m0, s40
    s_add_u32 s40, s40, 1024
    global_load_lds_dwordx4 v3, s[16:17]
    v_add_u32 v3, s39, v3
    s_mov_b32 m0, s40
    s_add_u32 s40, s40, 1024
    global_load_lds_dwordx4 v3, s[16:17]
    v_add_u32 v3, s39, v3
    s_mov_b32 m0, s40
    s_add_u32 s40, s40, 1024
    global_load_lds_dwordx4 v3, s[16:17]
    v_add_u32 v3, s39, v3
    s_mov_b32 m0, s40
    s_add_u32 s40, s40, 1024
    global_load_lds_dwordx4 v3, s[16:17]
    v_add_u32 v3, s39, v3
    s_mov_b32 m0, s40
    s_add_u32 s40, s40, 1024
    global_load_lds_dwordx4 v3, s[16:17]
    v_add_u32 v3, s39, v3
    s_mov_b32 m0, s40
    s_add_u32 s40, s40, 1024
    global_load_lds_dwordx4 v3, s[16:17]
    v_add_u32 v3, s39, v3
    s_mov_b32 m0, s40
    s_add_u32 s40, s40, 1024
    global_load_lds_dwordx4 v3, s[16:17]
    v_add_u32 v3, s39, v3
    s_mov_b32 m0, s40
    s_add_u32 s40, s40, 1024
    global_load_lds_dwordx4 v3, s[16:17]
    v_add_u32 v3, s39, v3
    s_mov_b32 m0, s40
    s_add_u32 s40, s40, 1024
    global_load_lds_dwordx4 v3, s[16:17]
    v_add_u32 v3, s39, v3
    s_mov_b32 s61, 73728
    v_lshrrev_b32 v7, 3, v6
    s_lshl_b32 s22, s64, 8
    s_lshl_b32 s23, s8, 6
    s_add_u32 s22, s22, s23
    v_add_u32 v88, s22, v7
    v_mul_u32_u24 v88, 1152, v88
    v_and_b32 v89, 7, v6
    v_lshl_add_u32 v88, v89, 4, v88
    v_xor_b32 v89, v89, v7
    v_lshlrev_b32 v89, 4, v89
    v_lshl_add_u32 v89, v7, 7, v89
    s_lshl_b32 s22, s8, 14
    s_add_u32 s22, s22, s61
    v_add_u32 v89, s22, v89
    v_and_b32 v94, 31, v6
    v_lshrrev_b32 v95, 5, v6
    v_and_b32 v96, 7, v94
    v_add_u32 v90, 0, v95
    v_xor_b32 v90, v90, v96
    v_lshlrev_b32 v90, 4, v90
    v_lshl_add_u32 v90, v94, 7, v90
    v_add_u32 v90, s22, v90
    v_add_u32 v91, 2, v95
    v_xor_b32 v91, v91, v96
    v_lshlrev_b32 v91, 4, v91
    v_lshl_add_u32 v91, v94, 7, v91
    v_add_u32 v91, s22, v91
    v_add_u32 v92, 4, v95
    v_xor_b32 v92, v92, v96
    v_lshlrev_b32 v92, 4, v92
    v_lshl_add_u32 v92, v94, 7, v92
    v_add_u32 v92, s22, v92
    v_add_u32 v93, 6, v95
    v_xor_b32 v93, v93, v96
    v_lshlrev_b32 v93, 4, v93
    v_lshl_add_u32 v93, v94, 7, v93
    v_add_u32 v93, s22, v93
    v_add_u32 v97, 0, v88
    global_load_dwordx4 a[0:3], v97, s[14:15] offset:0
    v_add_u32 v97, 9216, v88
    global_load_dwordx4 a[4:7], v97, s[14:15] offset:0
    v_add_u32 v97, 18432, v88
    global_load_dwordx4 a[8:11], v97, s[14:15] offset:0
    v_add_u32 v97, 27648, v88
    global_load_dwordx4 a[12:15], v97, s[14:15] offset:0
    v_add_u32 v97, 0, v88
    global_load_dwordx4 a[16:19], v97, s[14:15] offset:128
    v_add_u32 v97, 9216, v88
    global_load_dwordx4 a[20:23], v97, s[14:15] offset:128
    v_add_u32 v97, 18432, v88
    global_load_dwordx4 a[24:27], v97, s[14:15] offset:128
    v_add_u32 v97, 27648, v88
    global_load_dwordx4 a[28:31], v97, s[14:15] offset:128
    v_add_u32 v97, 0, v88
    global_load_dwordx4 a[32:35], v97, s[14:15] offset:256
    v_add_u32 v97, 9216, v88
    global_load_dwordx4 a[36:39], v97, s[14:15] offset:256
    v_add_u32 v97, 18432, v88
    global_load_dwordx4 a[40:43], v97, s[14:15] offset:256
    v_add_u32 v97, 27648, v88
    global_load_dwordx4 a[44:47], v97, s[14:15] offset:256
    v_add_u32 v97, 0, v88
    global_load_dwordx4 a[48:51], v97, s[14:15] offset:384
    v_add_u32 v97, 9216, v88
    global_load_dwordx4 a[52:55], v97, s[14:15] offset:384
    v_add_u32 v97, 18432, v88
    global_load_dwordx4 a[56:59], v97, s[14:15] offset:384
    v_add_u32 v97, 27648, v88
    global_load_dwordx4 a[60:63], v97, s[14:15] offset:384
    v_add_u32 v97, 0, v88
    global_load_dwordx4 a[64:67], v97, s[14:15] offset:512
    v_add_u32 v97, 9216, v88
    global_load_dwordx4 a[68:71], v97, s[14:15] offset:512
    v_add_u32 v97, 18432, v88
    global_load_dwordx4 a[72:75], v97, s[14:15] offset:512
    v_add_u32 v97, 27648, v88
    global_load_dwordx4 a[76:79], v97, s[14:15] offset:512
    v_add_u32 v97, 0, v88
    global_load_dwordx4 a[80:83], v97, s[14:15] offset:640
    v_add_u32 v97, 9216, v88
    global_load_dwordx4 a[84:87], v97, s[14:15] offset:640
    v_add_u32 v97, 18432, v88
    global_load_dwordx4 a[88:91], v97, s[14:15] offset:640
    v_add_u32 v97, 27648, v88
    global_load_dwordx4 a[92:95], v97, s[14:15] offset:640
    v_add_u32 v97, 0, v88
    global_load_dwordx4 a[96:99], v97, s[14:15] offset:768
    v_add_u32 v97, 9216, v88
    global_load_dwordx4 a[100:103], v97, s[14:15] offset:768
    v_add_u32 v97, 18432, v88
    global_load_dwordx4 a[104:107], v97, s[14:15] offset:768
    v_add_u32 v97, 27648, v88
    global_load_dwordx4 a[108:111], v97, s[14:15] offset:768
    v_add_u32 v97, 0, v88
    global_load_dwordx4 a[112:115], v97, s[14:15] offset:896
    v_add_u32 v97, 9216, v88
    global_load_dwordx4 a[116:119], v97, s[14:15] offset:896
    v_add_u32 v97, 18432, v88
    global_load_dwordx4 a[120:123], v97, s[14:15] offset:896
    v_add_u32 v97, 27648, v88
    global_load_dwordx4 a[124:127], v97, s[14:15] offset:896
    v_add_u32 v97, 0, v88
    global_load_dwordx4 a[128:131], v97, s[14:15] offset:1024
    v_add_u32 v97, 9216, v88
    global_load_dwordx4 a[132:135], v97, s[14:15] offset:1024
    v_add_u32 v97, 18432, v88
    global_load_dwordx4 a[136:139], v97, s[14:15] offset:1024
    v_add_u32 v97, 27648, v88
    global_load_dwordx4 a[140:143], v97, s[14:15] offset:1024
    v_add_u32 v97, 36864, v88
    global_load_dwordx4 a[144:147], v97, s[14:15] offset:0
    v_add_u32 v97, 46080, v88
    global_load_dwordx4 a[148:151], v97, s[14:15] offset:0
    v_add_u32 v97, 55296, v88
    global_load_dwordx4 a[152:155], v97, s[14:15] offset:0
    v_add_u32 v97, 64512, v88
    global_load_dwordx4 a[156:159], v97, s[14:15] offset:0
    s_waitcnt vmcnt(36)
    ds_write_b128 v89, a[0:3] offset:0
    ds_write_b128 v89, a[4:7] offset:1024
    ds_write_b128 v89, a[8:11] offset:2048
    ds_write_b128 v89, a[12:15] offset:3072
    s_waitcnt lgkmcnt(0)
    ds_read_b128 a[0:3], v90 offset:0
    ds_read_b128 a[4:7], v91 offset:0
    ds_read_b128 a[8:11], v92 offset:0
    ds_read_b128 a[12:15], v93 offset:0
    v_add_u32 v97, 36864, v88
    global_load_dwordx4 a[160:163], v97, s[14:15] offset:128
    v_add_u32 v97, 46080, v88
    global_load_dwordx4 a[164:167], v97, s[14:15] offset:128
    v_add_u32 v97, 55296, v88
    global_load_dwordx4 a[168:171], v97, s[14:15] offset:128
    v_add_u32 v97, 64512, v88
    global_load_dwordx4 a[172:175], v97, s[14:15] offset:128
    s_waitcnt vmcnt(36)
    ds_write_b128 v89, a[16:19] offset:4096
    ds_write_b128 v89, a[20:23] offset:5120
    ds_write_b128 v89, a[24:27] offset:6144
    ds_write_b128 v89, a[28:31] offset:7168
    s_waitcnt lgkmcnt(0)
    ds_read_b128 a[16:19], v90 offset:4096
    ds_read_b128 a[20:23], v91 offset:4096
    ds_read_b128 a[24:27], v92 offset:4096
    ds_read_b128 a[28:31], v93 offset:4096
    v_add_u32 v97, 36864, v88
    global_load_dwordx4 a[176:179], v97, s[14:15] offset:256
    v_add_u32 v97, 46080, v88
    global_load_dwordx4 a[180:183], v97, s[14:15] offset:256
    v_add_u32 v97, 55296, v88
    global_load_dwordx4 a[184:187], v97, s[14:15] offset:256
    v_add_u32 v97, 64512, v88
    global_load_dwordx4 a[188:191], v97, s[14:15] offset:256
    s_waitcnt vmcnt(36)
    ds_write_b128 v89, a[32:35] offset:8192
    ds_write_b128 v89, a[36:39] offset:9216
    ds_write_b128 v89, a[40:43] offset:10240
    ds_write_b128 v89, a[44:47] offset:11264
    s_waitcnt lgkmcnt(0)
    ds_read_b128 a[32:35], v90 offset:8192
    ds_read_b128 a[36:39], v91 offset:8192
    ds_read_b128 a[40:43], v92 offset:8192
    ds_read_b128 a[44:47], v93 offset:8192
    v_add_u32 v97, 36864, v88
    global_load_dwordx4 a[192:195], v97, s[14:15] offset:384
    v_add_u32 v97, 46080, v88
    global_load_dwordx4 a[196:199], v97, s[14:15] offset:384
    v_add_u32 v97, 55296, v88
    global_load_dwordx4 a[200:203], v97, s[14:15] offset:384
    v_add_u32 v97, 64512, v88
    global_load_dwordx4 a[204:207], v97, s[14:15] offset:384
    s_waitcnt vmcnt(36)
    ds_write_b128 v89, a[48:51] offset:12288
    ds_write_b128 v89, a[52:55] offset:13312
    ds_write_b128 v89, a[56:59] offset:14336
    ds_write_b128 v89, a[60:63] offset:15360
    s_waitcnt lgkmcnt(0)
    ds_read_b128 a[48:51], v90 offset:12288
    ds_read_b128 a[52:55], v91 offset:12288
    ds_read_b128 a[56:59], v92 offset:12288
    ds_read_b128 a[60:63], v93 offset:12288
    v_add_u32 v97, 36864, v88
    global_load_dwordx4 a[208:211], v97, s[14:15] offset:512
    v_add_u32 v97, 46080, v88
    global_load_dwordx4 a[212:215], v97, s[14:15] offset:512
    v_add_u32 v97, 55296, v88
    global_load_dwordx4 a[216:219], v97, s[14:15] offset:512
    v_add_u32 v97, 64512, v88
    global_load_dwordx4 a[220:223], v97, s[14:15] offset:512
    s_waitcnt vmcnt(36)
    ds_write_b128 v89, a[64:67] offset:0
    ds_write_b128 v89, a[68:71] offset:1024
    ds_write_b128 v89, a[72:75] offset:2048
    ds_write_b128 v89, a[76:79] offset:3072
    s_waitcnt lgkmcnt(0)
    ds_read_b128 a[64:67], v90 offset:0
    ds_read_b128 a[68:71], v91 offset:0
    ds_read_b128 a[72:75], v92 offset:0
    ds_read_b128 a[76:79], v93 offset:0
    v_add_u32 v97, 36864, v88
    global_load_dwordx4 a[224:227], v97, s[14:15] offset:640
    v_add_u32 v97, 46080, v88
    global_load_dwordx4 a[228:231], v97, s[14:15] offset:640
    v_add_u32 v97, 55296, v88
    global_load_dwordx4 a[232:235], v97, s[14:15] offset:640
    v_add_u32 v97, 64512, v88
    global_load_dwordx4 a[236:239], v97, s[14:15] offset:640
    s_waitcnt vmcnt(36)
    ds_write_b128 v89, a[80:83] offset:4096
    ds_write_b128 v89, a[84:87] offset:5120
    ds_write_b128 v89, a[88:91] offset:6144
    ds_write_b128 v89, a[92:95] offset:7168
    s_waitcnt lgkmcnt(0)
    ds_read_b128 a[80:83], v90 offset:4096
    ds_read_b128 a[84:87], v91 offset:4096
    ds_read_b128 a[88:91], v92 offset:4096
    ds_read_b128 a[92:95], v93 offset:4096
    v_add_u32 v97, 36864, v88
    global_load_dwordx4 a[240:243], v97, s[14:15] offset:768
    v_add_u32 v97, 46080, v88
    global_load_dwordx4 a[244:247], v97, s[14:15] offset:768
    v_add_u32 v97, 55296, v88
    global_load_dwordx4 a[248:251], v97, s[14:15] offset:768
    v_add_u32 v97, 64512, v88
    global_load_dwordx4 a[252:255], v97, s[14:15] offset:768
    s_waitcnt vmcnt(36)
    ds_write_b128 v89, a[96:99] offset:8192
    ds_write_b128 v89, a[100:103] offset:9216
    ds_write_b128 v89, a[104:107] offset:10240
    ds_write_b128 v89, a[108:111] offset:11264
    s_waitcnt lgkmcnt(0)
    ds_read_b128 a[96:99], v90 offset:8192
    ds_read_b128 a[100:103], v91 offset:8192
    ds_read_b128 a[104:107], v92 offset:8192
    ds_read_b128 a[108:111], v93 offset:8192
    v_add_u32 v97, 36864, v88
    global_load_dwordx4 v[224:227], v97, s[14:15] offset:896
    v_add_u32 v97, 46080, v88
    global_load_dwordx4 v[228:231], v97, s[14:15] offset:896
    v_add_u32 v97, 55296, v88
    global_load_dwordx4 v[232:235], v97, s[14:15] offset:896
    v_add_u32 v97, 64512, v88
    global_load_dwordx4 v[236:239], v97, s[14:15] offset:896
    s_waitcnt vmcnt(36)
    ds_write_b128 v89, a[112:115] offset:12288
    ds_write_b128 v89, a[116:119] offset:13312
    ds_write_b128 v89, a[120:123] offset:14336
    ds_write_b128 v89, a[124:127] offset:15360
    s_waitcnt lgkmcnt(0)
    ds_read_b128 a[112:115], v90 offset:12288
    ds_read_b128 a[116:119], v91 offset:12288
    ds_read_b128 a[120:123], v92 offset:12288
    ds_read_b128 a[124:127], v93 offset:12288
    v_add_u32 v97, 36864, v88
    global_load_dwordx4 v[240:243], v97, s[14:15] offset:1024
    v_add_u32 v97, 46080, v88
    global_load_dwordx4 v[244:247], v97, s[14:15] offset:1024
    v_add_u32 v97, 55296, v88
    global_load_dwordx4 v[248:251], v97, s[14:15] offset:1024
    v_add_u32 v97, 64512, v88
    global_load_dwordx4 v[252:255], v97, s[14:15] offset:1024
    s_waitcnt vmcnt(36)
    ds_write_b128 v89, a[128:131] offset:0
    ds_write_b128 v89, a[132:135] offset:1024
    ds_write_b128 v89, a[136:139] offset:2048
    ds_write_b128 v89, a[140:143] offset:3072
    s_waitcnt lgkmcnt(0)
    ds_read_b128 a[128:131], v90 offset:0
    ds_read_b128 a[132:135], v91 offset:0
    ds_read_b128 a[136:139], v92 offset:0
    ds_read_b128 a[140:143], v93 offset:0
    s_waitcnt vmcnt(32)
    ds_write_b128 v89, a[144:147] offset:4096
    ds_write_b128 v89, a[148:151] offset:5120
    ds_write_b128 v89, a[152:155] offset:6144
    ds_write_b128 v89, a[156:159] offset:7168
    s_waitcnt lgkmcnt(0)
    ds_read_b128 a[144:147], v90 offset:4096
    ds_read_b128 a[148:151], v91 offset:4096
    ds_read_b128 a[152:155], v92 offset:4096
    ds_read_b128 a[156:159], v93 offset:4096
    s_waitcnt vmcnt(28)
    ds_write_b128 v89, a[160:163] offset:8192
    ds_write_b128 v89, a[164:167] offset:9216
    ds_write_b128 v89, a[168:171] offset:10240
    ds_write_b128 v89, a[172:175] offset:11264
    s_waitcnt lgkmcnt(0)
    ds_read_b128 a[160:163], v90 offset:8192
    ds_read_b128 a[164:167], v91 offset:8192
    ds_read_b128 a[168:171], v92 offset:8192
    ds_read_b128 a[172:175], v93 offset:8192
    s_waitcnt vmcnt(24)
    ds_write_b128 v89, a[176:179] offset:12288
    ds_write_b128 v89, a[180:183] offset:13312
    ds_write_b128 v89, a[184:187] offset:14336
    ds_write_b128 v89, a[188:191] offset:15360
    s_waitcnt lgkmcnt(0)
    ds_read_b128 a[176:179], v90 offset:12288
    ds_read_b128 a[180:183], v91 offset:12288
    ds_read_b128 a[184:187], v92 offset:12288
    ds_read_b128 a[188:191], v93 offset:12288
    s_waitcnt vmcnt(20)
    ds_write_b128 v89, a[192:195] offset:0
    ds_write_b128 v89, a[196:199] offset:1024
    ds_write_b128 v89, a[200:203] offset:2048
    ds_write_b128 v89, a[204:207] offset:3072
    s_waitcnt lgkmcnt(0)
    ds_read_b128 a[192:195], v90 offset:0
    ds_read_b128 a[196:199], v91 offset:0
    ds_read_b128 a[200:203], v92 offset:0
    ds_read_b128 a[204:207], v93 offset:0
    s_waitcnt vmcnt(16)
    ds_write_b128 v89, a[208:211] offset:4096
    ds_write_b128 v89, a[212:215] offset:5120
    ds_write_b128 v89, a[216:219] offset:6144
    ds_write_b128 v89, a[220:223] offset:7168
    s_waitcnt lgkmcnt(0)
    ds_read_b128 a[208:211], v90 offset:4096
    ds_read_b128 a[212:215], v91 offset:4096
    ds_read_b128 a[216:219], v92 offset:4096
    ds_read_b128 a[220:223], v93 offset:4096
    s_waitcnt vmcnt(12)
    ds_write_b128 v89, a[224:227] offset:8192
    ds_write_b128 v89, a[228:231] offset:9216
    ds_write_b128 v89, a[232:235] offset:10240
    ds_write_b128 v89, a[236:239] offset:11264
    s_waitcnt lgkmcnt(0)
    ds_read_b128 a[224:227], v90 offset:8192
    ds_read_b128 a[228:231], v91 offset:8192
    ds_read_b128 a[232:235], v92 offset:8192
    ds_read_b128 a[236:239], v93 offset:8192
    s_waitcnt vmcnt(8)
    ds_write_b128 v89, a[240:243] offset:12288
    ds_write_b128 v89, a[244:247] offset:13312
    ds_write_b128 v89, a[248:251] offset:14336
    ds_write_b128 v89, a[252:255] offset:15360
    s_waitcnt lgkmcnt(0)
    ds_read_b128 a[240:243], v90 offset:12288
    ds_read_b128 a[244:247], v91 offset:12288
    ds_read_b128 a[248:251], v92 offset:12288
    ds_read_b128 a[252:255], v93 offset:12288
    s_waitcnt vmcnt(4)
    ds_write_b128 v89, v[224:227] offset:0
    ds_write_b128 v89, v[228:231] offset:1024
    ds_write_b128 v89, v[232:235] offset:2048
    ds_write_b128 v89, v[236:239] offset:3072
    s_waitcnt lgkmcnt(0)
    ds_read_b128 v[224:227], v90 offset:0
    ds_read_b128 v[228:231], v91 offset:0
    ds_read_b128 v[232:235], v92 offset:0
    ds_read_b128 v[236:239], v93 offset:0
    s_waitcnt vmcnt(0)
    ds_write_b128 v89, v[240:243] offset:4096
    ds_write_b128 v89, v[244:247] offset:5120
    ds_write_b128 v89, v[248:251] offset:6144
    ds_write_b128 v89, v[252:255] offset:7168
    s_waitcnt lgkmcnt(0)
    ds_read_b128 v[240:243], v90 offset:4096
    ds_read_b128 v[244:247], v91 offset:4096
    ds_read_b128 v[248:251], v92 offset:4096
    ds_read_b128 v[252:255], v93 offset:4096
    s_waitcnt lgkmcnt(0)
    v_lshrrev_b32 v1, 5, v6
    v_lshlrev_b32 v1, 3, v1
    v_bfe_u32 v7, v6, 2, 2
    v_add_u32 v1, v1, v7
    v_lshlrev_b32 v1, 6, v1
    v_bfe_u32 v7, v6, 4, 1
    v_lshl_add_u32 v1, v7, 5, v1
    v_and_b32 v7, 3, v6
    v_lshl_add_u32 v1, v7, 3, v1
    v_add_u32 v2, 36864, v1
    s_waitcnt vmcnt(0)
    v_lshlrev_b32 v7, 4, v0
    v_mov_b32 v88, -1
    v_mov_b32 v89, -1
    v_mov_b32 v90, -1
    v_mov_b32 v91, -1
    s_lshl_b32 s22, s9, 12
    s_add_u32 s22, s22, 33554432
    s_add_u32 s44, s4, s22
    s_addc_u32 s45, s5, 0
    global_store_dwordx4 v7, v[88:91], s[44:45] sc1
    s_add_u32 s44, s44, 917504
    s_addc_u32 s45, s45, 0
    global_store_dwordx4 v7, v[88:91], s[44:45] sc1
    s_add_u32 s44, s44, 917504
    s_addc_u32 s45, s45, 0
    global_store_dwordx4 v7, v[88:91], s[44:45] sc1
    s_add_u32 s44, s44, 917504
    s_addc_u32 s45, s45, 0
    global_store_dwordx4 v7, v[88:91], s[44:45] sc1
    s_add_u32 s44, s44, 917504
    s_addc_u32 s45, s45, 0
    global_store_dwordx4 v7, v[88:91], s[44:45] sc1
    s_add_u32 s44, s44, 917504
    s_addc_u32 s45, s45, 0
    global_store_dwordx4 v7, v[88:91], s[44:45] sc1
    s_add_u32 s44, s44, 917504
    s_addc_u32 s45, s45, 0
    global_store_dwordx4 v7, v[88:91], s[44:45] sc1
    s_add_u32 s44, s44, 917504
    s_addc_u32 s45, s45, 0
    global_store_dwordx4 v7, v[88:91], s[44:45] sc1
    s_add_u32 s44, s44, 917504
    s_addc_u32 s45, s45, 0
    global_store_dwordx4 v7, v[88:91], s[44:45] sc1
    s_add_u32 s44, s44, 917504
    s_addc_u32 s45, s45, 0
    s_cmp_ge_u32 s9, 32
    s_cbranch_scc1 L_fill_14
    global_store_dwordx4 v7, v[88:91], s[44:45] sc1
L_fill_14:
L_p1loop_15:
    s_barrier
    s_cmp_eq_u32 s64, s10
    s_cbranch_scc1 L_nosw_20
    s_cmp_eq_u32 s12, 0
    s_cbranch_scc1 L_nosw_20
    s_mov_b32 s64, s10
    s_sub_u32 s61, 73728, s41
    v_lshrrev_b32 v7, 3, v6
    s_lshl_b32 s22, s64, 8
    s_lshl_b32 s23, s8, 6
    s_add_u32 s22, s22, s23
    v_add_u32 v88, s22, v7
    v_mul_u32_u24 v88, 1152, v88
    v_and_b32 v89, 7, v6
    v_lshl_add_u32 v88, v89, 4, v88
    v_xor_b32 v89, v89, v7
    v_lshlrev_b32 v89, 4, v89
    v_lshl_add_u32 v89, v7, 7, v89
    s_lshl_b32 s22, s8, 14
    s_add_u32 s22, s22, s61
    v_add_u32 v89, s22, v89
    v_and_b32 v94, 31, v6
    v_lshrrev_b32 v95, 5, v6
    v_and_b32 v96, 7, v94
    v_add_u32 v90, 0, v95
    v_xor_b32 v90, v90, v96
    v_lshlrev_b32 v90, 4, v90
    v_lshl_add_u32 v90, v94, 7, v90
    v_add_u32 v90, s22, v90
    v_add_u32 v91, 2, v95
    v_xor_b32 v91, v91, v96
    v_lshlrev_b32 v91, 4, v91
    v_lshl_add_u32 v91, v94, 7, v91
    v_add_u32 v91, s22, v91
    v_add_u32 v92, 4, v95
    v_xor_b32 v92, v92, v96
    v_lshlrev_b32 v92, 4, v92
    v_lshl_add_u32 v92, v94, 7, v92
    v_add_u32 v92, s22, v92
    v_add_u32 v93, 6, v95
    v_xor_b32 v93, v93, v96
    v_lshlrev_b32 v93, 4, v93
    v_lshl_add_u32 v93, v94, 7, v93
    v_add_u32 v93, s22, v93
    v_add_u32 v97, 0, v88
    global_load_dwordx4 a[0:3], v97, s[14:15] offset:0
    v_add_u32 v97, 9216, v88
    global_load_dwordx4 a[4:7], v97, s[14:15] offset:0
    v_add_u32 v97, 18432, v88
    global_load_dwordx4 a[8:11], v97, s[14:15] offset:0
    v_add_u32 v97, 27648, v88
    global_load_dwordx4 a[12:15], v97, s[14:15] offset:0
    v_add_u32 v97, 0, v88
    global_load_dwordx4 a[16:19], v97, s[14:15] offset:128
    v_add_u32 v97, 9216, v88
    global_load_dwordx4 a[20:23], v97, s[14:15] offset:128
    v_add_u32 v97, 18432, v88
    global_load_dwordx4 a[24:27], v97, s[14:15] offset:128
    v_add_u32 v97, 27648, v88
    global_load_dwordx4 a[28:31], v97, s[14:15] offset:128
    v_add_u32 v97, 0, v88
    global_load_dwordx4 a[32:35], v97, s[14:15] offset:256
    v_add_u32 v97, 9216, v88
    global_load_dwordx4 a[36:39], v97, s[14:15] offset:256
    v_add_u32 v97, 18432, v88
    global_load_dwordx4 a[40:43], v97, s[14:15] offset:256
    v_add_u32 v97, 27648, v88
    global_load_dwordx4 a[44:47], v97, s[14:15] offset:256
    v_add_u32 v97, 0, v88
    global_load_dwordx4 a[48:51], v97, s[14:15] offset:384
    v_add_u32 v97, 9216, v88
    global_load_dwordx4 a[52:55], v97, s[14:15] offset:384
    v_add_u32 v97, 18432, v88
    global_load_dwordx4 a[56:59], v97, s[14:15] offset:384
    v_add_u32 v97, 27648, v88
    global_load_dwordx4 a[60:63], v97, s[14:15] offset:384
    v_add_u32 v97, 0, v88
    global_load_dwordx4 a[64:67], v97, s[14:15] offset:512
    v_add_u32 v97, 9216, v88
    global_load_dwordx4 a[68:71], v97, s[14:15] offset:512
    v_add_u32 v97, 18432, v88
    global_load_dwordx4 a[72:75], v97, s[14:15] offset:512
    v_add_u32 v97, 27648, v88
    global_load_dwordx4 a[76:79], v97, s[14:15] offset:512
    v_add_u32 v97, 0, v88
    global_load_dwordx4 a[80:83], v97, s[14:15] offset:640
    v_add_u32 v97, 9216, v88
    global_load_dwordx4 a[84:87], v97, s[14:15] offset:640
    v_add_u32 v97, 18432, v88
    global_load_dwordx4 a[88:91], v97, s[14:15] offset:640
    v_add_u32 v97, 27648, v88
    global_load_dwordx4 a[92:95], v97, s[14:15] offset:640
    v_add_u32 v97, 0, v88
    global_load_dwordx4 a[96:99], v97, s[14:15] offset:768
    v_add_u32 v97, 9216, v88
    global_load_dwordx4 a[100:103], v97, s[14:15] offset:768
    v_add_u32 v97, 18432, v88
    global_load_dwordx4 a[104:107], v97, s[14:15] offset:768
    v_add_u32 v97, 27648, v88
    global_load_dwordx4 a[108:111], v97, s[14:15] offset:768
    v_add_u32 v97, 0, v88
    global_load_dwordx4 a[112:115], v97, s[14:15] offset:896
    v_add_u32 v97, 9216, v88
    global_load_dwordx4 a[116:119], v97, s[14:15] offset:896
    v_add_u32 v97, 18432, v88
    global_load_dwordx4 a[120:123], v97, s[14:15] offset:896
    v_add_u32 v97, 27648, v88
    global_load_dwordx4 a[124:127], v97, s[14:15] offset:896
    v_add_u32 v97, 0, v88
    global_load_dwordx4 a[128:131], v97, s[14:15] offset:1024
    v_add_u32 v97, 9216, v88
    global_load_dwordx4 a[132:135], v97, s[14:15] offset:1024
    v_add_u32 v97, 18432, v88
    global_load_dwordx4 a[136:139], v97, s[14:15] offset:1024
    v_add_u32 v97, 27648, v88
    global_load_dwordx4 a[140:143], v97, s[14:15] offset:1024
    v_add_u32 v97, 36864, v88
    global_load_dwordx4 a[144:147], v97, s[14:15] offset:0
    v_add_u32 v97, 46080, v88
    global_load_dwordx4 a[148:151], v97, s[14:15] offset:0
    v_add_u32 v97, 55296, v88
    global_load_dwordx4 a[152:155], v97, s[14:15] offset:0
    v_add_u32 v97, 64512, v88
    global_load_dwordx4 a[156:159], v97, s[14:15] offset:0
    s_waitcnt vmcnt(36)
    ds_write_b128 v89, a[0:3] offset:0
    ds_write_b128 v89, a[4:7] offset:1024
    ds_write_b128 v89, a[8:11] offset:2048
    ds_write_b128 v89, a[12:15] offset:3072
    s_waitcnt lgkmcnt(0)
    ds_read_b128 a[0:3], v90 offset:0
    ds_read_b128 a[4:7], v91 offset:0
    ds_read_b128 a[8:11], v92 offset:0
    ds_read_b128 a[12:15], v93 offset:0
    v_add_u32 v97, 36864, v88
    global_load_dwordx4 a[160:163], v97, s[14:15] offset:128
    v_add_u32 v97, 46080, v88
    global_load_dwordx4 a[164:167], v97, s[14:15] offset:128
    v_add_u32 v97, 55296, v88
    global_load_dwordx4 a[168:171], v97, s[14:15] offset:128
    v_add_u32 v97, 64512, v88
    global_load_dwordx4 a[172:175], v97, s[14:15] offset:128
    s_waitcnt vmcnt(36)
    ds_write_b128 v89, a[16:19] offset:4096
    ds_write_b128 v89, a[20:23] offset:5120
    ds_write_b128 v89, a[24:27] offset:6144
    ds_write_b128 v89, a[28:31] offset:7168
    s_waitcnt lgkmcnt(0)
    ds_read_b128 a[16:19], v90 offset:4096
    ds_read_b128 a[20:23], v91 offset:4096
    ds_read_b128 a[24:27], v92 offset:4096
    ds_read_b128 a[28:31], v93 offset:4096
    v_add_u32 v97, 36864, v88
    global_load_dwordx4 a[176:179], v97, s[14:15] offset:256
    v_add_u32 v97, 46080, v88
    global_load_dwordx4 a[180:183], v97, s[14:15] offset:256
    v_add_u32 v97, 55296, v88
    global_load_dwordx4 a[184:187], v97, s[14:15] offset:256
    v_add_u32 v97, 64512, v88
    global_load_dwordx4 a[188:191], v97, s[14:15] offset:256
    s_waitcnt vmcnt(36)
    ds_write_b128 v89, a[32:35] offset:8192
    ds_write_b128 v89, a[36:39] offset:9216
    ds_write_b128 v89, a[40:43] offset:10240
    ds_write_b128 v89, a[44:47] offset:11264
    s_waitcnt lgkmcnt(0)
    ds_read_b128 a[32:35], v90 offset:8192
    ds_read_b128 a[36:39], v91 offset:8192
    ds_read_b128 a[40:43], v92 offset:8192
    ds_read_b128 a[44:47], v93 offset:8192
    v_add_u32 v97, 36864, v88
    global_load_dwordx4 a[192:195], v97, s[14:15] offset:384
    v_add_u32 v97, 46080, v88
    global_load_dwordx4 a[196:199], v97, s[14:15] offset:384
    v_add_u32 v97, 55296, v88
    global_load_dwordx4 a[200:203], v97, s[14:15] offset:384
    v_add_u32 v97, 64512, v88
    global_load_dwordx4 a[204:207], v97, s[14:15] offset:384
    s_waitcnt vmcnt(36)
    ds_write_b128 v89, a[48:51] offset:12288
    ds_write_b128 v89, a[52:55] offset:13312
    ds_write_b128 v89, a[56:59] offset:14336
    ds_write_b128 v89, a[60:63] offset:15360
    s_waitcnt lgkmcnt(0)
    ds_read_b128 a[48:51], v90 offset:12288
    ds_read_b128 a[52:55], v91 offset:12288
    ds_read_b128 a[56:59], v92 offset:12288
    ds_read_b128 a[60:63], v93 offset:12288
    v_add_u32 v97, 36864, v88
    global_load_dwordx4 a[208:211], v97, s[14:15] offset:512
    v_add_u32 v97, 46080, v88
    global_load_dwordx4 a[212:215], v97, s[14:15] offset:512
    v_add_u32 v97, 55296, v88
    global_load_dwordx4 a[216:219], v97, s[14:15] offset:512
    v_add_u32 v97, 64512, v88
    global_load_dwordx4 a[220:223], v97, s[14:15] offset:512
    s_waitcnt vmcnt(36)
    ds_write_b128 v89, a[64:67] offset:0
    ds_write_b128 v89, a[68:71] offset:1024
    ds_write_b128 v89, a[72:75] offset:2048
    ds_write_b128 v89, a[76:79] offset:3072
    s_waitcnt lgkmcnt(0)
    ds_read_b128 a[64:67], v90 offset:0
    ds_read_b128 a[68:71], v91 offset:0
    ds_read_b128 a[72:75], v92 offset:0
    ds_read_b128 a[76:79], v93 offset:0
    v_add_u32 v97, 36864, v88
    global_load_dwordx4 a[224:227], v97, s[14:15] offset:640
    v_add_u32 v97, 46080, v88
    global_load_dwordx4 a[228:231], v97, s[14:15] offset:640
    v_add_u32 v97, 55296, v88
    global_load_dwordx4 a[232:235], v97, s[14:15] offset:640
    v_add_u32 v97, 64512, v88
    global_load_dwordx4 a[236:239], v97, s[14:15] offset:640
    s_waitcnt vmcnt(36)
    ds_write_b128 v89, a[80:83] offset:4096
    ds_write_b128 v89, a[84:87] offset:5120
    ds_write_b128 v89, a[88:91] offset:6144
    ds_write_b128 v89, a[92:95] offset:7168
    s_waitcnt lgkmcnt(0)
    ds_read_b128 a[80:83], v90 offset:4096
    ds_read_b128 a[84:87], v91 offset:4096
    ds_read_b128 a[88:91], v92 offset:4096
    ds_read_b128 a[92:95], v93 offset:4096
    v_add_u32 v97, 36864, v88
    global_load_dwordx4 a[240:243], v97, s[14:15] offset:768
    v_add_u32 v97, 46080, v88
    global_load_dwordx4 a[244:247], v97, s[14:15] offset:768
    v_add_u32 v97, 55296, v88
    global_load_dwordx4 a[248:251], v97, s[14:15] offset:768
    v_add_u32 v97, 64512, v88
    global_load_dwordx4 a[252:255], v97, s[14:15] offset:768
    s_waitcnt vmcnt(36)
    ds_write_b128 v89, a[96:99] offset:8192
    ds_write_b128 v89, a[100:103] offset:9216
    ds_write_b128 v89, a[104:107] offset:10240
    ds_write_b128 v89, a[108:111] offset:11264
    s_waitcnt lgkmcnt(0)
    ds_read_b128 a[96:99], v90 offset:8192
    ds_read_b128 a[100:103], v91 offset:8192
    ds_read_b128 a[104:107], v92 offset:8192
    ds_read_b128 a[108:111], v93 offset:8192
    v_add_u32 v97, 36864, v88
    global_load_dwordx4 v[224:227], v97, s[14:15] offset:896
    v_add_u32 v97, 46080, v88
    global_load_dwordx4 v[228:231], v97, s[14:15] offset:896
    v_add_u32 v97, 55296, v88
    global_load_dwordx4 v[232:235], v97, s[14:15] offset:896
    v_add_u32 v97, 64512, v88
    global_load_dwordx4 v[236:239], v97, s[14:15] offset:896
    s_waitcnt vmcnt(36)
    ds_write_b128 v89, a[112:115] offset:12288
    ds_write_b128 v89, a[116:119] offset:13312
    ds_write_b128 v89, a[120:123] offset:14336
    ds_write_b128 v89, a[124:127] offset:15360
    s_waitcnt lgkmcnt(0)
    ds_read_b128 a[112:115], v90 offset:12288
    ds_read_b128 a[116:119], v91 offset:12288
    ds_read_b128 a[120:123], v92 offset:12288
    ds_read_b128 a[124:127], v93 offset:12288
    v_add_u32 v97, 36864, v88
    global_load_dwordx4 v[240:243], v97, s[14:15] offset:1024
    v_add_u32 v97, 46080, v88
    global_load_dwordx4 v[244:247], v97, s[14:15] offset:1024
    v_add_u32 v97, 55296, v88
    global_load_dwordx4 v[248:251], v97, s[14:15] offset:1024
    v_add_u32 v97, 64512, v88
    global_load_dwordx4 v[252:255], v97, s[14:15] offset:1024
    s_waitcnt vmcnt(36)
    ds_write_b128 v89, a[128:131] offset:0
    ds_write_b128 v89, a[132:135] offset:1024
    ds_write_b128 v89, a[136:139] offset:2048
    ds_write_b128 v89, a[140:143] offset:3072
    s_waitcnt lgkmcnt(0)
    ds_read_b128 a[128:131], v90 offset:0
    ds_read_b128 a[132:135], v91 offset:0
    ds_read_b128 a[136:139], v92 offset:0
    ds_read_b128 a[140:143], v93 offset:0
    s_waitcnt vmcnt(32)
    ds_write_b128 v89, a[144:147] offset:4096
    ds_write_b128 v89, a[148:151] offset:5120
    ds_write_b128 v89, a[152:155] offset:6144
    ds_write_b128 v89, a[156:159] offset:7168
    s_waitcnt lgkmcnt(0)
    ds_read_b128 a[144:147], v90 offset:4096
    ds_read_b128 a[148:151], v91 offset:4096
    ds_read_b128 a[152:155], v92 offset:4096
    ds_read_b128 a[156:159], v93 offset:4096
    s_waitcnt vmcnt(28)
    ds_write_b128 v89, a[160:163] offset:8192
    ds_write_b128 v89, a[164:167] offset:9216
    ds_write_b128 v89, a[168:171] offset:10240
    ds_write_b128 v89, a[172:175] offset:11264
    s_waitcnt lgkmcnt(0)
    ds_read_b128 a[160:163], v90 offset:8192
    ds_read_b128 a[164:167], v91 offset:8192
    ds_read_b128 a[168:171], v92 offset:8192
    ds_read_b128 a[172:175], v93 offset:8192
    s_waitcnt vmcnt(24)
    ds_write_b128 v89, a[176:179] offset:12288
    ds_write_b128 v89, a[180:183] offset:13312
    ds_write_b128 v89, a[184:187] offset:14336
    ds_write_b128 v89, a[188:191] offset:15360
    s_waitcnt lgkmcnt(0)
    ds_read_b128 a[176:179], v90 offset:12288
    ds_read_b128 a[180:183], v91 offset:12288
    ds_read_b128 a[184:187], v92 offset:12288
    ds_read_b128 a[188:191], v93 offset:12288
    s_waitcnt vmcnt(20)
    ds_write_b128 v89, a[192:195] offset:0
    ds_write_b128 v89, a[196:199] offset:1024
    ds_write_b128 v89, a[200:203] offset:2048
    ds_write_b128 v89, a[204:207] offset:3072
    s_waitcnt lgkmcnt(0)
    ds_read_b128 a[192:195], v90 offset:0
    ds_read_b128 a[196:199], v91 offset:0
    ds_read_b128 a[200:203], v92 offset:0
    ds_read_b128 a[204:207], v93 offset:0
    s_waitcnt vmcnt(16)
    ds_write_b128 v89, a[208:211] offset:4096
    ds_write_b128 v89, a[212:215] offset:5120
    ds_write_b128 v89, a[216:219] offset:6144
    ds_write_b128 v89, a[220:223] offset:7168
    s_waitcnt lgkmcnt(0)
    ds_read_b128 a[208:211], v90 offset:4096
    ds_read_b128 a[212:215], v91 offset:4096
    ds_read_b128 a[216:219], v92 offset:4096
    ds_read_b128 a[220:223], v93 offset:4096
    s_waitcnt vmcnt(12)
    ds_write_b128 v89, a[224:227] offset:8192
    ds_write_b128 v89, a[228:231] offset:9216
    ds_write_b128 v89, a[232:235] offset:10240
    ds_write_b128 v89, a[236:239] offset:11264
    s_waitcnt lgkmcnt(0)
    ds_read_b128 a[224:227], v90 offset:8192
    ds_read_b128 a[228:231], v91 offset:8192
    ds_read_b128 a[232:235], v92 offset:8192
    ds_read_b128 a[236:239], v93 offset:8192
    s_waitcnt vmcnt(8)
    ds_write_b128 v89, a[240:243] offset:12288
    ds_write_b128 v89, a[244:247] offset:13312
    ds_write_b128 v89, a[248:251] offset:14336
    ds_write_b128 v89, a[252:255] offset:15360
    s_waitcnt lgkmcnt(0)
    ds_read_b128 a[240:243], v90 offset:12288
    ds_read_b128 a[244:247], v91 offset:12288
    ds_read_b128 a[248:251], v92 offset:12288
    ds_read_b128 a[252:255], v93 offset:12288
    s_waitcnt vmcnt(4)
    ds_write_b128 v89, v[224:227] offset:0
    ds_write_b128 v89, v[228:231] offset:1024
    ds_write_b128 v89, v[232:235] offset:2048
    ds_write_b128 v89, v[236:239] offset:3072
    s_waitcnt lgkmcnt(0)
    ds_read_b128 v[224:227], v90 offset:0
    ds_read_b128 v[228:231], v91 offset:0
    ds_read_b128 v[232:235], v92 offset:0
    ds_read_b128 v[236:239], v93 offset:0
    s_waitcnt vmcnt(0)
    ds_write_b128 v89, v[240:243] offset:4096
    ds_write_b128 v89, v[244:247] offset:5120
    ds_write_b128 v89, v[248:251] offset:6144
    ds_write_b128 v89, v[252:255] offset:7168
    s_waitcnt lgkmcnt(0)
    ds_read_b128 v[240:243], v90 offset:4096
    ds_read_b128 v[244:247], v91 offset:4096
    ds_read_b128 v[248:251], v92 offset:4096
    ds_read_b128 v[252:255], v93 offset:4096
    s_waitcnt lgkmcnt(0)
    s_barrier
L_nosw_20:
    s_cmp_lt_u32 s12, s62
    s_cbranch_scc1 L_d0_21
    s_cmp_ge_u32 s12, s65
    s_cbranch_scc1 L_dB_22
    s_sub_u32 s22, s12, s62
    s_mul_i32 s22, s22, 28
    s_add_u32 s22, s22, s11
    s_add_u32 s22, s22, s66
    s_branch L_dq_25
L_d0_21:
    s_mov_b32 s22, s63
L_dq_25:
    s_lshr_b32 s13, s22, 6
    s_and_b32 s60, s22, 63
    s_branch L_dD_24
L_dB_22:
    s_sub_u32 s22, s12, s65
    s_cmp_eq_u32 s38, 1
    s_cbranch_scc1 L_dF_23
    s_mul_i32 s22, s22, 9
    s_add_u32 s60, s22, s11
    s_mov_b32 s13, 2
    s_branch L_dD_24
L_dF_23:
    s_mul_i32 s22, s22, 19
    s_add_u32 s60, s22, s11
    s_sub_u32 s60, s60, 9
    s_mov_b32 s13, 3
L_dD_24:
    s_add_u32 s46, s12, 1
    s_sub_u32 s25, s49, 1
    s_min_u32 s46, s46, s25
    s_cmp_lt_u32 s46, s62
    s_cbranch_scc1 L_d0_26
    s_cmp_ge_u32 s46, s65
    s_cbranch_scc1 L_dB_27
    s_sub_u32 s22, s46, s62
    s_mul_i32 s22, s22, 28
    s_add_u32 s22, s22, s11
    s_add_u32 s22, s22, s66
    s_branch L_dq_30
L_d0_26:
    s_mov_b32 s22, s63
L_dq_30:
    s_lshr_b32 s58, s22, 6
    s_and_b32 s59, s22, 63
    s_branch L_dD_29
L_dB_27:
    s_sub_u32 s22, s46, s65
    s_cmp_eq_u32 s38, 1
    s_cbranch_scc1 L_dF_28
    s_mul_i32 s22, s22, 9
    s_add_u32 s59, s22, s11
    s_mov_b32 s58, 2
    s_branch L_dD_29
L_dF_28:
    s_mul_i32 s22, s22, 19
    s_add_u32 s59, s22, s11
    s_sub_u32 s59, s59, 9
    s_mov_b32 s58, 3
L_dD_29:
    s_cmp_eq_u32 s58, 3
    s_cbranch_scc1 L_p1f_31
    s_cmp_eq_u32 s58, 0
    s_cselect_b32 s16, s28, s30
    s_cselect_b32 s17, s29, s31
    s_cmp_eq_u32 s58, 2
    s_cselect_b32 s16, s26, s16
    s_cselect_b32 s17, s27, s17
    s_lshl_b32 s23, s59, 7
    s_lshr_b32 s24, s8, 1
    s_lshl_b32 s24, s24, 6
    s_add_u32 s23, s23, s24
    s_mov_b32 s18, 8192
    s_branch L_p1d_32
L_p1f_31:
    s_cmp_lt_u32 s8, 2
    s_cselect_b32 s16, s32, s34
    s_cselect_b32 s17, s33, s35
    s_lshl_b32 s23, s59, 6
    s_mov_b32 s18, 9216
L_p1d_32:
    s_add_u32 s16, s16, s23
    s_addc_u32 s17, s17, 0
    s_lshl_b32 s39, s18, 4
    v_lshrrev_b32 v3, 2, v6
    v_mul_lo_u32 v3, v3, s18
    v_and_b32 v7, 3, v6
    v_lshl_add_u32 v3, v7, 4, v3
    s_and_b32 s22, s8, 1
    s_mul_i32 s22, s22, 18
    s_mul_i32 s22, s22, s39
    v_add_u32 v3, s22, v3
    s_sub_u32 s47, 73728, s41
    s_lshr_b32 s22, s8, 1
    s_mul_i32 s22, s22, 36864
    s_and_b32 s23, s8, 1
    s_mul_i32 s23, s23, 18432
    s_add_u32 s40, s22, s23
    s_add_u32 s40, s40, s47
    s_cmp_eq_u32 s13, 3
    s_cbranch_scc1 L_p1H_17
    s_lshr_b32 s23, s60, 1
    s_lshl_b32 s24, s64, 3
    s_lshl_b32 s25, s8, 1
    s_add_u32 s24, s24, s25
    s_lshl_b32 s24, s24, 5
    s_add_u32 s24, s24, s23
    s_lshl_b32 s24, s24, 13
    s_and_b32 s22, s60, 1
    s_cmp_eq_u32 s13, 1
    s_cbranch_scc1 L_p1V_16
    s_lshl_b32 s22, s22, 11
    s_add_u32 s24, s24, s22
    s_cmp_eq_u32 s13, 0
    s_mov_b32 s22, 50331648
    s_cselect_b32 s22, 0, s22
    s_add_u32 s24, s24, s22
    s_add_u32 s20, s4, s24
    s_addc_u32 s21, s5, 0
    v_bfe_u32 v7, v6, 4, 1
    v_lshlrev_b32 v4, 12, v7
    v_and_b32 v7, 15, v6
    v_lshl_add_u32 v4, v7, 4, v4
    v_lshrrev_b32 v7, 5, v6
    v_lshl_add_u32 v4, v7, 8, v4
    ds_read_b64_tr_b16 v[8:9], v1 offset:0
    ds_read_b64_tr_b16 v[10:11], v1 offset:256
    ds_read_b64_tr_b16 v[12:13], v2 offset:0
    ds_read_b64_tr_b16 v[14:15], v2 offset:256
    ds_read_b64_tr_b16 v[16:17], v1 offset:1024
    ds_read_b64_tr_b16 v[18:19], v1 offset:1280
    ds_read_b64_tr_b16 v[20:21], v2 offset:1024
    ds_read_b64_tr_b16 v[22:23], v2 offset:1280
    s_waitcnt lgkmcnt(4)
    v_mfma_f32_32x32x16_bf16 v[24:39], v[8:11], a[0:3], 0
    v_mfma_f32_32x32x16_bf16 v[40:55], v[12:15], a[0:3], 0
    s_mov_b32 m0, s40
    s_add_u32 s40, s40, 1024
    global_load_lds_dwordx4 v3, s[16:17]
    v_add_u32 v3, s39, v3
    v_mfma_f32_32x32x16_bf16 v[56:71], v[8:11], a[144:147], 0
    v_mfma_f32_32x32x16_bf16 v[72:87], v[12:15], a[144:147], 0
    ds_read_b64_tr_b16 v[8:9], v1 offset:2048
    ds_read_b64_tr_b16 v[10:11], v1 offset:2304
    ds_read_b64_tr_b16 v[12:13], v2 offset:2048
    ds_read_b64_tr_b16 v[14:15], v2 offset:2304
    s_waitcnt lgkmcnt(4)
    v_mfma_f32_32x32x16_bf16 v[24:39], v[16:19], a[4:7], v[24:39]
    v_mfma_f32_32x32x16_bf16 v[40:55], v[20:23], a[4:7], v[40:55]
    s_mov_b32 m0, s40
    s_add_u32 s40, s40, 1024
    global_load_lds_dwordx4 v3, s[16:17]
    v_add_u32 v3, s39, v3
    v_mfma_f32_32x32x16_bf16 v[56:71], v[16:19], a[148:151], v[56:71]
    v_mfma_f32_32x32x16_bf16 v[72:87], v[20:23], a[148:151], v[72:87]
    ds_read_b64_tr_b16 v[16:17], v1 offset:3072
    ds_read_b64_tr_b16 v[18:19], v1 offset:3328
    ds_read_b64_tr_b16 v[20:21], v2 offset:3072
    ds_read_b64_tr_b16 v[22:23], v2 offset:3328
    s_waitcnt lgkmcnt(4)
    v_mfma_f32_32x32x16_bf16 v[24:39], v[8:11], a[8:11], v[24:39]
    v_mfma_f32_32x32x16_bf16 v[40:55], v[12:15], a[8:11], v[40:55]
    s_mov_b32 m0, s40
    s_add_u32 s40, s40, 1024
    global_load_lds_dwordx4 v3, s[16:17]
    v_add_u32 v3, s39, v3
    v_mfma_f32_32x32x16_bf16 v[56:71], v[8:11], a[152:155], v[56:71]
    v_mfma_f32_32x32x16_bf16 v[72:87], v[12:15], a[152:155], v[72:87]
    ds_read_b64_tr_b16 v[8:9], v1 offset:4096
    ds_read_b64_tr_b16 v[10:11], v1 offset:4352
    ds_read_b64_tr_b16 v[12:13], v2 offset:4096
    ds_read_b64_tr_b16 v[14:15], v2 offset:4352
    s_waitcnt lgkmcnt(4)
    v_mfma_f32_32x32x16_bf16 v[24:39], v[16:19], a[12:15], v[24:39]
    v_mfma_f32_32x32x16_bf16 v[40:55], v[20:23], a[12:15], v[40:55]
    s_mov_b32 m0, s40
    s_add_u32 s40, s40, 1024
    global_load_lds_dwordx4 v3, s[16:17]
    v_add_u32 v3, s39, v3
    v_mfma_f32_32x32x16_bf16 v[56:71], v[16:19], a[156:159], v[56:71]
    v_mfma_f32_32x32x16_bf16 v[72:87], v[20:23], a[156:159], v[72:87]
    ds_read_b64_tr_b16 v[16:17], v1 offset:5120
    ds_read_b64_tr_b16 v[18:19], v1 offset:5376
    ds_read_b64_tr_b16 v[20:21], v2 offset:5120
    ds_read_b64_tr_b16 v[22:23], v2 offset:5376
    s_waitcnt lgkmcnt(4)
    v_mfma_f32_32x32x16_bf16 v[24:39], v[8:11], a[16:19], v[24:39]
    v_mfma_f32_32x32x16_bf16 v[40:55], v[12:15], a[16:19], v[40:55]
    s_mov_b32 m0, s40
    s_add_u32 s40, s40, 1024
    global_load_lds_dwordx4 v3, s[16:17]
    v_add_u32 v3, s39, v3
    v_mfma_f32_32x32x16_bf16 v[56:71], v[8:11], a[160:163], v[56:71]
    v_mfma_f32_32x32x16_bf16 v[72:87], v[12:15], a[160:163], v[72:87]
    ds_read_b64_tr_b16 v[8:9], v1 offset:6144
    ds_read_b64_tr_b16 v[10:11], v1 offset:6400
    ds_read_b64_tr_b16 v[12:13], v2 offset:6144
    ds_read_b64_tr_b16 v[14:15], v2 offset:6400
    s_waitcnt lgkmcnt(4)
    v_mfma_f32_32x32x16_bf16 v[24:39], v[16:19], a[20:23], v[24:39]
    v_mfma_f32_32x32x16_bf16 v[40:55], v[20:23], a[20:23], v[40:55]
    s_mov_b32 m0, s40
    s_add_u32 s40, s40, 1024
    global_load_lds_dwordx4 v3, s[16:17]
    v_add_u32 v3, s39, v3
    v_mfma_f32_32x32x16_bf16 v[56:71], v[16:19], a[164:167], v[56:71]
    v_mfma_f32_32x32x16_bf16 v[72:87], v[20:23], a[164:167], v[72:87]
    ds_read_b64_tr_b16 v[16:17], v1 offset:7168
    ds_read_b64_tr_b16 v[18:19], v1 offset:7424
    ds_read_b64_tr_b16 v[20:21], v2 offset:7168
    ds_read_b64_tr_b16 v[22:23], v2 offset:7424
    s_waitcnt lgkmcnt(4)
    v_mfma_f32_32x32x16_bf16 v[24:39], v[8:11], a[24:27], v[24:39]
    v_mfma_f32_32x32x16_bf16 v[40:55], v[12:15], a[24:27], v[40:55]
    s_mov_b32 m0, s40
    s_add_u32 s40, s40, 1024
    global_load_lds_dwordx4 v3, s[16:17]
    v_add_u32 v3, s39, v3
    v_mfma_f32_32x32x16_bf16 v[56:71], v[8:11], a[168:171], v[56:71]
    v_mfma_f32_32x32x16_bf16 v[72:87], v[12:15], a[168:171], v[72:87]
    ds_read_b64_tr_b16 v[8:9], v1 offset:8192
    ds_read_b64_tr_b16 v[10:11], v1 offset:8448
    ds_read_b64_tr_b16 v[12:13], v2 offset:8192
    ds_read_b64_tr_b16 v[14:15], v2 offset:8448
    s_waitcnt lgkmcnt(4)
    v_mfma_f32_32x32x16_bf16 v[24:39], v[16:19], a[28:31], v[24:39]
    v_mfma_f32_32x32x16_bf16 v[40:55], v[20:23], a[28:31], v[40:55]
    s_mov_b32 m0, s40
    s_add_u32 s40, s40, 1024
    global_load_lds_dwordx4 v3, s[16:17]
    v_add_u32 v3, s39, v3
    v_mfma_f32_32x32x16_bf16 v[56:71], v[16:19], a[172:175], v[56:71]
    v_mfma_f32_32x32x16_bf16 v[72:87], v[20:23], a[172:175], v[72:87]
    ds_read_b64_tr_b16 v[16:17], v1 offset:9216
    ds_read_b64_tr_b16 v[18:19], v1 offset:9472
    ds_read_b64_tr_b16 v[20:21], v2 offset:9216
    ds_read_b64_tr_b16 v[22:23], v2 offset:9472
    s_waitcnt lgkmcnt(4)
    v_mfma_f32_32x32x16_bf16 v[24:39], v[8:11], a[32:35], v[24:39]
    v_mfma_f32_32x32x16_bf16 v[40:55], v[12:15], a[32:35], v[40:55]
    s_mov_b32 m0, s40
    s_add_u32 s40, s40, 1024
    global_load_lds_dwordx4 v3, s[16:17]
    v_add_u32 v3, s39, v3
    v_mfma_f32_32x32x16_bf16 v[56:71], v[8:11], a[176:179], v[56:71]
    v_mfma_f32_32x32x16_bf16 v[72:87], v[12:15], a[176:179], v[72:87]
    ds_read_b64_tr_b16 v[8:9], v1 offset:10240
    ds_read_b64_tr_b16 v[10:11], v1 offset:10496
    ds_read_b64_tr_b16 v[12:13], v2 offset:10240
    ds_read_b64_tr_b16 v[14:15], v2 offset:10496
    s_waitcnt lgkmcnt(4)
    v_mfma_f32_32x32x16_bf16 v[24:39], v[16:19], a[36:39], v[24:39]
    v_mfma_f32_32x32x16_bf16 v[40:55], v[20:23], a[36:39], v[40:55]
    s_mov_b32 m0, s40
    s_add_u32 s40, s40, 1024
    global_load_lds_dwordx4 v3, s[16:17]
    v_add_u32 v3, s39, v3
    v_mfma_f32_32x32x16_bf16 v[56:71], v[16:19], a[180:183], v[56:71]
    v_mfma_f32_32x32x16_bf16 v[72:87], v[20:23], a[180:183], v[72:87]
    ds_read_b64_tr_b16 v[16:17], v1 offset:11264
    ds_read_b64_tr_b16 v[18:19], v1 offset:11520
    ds_read_b64_tr_b16 v[20:21], v2 offset:11264
    ds_read_b64_tr_b16 v[22:23], v2 offset:11520
    s_waitcnt lgkmcnt(4)
    v_mfma_f32_32x32x16_bf16 v[24:39], v[8:11], a[40:43], v[24:39]
    v_mfma_f32_32x32x16_bf16 v[40:55], v[12:15], a[40:43], v[40:55]
    s_mov_b32 m0, s40
    s_add_u32 s40, s40, 1024
    global_load_lds_dwordx4 v3, s[16:17]
    v_add_u32 v3, s39, v3
    v_mfma_f32_32x32x16_bf16 v[56:71], v[8:11], a[184:187], v[56:71]
    v_mfma_f32_32x32x16_bf16 v[72:87], v[12:15], a[184:187], v[72:87]
    ds_read_b64_tr_b16 v[8:9], v1 offset:12288
    ds_read_b64_tr_b16 v[10:11], v1 offset:12544
    ds_read_b64_tr_b16 v[12:13], v2 offset:12288
    ds_read_b64_tr_b16 v[14:15], v2 offset:12544
    s_waitcnt lgkmcnt(4)
    v_mfma_f32_32x32x16_bf16 v[24:39], v[16:19], a[44:47], v[24:39]
    v_mfma_f32_32x32x16_bf16 v[40:55], v[20:23], a[44:47], v[40:55]
    s_mov_b32 m0, s40
    s_add_u32 s40, s40, 1024
    global_load_lds_dwordx4 v3, s[16:17]
    v_add_u32 v3, s39, v3
    v_mfma_f32_32x32x16_bf16 v[56:71], v[16:19], a[188:191], v[56:71]
    v_mfma_f32_32x32x16_bf16 v[72:87], v[20:23], a[188:191], v[72:87]
    ds_read_b64_tr_b16 v[16:17], v1 offset:13312
    ds_read_b64_tr_b16 v[18:19], v1 offset:13568
    ds_read_b64_tr_b16 v[20:21], v2 offset:13312
    ds_read_b64_tr_b16 v[22:23], v2 offset:13568
    s_waitcnt lgkmcnt(4)
    v_mfma_f32_32x32x16_bf16 v[24:39], v[8:11], a[48:51], v[24:39]
    v_mfma_f32_32x32x16_bf16 v[40:55], v[12:15], a[48:51], v[40:55]
    s_mov_b32 m0, s40
    s_add_u32 s40, s40, 1024
    global_load_lds_dwordx4 v3, s[16:17]
    v_add_u32 v3, s39, v3
    v_mfma_f32_32x32x16_bf16 v[56:71], v[8:11], a[192:195], v[56:71]
    v_mfma_f32_32x32x16_bf16 v[72:87], v[12:15], a[192:195], v[72:87]
    ds_read_b64_tr_b16 v[8:9], v1 offset:14336
    ds_read_b64_tr_b16 v[10:11], v1 offset:14592
    ds_read_b64_tr_b16 v[12:13], v2 offset:14336
    ds_read_b64_tr_b16 v[14:15], v2 offset:14592
    s_waitcnt lgkmcnt(4)
    v_mfma_f32_32x32x16_bf16 v[24:39], v[16:19], a[52:55], v[24:39]
    v_mfma_f32_32x32x16_bf16 v[40:55], v[20:23], a[52:55], v[40:55]
    s_mov_b32 m0, s40
    s_add_u32 s40, s40, 1024
    global_load_lds_dwordx4 v3, s[16:17]
    v_add_u32 v3, s39, v3
    v_mfma_f32_32x32x16_bf16 v[56:71], v[16:19], a[196:199], v[56:71]
    v_mfma_f32_32x32x16_bf16 v[72:87], v[20:23], a[196:199], v[72:87]
    ds_read_b64_tr_b16 v[16:17], v1 offset:15360
    ds_read_b64_tr_b16 v[18:19], v1 offset:15616
    ds_read_b64_tr_b16 v[20:21], v2 offset:15360
    ds_read_b64_tr_b16 v[22:23], v2 offset:15616
    s_waitcnt lgkmcnt(4)
    v_mfma_f32_32x32x16_bf16 v[24:39], v[8:11], a[56:59], v[24:39]
    v_mfma_f32_32x32x16_bf16 v[40:55], v[12:15], a[56:59], v[40:55]
    s_mov_b32 m0, s40
    s_add_u32 s40, s40, 1024
    global_load_lds_dwordx4 v3, s[16:17]
    v_add_u32 v3, s39, v3
    v_mfma_f32_32x32x16_bf16 v[56:71], v[8:11], a[200:203], v[56:71]
    v_mfma_f32_32x32x16_bf16 v[72:87], v[12:15], a[200:203], v[72:87]
    ds_read_b64_tr_b16 v[8:9], v1 offset:16384
    ds_read_b64_tr_b16 v[10:11], v1 offset:16640
    ds_read_b64_tr_b16 v[12:13], v2 offset:16384
    ds_read_b64_tr_b16 v[14:15], v2 offset:16640
    s_waitcnt lgkmcnt(4)
    v_mfma_f32_32x32x16_bf16 v[24:39], v[16:19], a[60:63], v[24:39]
    v_mfma_f32_32x32x16_bf16 v[40:55], v[20:23], a[60:63], v[40:55]
    s_mov_b32 m0, s40
    s_add_u32 s40, s40, 1024
    global_load_lds_dwordx4 v3, s[16:17]
    v_add_u32 v3, s39, v3
    v_mfma_f32_32x32x16_bf16 v[56:71], v[16:19], a[204:207], v[56:71]
    v_mfma_f32_32x32x16_bf16 v[72:87], v[20:23], a[204:207], v[72:87]
    ds_read_b64_tr_b16 v[16:17], v1 offset:17408
    ds_read_b64_tr_b16 v[18:19], v1 offset:17664
    ds_read_b64_tr_b16 v[20:21], v2 offset:17408
    ds_read_b64_tr_b16 v[22:23], v2 offset:17664
    s_waitcnt lgkmcnt(4)
    v_mfma_f32_32x32x16_bf16 v[24:39], v[8:11], a[64:67], v[24:39]
    v_mfma_f32_32x32x16_bf16 v[40:55], v[12:15], a[64:67], v[40:55]
    s_mov_b32 m0, s40
    s_add_u32 s40, s40, 1024
    global_load_lds_dwordx4 v3, s[16:17]
    v_add_u32 v3, s39, v3
    v_mfma_f32_32x32x16_bf16 v[56:71], v[8:11], a[208:211], v[56:71]
    v_mfma_f32_32x32x16_bf16 v[72:87], v[12:15], a[208:211], v[72:87]
    ds_read_b64_tr_b16 v[8:9], v1 offset:18432
    ds_read_b64_tr_b16 v[10:11], v1 offset:18688
    ds_read_b64_tr_b16 v[12:13], v2 offset:18432
    ds_read_b64_tr_b16 v[14:15], v2 offset:18688
    s_waitcnt lgkmcnt(4)
    v_mfma_f32_32x32x16_bf16 v[24:39], v[16:19], a[68:71], v[24:39]
    v_mfma_f32_32x32x16_bf16 v[40:55], v[20:23], a[68:71], v[40:55]
    s_mov_b32 m0, s40
    s_add_u32 s40, s40, 1024
    global_load_lds_dwordx4 v3, s[16:17]
    v_add_u32 v3, s39, v3
    v_mfma_f32_32x32x16_bf16 v[56:71], v[16:19], a[212:215], v[56:71]
    v_mfma_f32_32x32x16_bf16 v[72:87], v[20:23], a[212:215], v[72:87]
    ds_read_b64_tr_b16 v[16:17], v1 offset:19456
    ds_read_b64_tr_b16 v[18:19], v1 offset:19712
    ds_read_b64_tr_b16 v[20:21], v2 offset:19456
    ds_read_b64_tr_b16 v[22:23], v2 offset:19712
    s_waitcnt lgkmcnt(4)
    v_mfma_f32_32x32x16_bf16 v[24:39], v[8:11], a[72:75], v[24:39]
    v_mfma_f32_32x32x16_bf16 v[40:55], v[12:15], a[72:75], v[40:55]
    v_mfma_f32_32x32x16_bf16 v[56:71], v[8:11], a[216:219], v[56:71]
    v_mfma_f32_32x32x16_bf16 v[72:87], v[12:15], a[216:219], v[72:87]
    ds_read_b64_tr_b16 v[8:9], v1 offset:20480
    ds_read_b64_tr_b16 v[10:11], v1 offset:20736
    ds_read_b64_tr_b16 v[12:13], v2 offset:20480
    ds_read_b64_tr_b16 v[14:15], v2 offset:20736
    s_waitcnt lgkmcnt(4)
    v_mfma_f32_32x32x16_bf16 v[24:39], v[16:19], a[76:79], v[24:39]
    v_mfma_f32_32x32x16_bf16 v[40:55], v[20:23], a[76:79], v[40:55]
    v_mfma_f32_32x32x16_bf16 v[56:71], v[16:19], a[220:223], v[56:71]
    v_mfma_f32_32x32x16_bf16 v[72:87], v[20:23], a[220:223], v[72:87]
    ds_read_b64_tr_b16 v[16:17], v1 offset:21504
    ds_read_b64_tr_b16 v[18:19], v1 offset:21760
    ds_read_b64_tr_b16 v[20:21], v2 offset:21504
    ds_read_b64_tr_b16 v[22:23], v2 offset:21760
    s_waitcnt lgkmcnt(4)
    v_mfma_f32_32x32x16_bf16 v[24:39], v[8:11], a[80:83], v[24:39]
    v_mfma_f32_32x32x16_bf16 v[40:55], v[12:15], a[80:83], v[40:55]
    v_mfma_f32_32x32x16_bf16 v[56:71], v[8:11], a[224:227], v[56:71]
    v_mfma_f32_32x32x16_bf16 v[72:87], v[12:15], a[224:227], v[72:87]
    ds_read_b64_tr_b16 v[8:9], v1 offset:22528
    ds_read_b64_tr_b16 v[10:11], v1 offset:22784
    ds_read_b64_tr_b16 v[12:13], v2 offset:22528
    ds_read_b64_tr_b16 v[14:15], v2 offset:22784
    s_waitcnt lgkmcnt(4)
    v_mfma_f32_32x32x16_bf16 v[24:39], v[16:19], a[84:87], v[24:39]
    v_mfma_f32_32x32x16_bf16 v[40:55], v[20:23], a[84:87], v[40:55]
    v_mfma_f32_32x32x16_bf16 v[56:71], v[16:19], a[228:231], v[56:71]
    v_mfma_f32_32x32x16_bf16 v[72:87], v[20:23], a[228:231], v[72:87]
    ds_read_b64_tr_b16 v[16:17], v1 offset:23552
    ds_read_b64_tr_b16 v[18:19], v1 offset:23808
    ds_read_b64_tr_b16 v[20:21], v2 offset:23552
    ds_read_b64_tr_b16 v[22:23], v2 offset:23808
    s_waitcnt lgkmcnt(4)
    v_mfma_f32_32x32x16_bf16 v[24:39], v[8:11], a[88:91], v[24:39]
    v_mfma_f32_32x32x16_bf16 v[40:55], v[12:15], a[88:91], v[40:55]
    v_mfma_f32_32x32x16_bf16 v[56:71], v[8:11], a[232:235], v[56:71]
    v_mfma_f32_32x32x16_bf16 v[72:87], v[12:15], a[232:235], v[72:87]
    ds_read_b64_tr_b16 v[8:9], v1 offset:24576
    ds_read_b64_tr_b16 v[10:11], v1 offset:24832
    ds_read_b64_tr_b16 v[12:13], v2 offset:24576
    ds_read_b64_tr_b16 v[14:15], v2 offset:24832
    s_waitcnt lgkmcnt(4)
    v_mfma_f32_32x32x16_bf16 v[24:39], v[16:19], a[92:95], v[24:39]
    v_mfma_f32_32x32x16_bf16 v[40:55], v[20:23], a[92:95], v[40:55]
    v_mfma_f32_32x32x16_bf16 v[56:71], v[16:19], a[236:239], v[56:71]
    v_mfma_f32_32x32x16_bf16 v[72:87], v[20:23], a[236:239], v[72:87]
    ds_read_b64_tr_b16 v[16:17], v1 offset:25600
    ds_read_b64_tr_b16 v[18:19], v1 offset:25856
    ds_read_b64_tr_b16 v[20:21], v2 offset:25600
    ds_read_b64_tr_b16 v[22:23], v2 offset:25856
    s_waitcnt lgkmcnt(4)
    v_mfma_f32_32x32x16_bf16 v[24:39], v[8:11], a[96:99], v[24:39]
    v_mfma_f32_32x32x16_bf16 v[40:55], v[12:15], a[96:99], v[40:55]
    v_mfma_f32_32x32x16_bf16 v[56:71], v[8:11], a[240:243], v[56:71]
    v_mfma_f32_32x32x16_bf16 v[72:87], v[12:15], a[240:243], v[72:87]
    ds_read_b64_tr_b16 v[8:9], v1 offset:26624
    ds_read_b64_tr_b16 v[10:11], v1 offset:26880
    ds_read_b64_tr_b16 v[12:13], v2 offset:26624
    ds_read_b64_tr_b16 v[14:15], v2 offset:26880
    s_waitcnt lgkmcnt(4)
    v_mfma_f32_32x32x16_bf16 v[24:39], v[16:19], a[100:103], v[24:39]
    v_mfma_f32_32x32x16_bf16 v[40:55], v[20:23], a[100:103], v[40:55]
    v_mfma_f32_32x32x16_bf16 v[56:71], v[16:19], a[244:247], v[56:71]
    v_mfma_f32_32x32x16_bf16 v[72:87], v[20:23], a[244:247], v[72:87]
    ds_read_b64_tr_b16 v[16:17], v1 offset:27648
    ds_read_b64_tr_b16 v[18:19], v1 offset:27904
    ds_read_b64_tr_b16 v[20:21], v2 offset:27648
    ds_read_b64_tr_b16 v[22:23], v2 offset:27904
    s_waitcnt lgkmcnt(4)
    v_mfma_f32_32x32x16_bf16 v[24:39], v[8:11], a[104:107], v[24:39]
    v_mfma_f32_32x32x16_bf16 v[40:55], v[12:15], a[104:107], v[40:55]
    v_mfma_f32_32x32x16_bf16 v[56:71], v[8:11], a[248:251], v[56:71]
    v_mfma_f32_32x32x16_bf16 v[72:87], v[12:15], a[248:251], v[72:87]
    ds_read_b64_tr_b16 v[8:9], v1 offset:28672
    ds_read_b64_tr_b16 v[10:11], v1 offset:28928
    ds_read_b64_tr_b16 v[12:13], v2 offset:28672
    ds_read_b64_tr_b16 v[14:15], v2 offset:28928
    s_waitcnt lgkmcnt(4)
    v_mfma_f32_32x32x16_bf16 v[24:39], v[16:19], a[108:111], v[24:39]
    v_mfma_f32_32x32x16_bf16 v[40:55], v[20:23], a[108:111], v[40:55]
    v_mfma_f32_32x32x16_bf16 v[56:71], v[16:19], a[252:255], v[56:71]
    v_mfma_f32_32x32x16_bf16 v[72:87], v[20:23], a[252:255], v[72:87]
    ds_read_b64_tr_b16 v[16:17], v1 offset:29696
    ds_read_b64_tr_b16 v[18:19], v1 offset:29952
    ds_read_b64_tr_b16 v[20:21], v2 offset:29696
    ds_read_b64_tr_b16 v[22:23], v2 offset:29952
    s_waitcnt lgkmcnt(4)
    v_mfma_f32_32x32x16_bf16 v[24:39], v[8:11], a[112:115], v[24:39]
    v_mfma_f32_32x32x16_bf16 v[40:55], v[12:15], a[112:115], v[40:55]
    v_mfma_f32_32x32x16_bf16 v[56:71], v[8:11], v[224:227], v[56:71]
    v_mfma_f32_32x32x16_bf16 v[72:87], v[12:15], v[224:227], v[72:87]
    ds_read_b64_tr_b16 v[8:9], v1 offset:30720
    ds_read_b64_tr_b16 v[10:11], v1 offset:30976
    ds_read_b64_tr_b16 v[12:13], v2 offset:30720
    ds_read_b64_tr_b16 v[14:15], v2 offset:30976
    s_waitcnt lgkmcnt(4)
    v_mfma_f32_32x32x16_bf16 v[24:39], v[16:19], a[116:119], v[24:39]
    v_mfma_f32_32x32x16_bf16 v[40:55], v[20:23], a[116:119], v[40:55]
    v_mfma_f32_32x32x16_bf16 v[56:71], v[16:19], v[228:231], v[56:71]
    v_mfma_f32_32x32x16_bf16 v[72:87], v[20:23], v[228:231], v[72:87]
    ds_read_b64_tr_b16 v[16:17], v1 offset:31744
    ds_read_b64_tr_b16 v[18:19], v1 offset:32000
    ds_read_b64_tr_b16 v[20:21], v2 offset:31744
    ds_read_b64_tr_b16 v[22:23], v2 offset:32000
    s_waitcnt lgkmcnt(4)
    v_mfma_f32_32x32x16_bf16 v[24:39], v[8:11], a[120:123], v[24:39]
    v_mfma_f32_32x32x16_bf16 v[40:55], v[12:15], a[120:123], v[40:55]
    v_mfma_f32_32x32x16_bf16 v[56:71], v[8:11], v[232:235], v[56:71]
    v_mfma_f32_32x32x16_bf16 v[72:87], v[12:15], v[232:235], v[72:87]
    ds_read_b64_tr_b16 v[8:9], v1 offset:32768
    ds_read_b64_tr_b16 v[10:11], v1 offset:33024
    ds_read_b64_tr_b16 v[12:13], v2 offset:32768
    ds_read_b64_tr_b16 v[14:15], v2 offset:33024
    s_waitcnt lgkmcnt(4)
    v_mfma_f32_32x32x16_bf16 v[24:39], v[16:19], a[124:127], v[24:39]
    v_mfma_f32_32x32x16_bf16 v[40:55], v[20:23], a[124:127], v[40:55]
    v_mfma_f32_32x32x16_bf16 v[56:71], v[16:19], v[236:239], v[56:71]
    v_mfma_f32_32x32x16_bf16 v[72:87], v[20:23], v[236:239], v[72:87]
    ds_read_b64_tr_b16 v[16:17], v1 offset:33792
    ds_read_b64_tr_b16 v[18:19], v1 offset:34048
    ds_read_b64_tr_b16 v[20:21], v2 offset:33792
    ds_read_b64_tr_b16 v[22:23], v2 offset:34048
    s_waitcnt lgkmcnt(4)
    v_mfma_f32_32x32x16_bf16 v[24:39], v[8:11], a[128:131], v[24:39]
    v_mfma_f32_32x32x16_bf16 v[40:55], v[12:15], a[128:131], v[40:55]
    v_mfma_f32_32x32x16_bf16 v[56:71], v[8:11], v[240:243], v[56:71]
    v_mfma_f32_32x32x16_bf16 v[72:87], v[12:15], v[240:243], v[72:87]
    ds_read_b64_tr_b16 v[8:9], v1 offset:34816
    ds_read_b64_tr_b16 v[10:11], v1 offset:35072
    ds_read_b64_tr_b16 v[12:13], v2 offset:34816
    ds_read_b64_tr_b16 v[14:15], v2 offset:35072
    s_waitcnt lgkmcnt(4)
    v_mfma_f32_32x32x16_bf16 v[24:39], v[16:19], a[132:135], v[24:39]
    v_mfma_f32_32x32x16_bf16 v[40:55], v[20:23], a[132:135], v[40:55]
    v_mfma_f32_32x32x16_bf16 v[56:71], v[16:19], v[244:247], v[56:71]
    v_mfma_f32_32x32x16_bf16 v[72:87], v[20:23], v[244:247], v[72:87]
    ds_read_b64_tr_b16 v[16:17], v1 offset:35840
    ds_read_b64_tr_b16 v[18:19], v1 offset:36096
    ds_read_b64_tr_b16 v[20:21], v2 offset:35840
    ds_read_b64_tr_b16 v[22:23], v2 offset:36096
    s_waitcnt lgkmcnt(4)
    v_mfma_f32_32x32x16_bf16 v[24:39], v[8:11], a[136:139], v[24:39]
    v_mfma_f32_32x32x16_bf16 v[40:55], v[12:15], a[136:139], v[40:55]
    v_mfma_f32_32x32x16_bf16 v[56:71], v[8:11], v[248:251], v[56:71]
    v_mfma_f32_32x32x16_bf16 v[72:87], v[12:15], v[248:251], v[72:87]
    s_waitcnt lgkmcnt(0)
    v_mfma_f32_32x32x16_bf16 v[24:39], v[16:19], a[140:143], v[24:39]
    v_mfma_f32_32x32x16_bf16 v[40:55], v[20:23], a[140:143], v[40:55]
    v_mfma_f32_32x32x16_bf16 v[56:71], v[16:19], v[252:255], v[56:71]
    v_mfma_f32_32x32x16_bf16 v[72:87], v[20:23], v[252:255], v[72:87]
    s_nop 8
    v_cvt_pk_bf16_f32 v88, v24, v25
    v_cvt_pk_bf16_f32 v89, v26, v27
    v_cvt_pk_bf16_f32 v90, v28, v29
    v_cvt_pk_bf16_f32 v91, v30, v31
    v_cvt_pk_bf16_f32 v92, v32, v33
    v_cvt_pk_bf16_f32 v93, v34, v35
    v_cvt_pk_bf16_f32 v94, v36, v37
    v_cvt_pk_bf16_f32 v95, v38, v39
    v_permlane32_swap_b32 v88, v90
    v_permlane32_swap_b32 v89, v91
    v_permlane32_swap_b32 v92, v94
    v_permlane32_swap_b32 v93, v95
    v_mov_b32 v7, v4
    global_store_dwordx4 v7, v[88:91], s[20:21] offset:0 sc1
    global_store_dwordx4 v7, v[92:95], s[20:21] offset:512 sc1
    v_cvt_pk_bf16_f32 v104, v40, v41
    v_cvt_pk_bf16_f32 v105, v42, v43
    v_cvt_pk_bf16_f32 v106, v44, v45
    v_cvt_pk_bf16_f32 v107, v46, v47
    v_cvt_pk_bf16_f32 v108, v48, v49
    v_cvt_pk_bf16_f32 v109, v50, v51
    v_cvt_pk_bf16_f32 v110, v52, v53
    v_cvt_pk_bf16_f32 v111, v54, v55
    v_permlane32_swap_b32 v104, v106
    v_permlane32_swap_b32 v105, v107
    v_permlane32_swap_b32 v108, v110
    v_permlane32_swap_b32 v109, v111
    global_store_dwordx4 v7, v[104:107], s[20:21] offset:1024 sc1
    global_store_dwordx4 v7, v[108:111], s[20:21] offset:1536 sc1
    v_cvt_pk_bf16_f32 v88, v56, v57
    v_cvt_pk_bf16_f32 v89, v58, v59
    v_cvt_pk_bf16_f32 v90, v60, v61
    v_cvt_pk_bf16_f32 v91, v62, v63
    v_cvt_pk_bf16_f32 v92, v64, v65
    v_cvt_pk_bf16_f32 v93, v66, v67
    v_cvt_pk_bf16_f32 v94, v68, v69
    v_cvt_pk_bf16_f32 v95, v70, v71
    v_permlane32_swap_b32 v88, v90
    v_permlane32_swap_b32 v89, v91
    v_permlane32_swap_b32 v92, v94
    v_permlane32_swap_b32 v93, v95
    v_add_u32 v7, 262144, v4
    global_store_dwordx4 v7, v[88:91], s[20:21] offset:0 sc1
    global_store_dwordx4 v7, v[92:95], s[20:21] offset:512 sc1
    v_cvt_pk_bf16_f32 v104, v72, v73
    v_cvt_pk_bf16_f32 v105, v74, v75
    v_cvt_pk_bf16_f32 v106, v76, v77
    v_cvt_pk_bf16_f32 v107, v78, v79
    v_cvt_pk_bf16_f32 v108, v80, v81
    v_cvt_pk_bf16_f32 v109, v82, v83
    v_cvt_pk_bf16_f32 v110, v84, v85
    v_cvt_pk_bf16_f32 v111, v86, v87
    v_permlane32_swap_b32 v104, v106
    v_permlane32_swap_b32 v105, v107
    v_permlane32_swap_b32 v108, v110
    v_permlane32_swap_b32 v109, v111
    global_store_dwordx4 v7, v[104:107], s[20:21] offset:1024 sc1
    global_store_dwordx4 v7, v[108:111], s[20:21] offset:1536 sc1
    s_waitcnt vmcnt(8)
    s_branch L_p1e_18
L_p1V_16:
    s_lshl_b32 s22, s22, 12
    s_add_u32 s24, s24, s22
    s_add_u32 s24, s24, 16777216
    s_add_u32 s20, s4, s24
    s_addc_u32 s21, s5, 0
    v_and_b32 v7, 1, v6
    v_lshlrev_b32 v4, 10, v7
    v_bfe_u32 v7, v6, 1, 4
    v_lshl_add_u32 v4, v7, 4, v4
    v_lshrrev_b32 v7, 5, v6
    v_lshl_add_u32 v4, v7, 8, v4
    ds_read_b64_tr_b16 v[8:9], v1 offset:0
    ds_read_b64_tr_b16 v[10:11], v1 offset:256
    ds_read_b64_tr_b16 v[12:13], v2 offset:0
    ds_read_b64_tr_b16 v[14:15], v2 offset:256
    ds_read_b64_tr_b16 v[16:17], v1 offset:1024
    ds_read_b64_tr_b16 v[18:19], v1 offset:1280
    ds_read_b64_tr_b16 v[20:21], v2 offset:1024
    ds_read_b64_tr_b16 v[22:23], v2 offset:1280
    s_waitcnt lgkmcnt(4)
    v_mfma_f32_32x32x16_bf16 v[24:39], a[0:3], v[8:11], 0
    v_mfma_f32_32x32x16_bf16 v[40:55], a[0:3], v[12:15], 0
    s_mov_b32 m0, s40
    s_add_u32 s40, s40, 1024
    global_load_lds_dwordx4 v3, s[16:17]
    v_add_u32 v3, s39, v3
    v_mfma_f32_32x32x16_bf16 v[56:71], a[144:147], v[8:11], 0
    v_mfma_f32_32x32x16_bf16 v[72:87], a[144:147], v[12:15], 0
    ds_read_b64_tr_b16 v[8:9], v1 offset:2048
    ds_read_b64_tr_b16 v[10:11], v1 offset:2304
    ds_read_b64_tr_b16 v[12:13], v2 offset:2048
    ds_read_b64_tr_b16 v[14:15], v2 offset:2304
    s_waitcnt lgkmcnt(4)
    v_mfma_f32_32x32x16_bf16 v[24:39], a[4:7], v[16:19], v[24:39]
    v_mfma_f32_32x32x16_bf16 v[40:55], a[4:7], v[20:23], v[40:55]
    s_mov_b32 m0, s40
    s_add_u32 s40, s40, 1024
    global_load_lds_dwordx4 v3, s[16:17]
    v_add_u32 v3, s39, v3
    v_mfma_f32_32x32x16_bf16 v[56:71], a[148:151], v[16:19], v[56:71]
    v_mfma_f32_32x32x16_bf16 v[72:87], a[148:151], v[20:23], v[72:87]
    ds_read_b64_tr_b16 v[16:17], v1 offset:3072
    ds_read_b64_tr_b16 v[18:19], v1 offset:3328
    ds_read_b64_tr_b16 v[20:21], v2 offset:3072
    ds_read_b64_tr_b16 v[22:23], v2 offset:3328
    s_waitcnt lgkmcnt(4)
    v_mfma_f32_32x32x16_bf16 v[24:39], a[8:11], v[8:11], v[24:39]
    v_mfma_f32_32x32x16_bf16 v[40:55], a[8:11], v[12:15], v[40:55]
    s_mov_b32 m0, s40
    s_add_u32 s40, s40, 1024
    global_load_lds_dwordx4 v3, s[16:17]
    v_add_u32 v3, s39, v3
    v_mfma_f32_32x32x16_bf16 v[56:71], a[152:155], v[8:11], v[56:71]
    v_mfma_f32_32x32x16_bf16 v[72:87], a[152:155], v[12:15], v[72:87]
    ds_read_b64_tr_b16 v[8:9], v1 offset:4096
    ds_read_b64_tr_b16 v[10:11], v1 offset:4352
    ds_read_b64_tr_b16 v[12:13], v2 offset:4096
    ds_read_b64_tr_b16 v[14:15], v2 offset:4352
    s_waitcnt lgkmcnt(4)
    v_mfma_f32_32x32x16_bf16 v[24:39], a[12:15], v[16:19], v[24:39]
    v_mfma_f32_32x32x16_bf16 v[40:55], a[12:15], v[20:23], v[40:55]
    s_mov_b32 m0, s40
    s_add_u32 s40, s40, 1024
    global_load_lds_dwordx4 v3, s[16:17]
    v_add_u32 v3, s39, v3
    v_mfma_f32_32x32x16_bf16 v[56:71], a[156:159], v[16:19], v[56:71]
    v_mfma_f32_32x32x16_bf16 v[72:87], a[156:159], v[20:23], v[72:87]
    ds_read_b64_tr_b16 v[16:17], v1 offset:5120
    ds_read_b64_tr_b16 v[18:19], v1 offset:5376
    ds_read_b64_tr_b16 v[20:21], v2 offset:5120
    ds_read_b64_tr_b16 v[22:23], v2 offset:5376
    s_waitcnt lgkmcnt(4)
    v_mfma_f32_32x32x16_bf16 v[24:39], a[16:19], v[8:11], v[24:39]
    v_mfma_f32_32x32x16_bf16 v[40:55], a[16:19], v[12:15], v[40:55]
    s_mov_b32 m0, s40
    s_add_u32 s40, s40, 1024
    global_load_lds_dwordx4 v3, s[16:17]
    v_add_u32 v3, s39, v3
    v_mfma_f32_32x32x16_bf16 v[56:71], a[160:163], v[8:11], v[56:71]
    v_mfma_f32_32x32x16_bf16 v[72:87], a[160:163], v[12:15], v[72:87]
    ds_read_b64_tr_b16 v[8:9], v1 offset:6144
    ds_read_b64_tr_b16 v[10:11], v1 offset:6400
    ds_read_b64_tr_b16 v[12:13], v2 offset:6144
    ds_read_b64_tr_b16 v[14:15], v2 offset:6400
    s_waitcnt lgkmcnt(4)
    v_mfma_f32_32x32x16_bf16 v[24:39], a[20:23], v[16:19], v[24:39]
    v_mfma_f32_32x32x16_bf16 v[40:55], a[20:23], v[20:23], v[40:55]
    s_mov_b32 m0, s40
    s_add_u32 s40, s40, 1024
    global_load_lds_dwordx4 v3, s[16:17]
    v_add_u32 v3, s39, v3
    v_mfma_f32_32x32x16_bf16 v[56:71], a[164:167], v[16:19], v[56:71]
    v_mfma_f32_32x32x16_bf16 v[72:87], a[164:167], v[20:23], v[72:87]
    ds_read_b64_tr_b16 v[16:17], v1 offset:7168
    ds_read_b64_tr_b16 v[18:19], v1 offset:7424
    ds_read_b64_tr_b16 v[20:21], v2 offset:7168
    ds_read_b64_tr_b16 v[22:23], v2 offset:7424
    s_waitcnt lgkmcnt(4)
    v_mfma_f32_32x32x16_bf16 v[24:39], a[24:27], v[8:11], v[24:39]
    v_mfma_f32_32x32x16_bf16 v[40:55], a[24:27], v[12:15], v[40:55]
    s_mov_b32 m0, s40
    s_add_u32 s40, s40, 1024
    global_load_lds_dwordx4 v3, s[16:17]
    v_add_u32 v3, s39, v3
    v_mfma_f32_32x32x16_bf16 v[56:71], a[168:171], v[8:11], v[56:71]
    v_mfma_f32_32x32x16_bf16 v[72:87], a[168:171], v[12:15], v[72:87]
    ds_read_b64_tr_b16 v[8:9], v1 offset:8192
    ds_read_b64_tr_b16 v[10:11], v1 offset:8448
    ds_read_b64_tr_b16 v[12:13], v2 offset:8192
    ds_read_b64_tr_b16 v[14:15], v2 offset:8448
    s_waitcnt lgkmcnt(4)
    v_mfma_f32_32x32x16_bf16 v[24:39], a[28:31], v[16:19], v[24:39]
    v_mfma_f32_32x32x16_bf16 v[40:55], a[28:31], v[20:23], v[40:55]
    s_mov_b32 m0, s40
    s_add_u32 s40, s40, 1024
    global_load_lds_dwordx4 v3, s[16:17]
    v_add_u32 v3, s39, v3
    v_mfma_f32_32x32x16_bf16 v[56:71], a[172:175], v[16:19], v[56:71]
    v_mfma_f32_32x32x16_bf16 v[72:87], a[172:175], v[20:23], v[72:87]
    ds_read_b64_tr_b16 v[16:17], v1 offset:9216
    ds_read_b64_tr_b16 v[18:19], v1 offset:9472
    ds_read_b64_tr_b16 v[20:21], v2 offset:9216
    ds_read_b64_tr_b16 v[22:23], v2 offset:9472
    s_waitcnt lgkmcnt(4)
    v_mfma_f32_32x32x16_bf16 v[24:39], a[32:35], v[8:11], v[24:39]
    v_mfma_f32_32x32x16_bf16 v[40:55], a[32:35], v[12:15], v[40:55]
    s_mov_b32 m0, s40
    s_add_u32 s40, s40, 1024
    global_load_lds_dwordx4 v3, s[16:17]
    v_add_u32 v3, s39, v3
    v_mfma_f32_32x32x16_bf16 v[56:71], a[176:179], v[8:11], v[56:71]
    v_mfma_f32_32x32x16_bf16 v[72:87], a[176:179], v[12:15], v[72:87]
    ds_read_b64_tr_b16 v[8:9], v1 offset:10240
    ds_read_b64_tr_b16 v[10:11], v1 offset:10496
    ds_read_b64_tr_b16 v[12:13], v2 offset:10240
    ds_read_b64_tr_b16 v[14:15], v2 offset:10496
    s_waitcnt lgkmcnt(4)
    v_mfma_f32_32x32x16_bf16 v[24:39], a[36:39], v[16:19], v[24:39]
    v_mfma_f32_32x32x16_bf16 v[40:55], a[36:39], v[20:23], v[40:55]
    s_mov_b32 m0, s40
    s_add_u32 s40, s40, 1024
    global_load_lds_dwordx4 v3, s[16:17]
    v_add_u32 v3, s39, v3
    v_mfma_f32_32x32x16_bf16 v[56:71], a[180:183], v[16:19], v[56:71]
    v_mfma_f32_32x32x16_bf16 v[72:87], a[180:183], v[20:23], v[72:87]
    ds_read_b64_tr_b16 v[16:17], v1 offset:11264
    ds_read_b64_tr_b16 v[18:19], v1 offset:11520
    ds_read_b64_tr_b16 v[20:21], v2 offset:11264
    ds_read_b64_tr_b16 v[22:23], v2 offset:11520
    s_waitcnt lgkmcnt(4)
    v_mfma_f32_32x32x16_bf16 v[24:39], a[40:43], v[8:11], v[24:39]
    v_mfma_f32_32x32x16_bf16 v[40:55], a[40:43], v[12:15], v[40:55]
    s_mov_b32 m0, s40
    s_add_u32 s40, s40, 1024
    global_load_lds_dwordx4 v3, s[16:17]
    v_add_u32 v3, s39, v3
    v_mfma_f32_32x32x16_bf16 v[56:71], a[184:187], v[8:11], v[56:71]
    v_mfma_f32_32x32x16_bf16 v[72:87], a[184:187], v[12:15], v[72:87]
    ds_read_b64_tr_b16 v[8:9], v1 offset:12288
    ds_read_b64_tr_b16 v[10:11], v1 offset:12544
    ds_read_b64_tr_b16 v[12:13], v2 offset:12288
    ds_read_b64_tr_b16 v[14:15], v2 offset:12544
    s_waitcnt lgkmcnt(4)
    v_mfma_f32_32x32x16_bf16 v[24:39], a[44:47], v[16:19], v[24:39]
    v_mfma_f32_32x32x16_bf16 v[40:55], a[44:47], v[20:23], v[40:55]
    s_mov_b32 m0, s40
    s_add_u32 s40, s40, 1024
    global_load_lds_dwordx4 v3, s[16:17]
    v_add_u32 v3, s39, v3
    v_mfma_f32_32x32x16_bf16 v[56:71], a[188:191], v[16:19], v[56:71]
    v_mfma_f32_32x32x16_bf16 v[72:87], a[188:191], v[20:23], v[72:87]
    ds_read_b64_tr_b16 v[16:17], v1 offset:13312
    ds_read_b64_tr_b16 v[18:19], v1 offset:13568
    ds_read_b64_tr_b16 v[20:21], v2 offset:13312
    ds_read_b64_tr_b16 v[22:23], v2 offset:13568
    s_waitcnt lgkmcnt(4)
    v_mfma_f32_32x32x16_bf16 v[24:39], a[48:51], v[8:11], v[24:39]
    v_mfma_f32_32x32x16_bf16 v[40:55], a[48:51], v[12:15], v[40:55]
    s_mov_b32 m0, s40
    s_add_u32 s40, s40, 1024
    global_load_lds_dwordx4 v3, s[16:17]
    v_add_u32 v3, s39, v3
    v_mfma_f32_32x32x16_bf16 v[56:71], a[192:195], v[8:11], v[56:71]
    v_mfma_f32_32x32x16_bf16 v[72:87], a[192:195], v[12:15], v[72:87]
    ds_read_b64_tr_b16 v[8:9], v1 offset:14336
    ds_read_b64_tr_b16 v[10:11], v1 offset:14592
    ds_read_b64_tr_b16 v[12:13], v2 offset:14336
    ds_read_b64_tr_b16 v[14:15], v2 offset:14592
    s_waitcnt lgkmcnt(4)
    v_mfma_f32_32x32x16_bf16 v[24:39], a[52:55], v[16:19], v[24:39]
    v_mfma_f32_32x32x16_bf16 v[40:55], a[52:55], v[20:23], v[40:55]
    s_mov_b32 m0, s40
    s_add_u32 s40, s40, 1024
    global_load_lds_dwordx4 v3, s[16:17]
    v_add_u32 v3, s39, v3
    v_mfma_f32_32x32x16_bf16 v[56:71], a[196:199], v[16:19], v[56:71]
    v_mfma_f32_32x32x16_bf16 v[72:87], a[196:199], v[20:23], v[72:87]
    ds_read_b64_tr_b16 v[16:17], v1 offset:15360
    ds_read_b64_tr_b16 v[18:19], v1 offset:15616
    ds_read_b64_tr_b16 v[20:21], v2 offset:15360
    ds_read_b64_tr_b16 v[22:23], v2 offset:15616
    s_waitcnt lgkmcnt(4)
    v_mfma_f32_32x32x16_bf16 v[24:39], a[56:59], v[8:11], v[24:39]
    v_mfma_f32_32x32x16_bf16 v[40:55], a[56:59], v[12:15], v[40:55]
    s_mov_b32 m0, s40
    s_add_u32 s40, s40, 1024
    global_load_lds_dwordx4 v3, s[16:17]
    v_add_u32 v3, s39, v3
    v_mfma_f32_32x32x16_bf16 v[56:71], a[200:203], v[8:11], v[56:71]
    v_mfma_f32_32x32x16_bf16 v[72:87], a[200:203], v[12:15], v[72:87]
    ds_read_b64_tr_b16 v[8:9], v1 offset:16384
    ds_read_b64_tr_b16 v[10:11], v1 offset:16640
    ds_read_b64_tr_b16 v[12:13], v2 offset:16384
    ds_read_b64_tr_b16 v[14:15], v2 offset:16640
    s_waitcnt lgkmcnt(4)
    v_mfma_f32_32x32x16_bf16 v[24:39], a[60:63], v[16:19], v[24:39]
    v_mfma_f32_32x32x16_bf16 v[40:55], a[60:63], v[20:23], v[40:55]
    s_mov_b32 m0, s40
    s_add_u32 s40, s40, 1024
    global_load_lds_dwordx4 v3, s[16:17]
    v_add_u32 v3, s39, v3
    v_mfma_f32_32x32x16_bf16 v[56:71], a[204:207], v[16:19], v[56:71]
    v_mfma_f32_32x32x16_bf16 v[72:87], a[204:207], v[20:23], v[72:87]
    ds_read_b64_tr_b16 v[16:17], v1 offset:17408
    ds_read_b64_tr_b16 v[18:19], v1 offset:17664
    ds_read_b64_tr_b16 v[20:21], v2 offset:17408
    ds_read_b64_tr_b16 v[22:23], v2 offset:17664
    s_waitcnt lgkmcnt(4)
    v_mfma_f32_32x32x16_bf16 v[24:39], a[64:67], v[8:11], v[24:39]
    v_mfma_f32_32x32x16_bf16 v[40:55], a[64:67], v[12:15], v[40:55]
    s_mov_b32 m0, s40
    s_add_u32 s40, s40, 1024
    global_load_lds_dwordx4 v3, s[16:17]
    v_add_u32 v3, s39, v3
    v_mfma_f32_32x32x16_bf16 v[56:71], a[208:211], v[8:11], v[56:71]
    v_mfma_f32_32x32x16_bf16 v[72:87], a[208:211], v[12:15], v[72:87]
    ds_read_b64_tr_b16 v[8:9], v1 offset:18432
    ds_read_b64_tr_b16 v[10:11], v1 offset:18688
    ds_read_b64_tr_b16 v[12:13], v2 offset:18432
    ds_read_b64_tr_b16 v[14:15], v2 offset:18688
    s_waitcnt lgkmcnt(4)
    v_mfma_f32_32x32x16_bf16 v[24:39], a[68:71], v[16:19], v[24:39]
    v_mfma_f32_32x32x16_bf16 v[40:55], a[68:71], v[20:23], v[40:55]
    s_mov_b32 m0, s40
    s_add_u32 s40, s40, 1024
    global_load_lds_dwordx4 v3, s[16:17]
    v_add_u32 v3, s39, v3
    v_mfma_f32_32x32x16_bf16 v[56:71], a[212:215], v[16:19], v[56:71]
    v_mfma_f32_32x32x16_bf16 v[72:87], a[212:215], v[20:23], v[72:87]
    ds_read_b64_tr_b16 v[16:17], v1 offset:19456
    ds_read_b64_tr_b16 v[18:19], v1 offset:19712
    ds_read_b64_tr_b16 v[20:21], v2 offset:19456
    ds_read_b64_tr_b16 v[22:23], v2 offset:19712
    s_waitcnt lgkmcnt(4)
    v_mfma_f32_32x32x16_bf16 v[24:39], a[72:75], v[8:11], v[24:39]
    v_mfma_f32_32x32x16_bf16 v[40:55], a[72:75], v[12:15], v[40:55]
    v_mfma_f32_32x32x16_bf16 v[56:71], a[216:219], v[8:11], v[56:71]
    v_mfma_f32_32x32x16_bf16 v[72:87], a[216:219], v[12:15], v[72:87]
    ds_read_b64_tr_b16 v[8:9], v1 offset:20480
    ds_read_b64_tr_b16 v[10:11], v1 offset:20736
    ds_read_b64_tr_b16 v[12:13], v2 offset:20480
    ds_read_b64_tr_b16 v[14:15], v2 offset:20736
    s_waitcnt lgkmcnt(4)
    v_mfma_f32_32x32x16_bf16 v[24:39], a[76:79], v[16:19], v[24:39]
    v_mfma_f32_32x32x16_bf16 v[40:55], a[76:79], v[20:23], v[40:55]
    v_mfma_f32_32x32x16_bf16 v[56:71], a[220:223], v[16:19], v[56:71]
    v_mfma_f32_32x32x16_bf16 v[72:87], a[220:223], v[20:23], v[72:87]
    ds_read_b64_tr_b16 v[16:17], v1 offset:21504
    ds_read_b64_tr_b16 v[18:19], v1 offset:21760
    ds_read_b64_tr_b16 v[20:21], v2 offset:21504
    ds_read_b64_tr_b16 v[22:23], v2 offset:21760
    s_waitcnt lgkmcnt(4)
    v_mfma_f32_32x32x16_bf16 v[24:39], a[80:83], v[8:11], v[24:39]
    v_mfma_f32_32x32x16_bf16 v[40:55], a[80:83], v[12:15], v[40:55]
    v_mfma_f32_32x32x16_bf16 v[56:71], a[224:227], v[8:11], v[56:71]
    v_mfma_f32_32x32x16_bf16 v[72:87], a[224:227], v[12:15], v[72:87]
    ds_read_b64_tr_b16 v[8:9], v1 offset:22528
    ds_read_b64_tr_b16 v[10:11], v1 offset:22784
    ds_read_b64_tr_b16 v[12:13], v2 offset:22528
    ds_read_b64_tr_b16 v[14:15], v2 offset:22784
    s_waitcnt lgkmcnt(4)
    v_mfma_f32_32x32x16_bf16 v[24:39], a[84:87], v[16:19], v[24:39]
    v_mfma_f32_32x32x16_bf16 v[40:55], a[84:87], v[20:23], v[40:55]
    v_mfma_f32_32x32x16_bf16 v[56:71], a[228:231], v[16:19], v[56:71]
    v_mfma_f32_32x32x16_bf16 v[72:87], a[228:231], v[20:23], v[72:87]
    ds_read_b64_tr_b16 v[16:17], v1 offset:23552
    ds_read_b64_tr_b16 v[18:19], v1 offset:23808
    ds_read_b64_tr_b16 v[20:21], v2 offset:23552
    ds_read_b64_tr_b16 v[22:23], v2 offset:23808
    s_waitcnt lgkmcnt(4)
    v_mfma_f32_32x32x16_bf16 v[24:39], a[88:91], v[8:11], v[24:39]
    v_mfma_f32_32x32x16_bf16 v[40:55], a[88:91], v[12:15], v[40:55]
    v_mfma_f32_32x32x16_bf16 v[56:71], a[232:235], v[8:11], v[56:71]
    v_mfma_f32_32x32x16_bf16 v[72:87], a[232:235], v[12:15], v[72:87]
    ds_read_b64_tr_b16 v[8:9], v1 offset:24576
    ds_read_b64_tr_b16 v[10:11], v1 offset:24832
    ds_read_b64_tr_b16 v[12:13], v2 offset:24576
    ds_read_b64_tr_b16 v[14:15], v2 offset:24832
    s_waitcnt lgkmcnt(4)
    v_mfma_f32_32x32x16_bf16 v[24:39], a[92:95], v[16:19], v[24:39]
    v_mfma_f32_32x32x16_bf16 v[40:55], a[92:95], v[20:23], v[40:55]
    v_mfma_f32_32x32x16_bf16 v[56:71], a[236:239], v[16:19], v[56:71]
    v_mfma_f32_32x32x16_bf16 v[72:87], a[236:239], v[20:23], v[72:87]
    ds_read_b64_tr_b16 v[16:17], v1 offset:25600
    ds_read_b64_tr_b16 v[18:19], v1 offset:25856
    ds_read_b64_tr_b16 v[20:21], v2 offset:25600
    ds_read_b64_tr_b16 v[22:23], v2 offset:25856
    s_waitcnt lgkmcnt(4)
    v_mfma_f32_32x32x16_bf16 v[24:39], a[96:99], v[8:11], v[24:39]
    v_mfma_f32_32x32x16_bf16 v[40:55], a[96:99], v[12:15], v[40:55]
    v_mfma_f32_32x32x16_bf16 v[56:71], a[240:243], v[8:11], v[56:71]
    v_mfma_f32_32x32x16_bf16 v[72:87], a[240:243], v[12:15], v[72:87]
    ds_read_b64_tr_b16 v[8:9], v1 offset:26624
    ds_read_b64_tr_b16 v[10:11], v1 offset:26880
    ds_read_b64_tr_b16 v[12:13], v2 offset:26624
    ds_read_b64_tr_b16 v[14:15], v2 offset:26880
    s_waitcnt lgkmcnt(4)
    v_mfma_f32_32x32x16_bf16 v[24:39], a[100:103], v[16:19], v[24:39]
    v_mfma_f32_32x32x16_bf16 v[40:55], a[100:103], v[20:23], v[40:55]
    v_mfma_f32_32x32x16_bf16 v[56:71], a[244:247], v[16:19], v[56:71]
    v_mfma_f32_32x32x16_bf16 v[72:87], a[244:247], v[20:23], v[72:87]
    ds_read_b64_tr_b16 v[16:17], v1 offset:27648
    ds_read_b64_tr_b16 v[18:19], v1 offset:27904
    ds_read_b64_tr_b16 v[20:21], v2 offset:27648
    ds_read_b64_tr_b16 v[22:23], v2 offset:27904
    s_waitcnt lgkmcnt(4)
    v_mfma_f32_32x32x16_bf16 v[24:39], a[104:107], v[8:11], v[24:39]
    v_mfma_f32_32x32x16_bf16 v[40:55], a[104:107], v[12:15], v[40:55]
    v_mfma_f32_32x32x16_bf16 v[56:71], a[248:251], v[8:11], v[56:71]
    v_mfma_f32_32x32x16_bf16 v[72:87], a[248:251], v[12:15], v[72:87]
    ds_read_b64_tr_b16 v[8:9], v1 offset:28672
    ds_read_b64_tr_b16 v[10:11], v1 offset:28928
    ds_read_b64_tr_b16 v[12:13], v2 offset:28672
    ds_read_b64_tr_b16 v[14:15], v2 offset:28928
    s_waitcnt lgkmcnt(4)
    v_mfma_f32_32x32x16_bf16 v[24:39], a[108:111], v[16:19], v[24:39]
    v_mfma_f32_32x32x16_bf16 v[40:55], a[108:111], v[20:23], v[40:55]
    v_mfma_f32_32x32x16_bf16 v[56:71], a[252:255], v[16:19], v[56:71]
    v_mfma_f32_32x32x16_bf16 v[72:87], a[252:255], v[20:23], v[72:87]
    ds_read_b64_tr_b16 v[16:17], v1 offset:29696
    ds_read_b64_tr_b16 v[18:19], v1 offset:29952
    ds_read_b64_tr_b16 v[20:21], v2 offset:29696
    ds_read_b64_tr_b16 v[22:23], v2 offset:29952
    s_waitcnt lgkmcnt(4)
    v_mfma_f32_32x32x16_bf16 v[24:39], a[112:115], v[8:11], v[24:39]
    v_mfma_f32_32x32x16_bf16 v[40:55], a[112:115], v[12:15], v[40:55]
    v_mfma_f32_32x32x16_bf16 v[56:71], v[224:227], v[8:11], v[56:71]
    v_mfma_f32_32x32x16_bf16 v[72:87], v[224:227], v[12:15], v[72:87]
    ds_read_b64_tr_b16 v[8:9], v1 offset:30720
    ds_read_b64_tr_b16 v[10:11], v1 offset:30976
    ds_read_b64_tr_b16 v[12:13], v2 offset:30720
    ds_read_b64_tr_b16 v[14:15], v2 offset:30976
    s_waitcnt lgkmcnt(4)
    v_mfma_f32_32x32x16_bf16 v[24:39], a[116:119], v[16:19], v[24:39]
    v_mfma_f32_32x32x16_bf16 v[40:55], a[116:119], v[20:23], v[40:55]
    v_mfma_f32_32x32x16_bf16 v[56:71], v[228:231], v[16:19], v[56:71]
    v_mfma_f32_32x32x16_bf16 v[72:87], v[228:231], v[20:23], v[72:87]
    ds_read_b64_tr_b16 v[16:17], v1 offset:31744
    ds_read_b64_tr_b16 v[18:19], v1 offset:32000
    ds_read_b64_tr_b16 v[20:21], v2 offset:31744
    ds_read_b64_tr_b16 v[22:23], v2 offset:32000
    s_waitcnt lgkmcnt(4)
    v_mfma_f32_32x32x16_bf16 v[24:39], a[120:123], v[8:11], v[24:39]
    v_mfma_f32_32x32x16_bf16 v[40:55], a[120:123], v[12:15], v[40:55]
    v_mfma_f32_32x32x16_bf16 v[56:71], v[232:235], v[8:11], v[56:71]
    v_mfma_f32_32x32x16_bf16 v[72:87], v[232:235], v[12:15], v[72:87]
    ds_read_b64_tr_b16 v[8:9], v1 offset:32768
    ds_read_b64_tr_b16 v[10:11], v1 offset:33024
    ds_read_b64_tr_b16 v[12:13], v2 offset:32768
    ds_read_b64_tr_b16 v[14:15], v2 offset:33024
    s_waitcnt lgkmcnt(4)
    v_mfma_f32_32x32x16_bf16 v[24:39], a[124:127], v[16:19], v[24:39]
    v_mfma_f32_32x32x16_bf16 v[40:55], a[124:127], v[20:23], v[40:55]
    v_mfma_f32_32x32x16_bf16 v[56:71], v[236:239], v[16:19], v[56:71]
    v_mfma_f32_32x32x16_bf16 v[72:87], v[236:239], v[20:23], v[72:87]
    ds_read_b64_tr_b16 v[16:17], v1 offset:33792
    ds_read_b64_tr_b16 v[18:19], v1 offset:34048
    ds_read_b64_tr_b16 v[20:21], v2 offset:33792
    ds_read_b64_tr_b16 v[22:23], v2 offset:34048
    s_waitcnt lgkmcnt(4)
    v_mfma_f32_32x32x16_bf16 v[24:39], a[128:131], v[8:11], v[24:39]
    v_mfma_f32_32x32x16_bf16 v[40:55], a[128:131], v[12:15], v[40:55]
    v_mfma_f32_32x32x16_bf16 v[56:71], v[240:243], v[8:11], v[56:71]
    v_mfma_f32_32x32x16_bf16 v[72:87], v[240:243], v[12:15], v[72:87]
    ds_read_b64_tr_b16 v[8:9], v1 offset:34816
    ds_read_b64_tr_b16 v[10:11], v1 offset:35072
    ds_read_b64_tr_b16 v[12:13], v2 offset:34816
    ds_read_b64_tr_b16 v[14:15], v2 offset:35072
    s_waitcnt lgkmcnt(4)
    v_mfma_f32_32x32x16_bf16 v[24:39], a[132:135], v[16:19], v[24:39]
    v_mfma_f32_32x32x16_bf16 v[40:55], a[132:135], v[20:23], v[40:55]
    v_mfma_f32_32x32x16_bf16 v[56:71], v[244:247], v[16:19], v[56:71]
    v_mfma_f32_32x32x16_bf16 v[72:87], v[244:247], v[20:23], v[72:87]
    ds_read_b64_tr_b16 v[16:17], v1 offset:35840
    ds_read_b64_tr_b16 v[18:19], v1 offset:36096
    ds_read_b64_tr_b16 v[20:21], v2 offset:35840
    ds_read_b64_tr_b16 v[22:23], v2 offset:36096
    s_waitcnt lgkmcnt(4)
    v_mfma_f32_32x32x16_bf16 v[24:39], a[136:139], v[8:11], v[24:39]
    v_mfma_f32_32x32x16_bf16 v[40:55], a[136:139], v[12:15], v[40:55]
    v_mfma_f32_32x32x16_bf16 v[56:71], v[248:251], v[8:11], v[56:71]
    v_mfma_f32_32x32x16_bf16 v[72:87], v[248:251], v[12:15], v[72:87]
    s_waitcnt lgkmcnt(0)
    v_mfma_f32_32x32x16_bf16 v[24:39], a[140:143], v[16:19], v[24:39]
    v_mfma_f32_32x32x16_bf16 v[40:55], a[140:143], v[20:23], v[40:55]
    v_mfma_f32_32x32x16_bf16 v[56:71], v[252:255], v[16:19], v[56:71]
    v_mfma_f32_32x32x16_bf16 v[72:87], v[252:255], v[20:23], v[72:87]
    s_nop 8
    v_cvt_pk_bf16_f32 v88, v24, v25
    v_cvt_pk_bf16_f32 v89, v26, v27
    v_cvt_pk_bf16_f32 v90, v32, v33
    v_cvt_pk_bf16_f32 v91, v34, v35
    v_cvt_pk_bf16_f32 v92, v28, v29
    v_cvt_pk_bf16_f32 v93, v30, v31
    v_cvt_pk_bf16_f32 v94, v36, v37
    v_cvt_pk_bf16_f32 v95, v38, v39
    v_mov_b32 v7, v4
    global_store_dwordx4 v7, v[88:91], s[20:21] offset:0 sc1
    global_store_dwordx4 v7, v[92:95], s[20:21] offset:512 sc1
    v_cvt_pk_bf16_f32 v104, v40, v41
    v_cvt_pk_bf16_f32 v105, v42, v43
    v_cvt_pk_bf16_f32 v106, v48, v49
    v_cvt_pk_bf16_f32 v107, v50, v51
    v_cvt_pk_bf16_f32 v108, v44, v45
    v_cvt_pk_bf16_f32 v109, v46, v47
    v_cvt_pk_bf16_f32 v110, v52, v53
    v_cvt_pk_bf16_f32 v111, v54, v55
    global_store_dwordx4 v7, v[104:107], s[20:21] offset:2048 sc1
    global_store_dwordx4 v7, v[108:111], s[20:21] offset:2560 sc1
    v_cvt_pk_bf16_f32 v88, v56, v57
    v_cvt_pk_bf16_f32 v89, v58, v59
    v_cvt_pk_bf16_f32 v90, v64, v65
    v_cvt_pk_bf16_f32 v91, v66, v67
    v_cvt_pk_bf16_f32 v92, v60, v61
    v_cvt_pk_bf16_f32 v93, v62, v63
    v_cvt_pk_bf16_f32 v94, v68, v69
    v_cvt_pk_bf16_f32 v95, v70, v71
    v_add_u32 v7, 262144, v4
    global_store_dwordx4 v7, v[88:91], s[20:21] offset:0 sc1
    global_store_dwordx4 v7, v[92:95], s[20:21] offset:512 sc1
    v_cvt_pk_bf16_f32 v104, v72, v73
    v_cvt_pk_bf16_f32 v105, v74, v75
    v_cvt_pk_bf16_f32 v106, v80, v81
    v_cvt_pk_bf16_f32 v107, v82, v83
    v_cvt_pk_bf16_f32 v108, v76, v77
    v_cvt_pk_bf16_f32 v109, v78, v79
    v_cvt_pk_bf16_f32 v110, v84, v85
    v_cvt_pk_bf16_f32 v111, v86, v87
    global_store_dwordx4 v7, v[104:107], s[20:21] offset:2048 sc1
    global_store_dwordx4 v7, v[108:111], s[20:21] offset:2560 sc1
    s_waitcnt vmcnt(8)
    s_branch L_p1e_18
L_p1H_17:
    s_lshl_b32 s24, s10, 3
    s_lshl_b32 s25, s8, 1
    s_add_u32 s24, s24, s25
    s_mul_i32 s24, s24, 288
    s_lshl_b32 s23, s60, 1
    s_add_u32 s24, s24, s23
    s_lshl_b32 s24, s24, 10
    s_add_u32 s24, s24, 67108864
    s_add_u32 s20, s4, s24
    s_addc_u32 s21, s5, 0
    v_lshlrev_b32 v4, 4, v6
    ds_read_b64_tr_b16 v[8:9], v1 offset:0
    ds_read_b64_tr_b16 v[10:11], v1 offset:256
    ds_read_b64_tr_b16 v[12:13], v2 offset:0
    ds_read_b64_tr_b16 v[14:15], v2 offset:256
    ds_read_b64_tr_b16 v[16:17], v1 offset:1024
    ds_read_b64_tr_b16 v[18:19], v1 offset:1280
    ds_read_b64_tr_b16 v[20:21], v2 offset:1024
    ds_read_b64_tr_b16 v[22:23], v2 offset:1280
    s_waitcnt lgkmcnt(4)
    v_mfma_f32_32x32x16_bf16 v[24:39], v[8:11], a[0:3], 0
    v_mfma_f32_32x32x16_bf16 v[40:55], v[12:15], a[0:3], 0
    s_mov_b32 m0, s40
    s_add_u32 s40, s40, 1024
    global_load_lds_dwordx4 v3, s[16:17]
    v_add_u32 v3, s39, v3
    v_mfma_f32_32x32x16_bf16 v[56:71], v[8:11], a[144:147], 0
    v_mfma_f32_32x32x16_bf16 v[72:87], v[12:15], a[144:147], 0
    ds_read_b64_tr_b16 v[8:9], v1 offset:2048
    ds_read_b64_tr_b16 v[10:11], v1 offset:2304
    ds_read_b64_tr_b16 v[12:13], v2 offset:2048
    ds_read_b64_tr_b16 v[14:15], v2 offset:2304
    s_waitcnt lgkmcnt(4)
    v_mfma_f32_32x32x16_bf16 v[24:39], v[16:19], a[4:7], v[24:39]
    v_mfma_f32_32x32x16_bf16 v[40:55], v[20:23], a[4:7], v[40:55]
    s_mov_b32 m0, s40
    s_add_u32 s40, s40, 1024
    global_load_lds_dwordx4 v3, s[16:17]
    v_add_u32 v3, s39, v3
    v_mfma_f32_32x32x16_bf16 v[56:71], v[16:19], a[148:151], v[56:71]
    v_mfma_f32_32x32x16_bf16 v[72:87], v[20:23], a[148:151], v[72:87]
    ds_read_b64_tr_b16 v[16:17], v1 offset:3072
    ds_read_b64_tr_b16 v[18:19], v1 offset:3328
    ds_read_b64_tr_b16 v[20:21], v2 offset:3072
    ds_read_b64_tr_b16 v[22:23], v2 offset:3328
    s_waitcnt lgkmcnt(4)
    v_mfma_f32_32x32x16_bf16 v[24:39], v[8:11], a[8:11], v[24:39]
    v_mfma_f32_32x32x16_bf16 v[40:55], v[12:15], a[8:11], v[40:55]
    s_mov_b32 m0, s40
    s_add_u32 s40, s40, 1024
    global_load_lds_dwordx4 v3, s[16:17]
    v_add_u32 v3, s39, v3
    v_mfma_f32_32x32x16_bf16 v[56:71], v[8:11], a[152:155], v[56:71]
    v_mfma_f32_32x32x16_bf16 v[72:87], v[12:15], a[152:155], v[72:87]
    ds_read_b64_tr_b16 v[8:9], v1 offset:4096
    ds_read_b64_tr_b16 v[10:11], v1 offset:4352
    ds_read_b64_tr_b16 v[12:13], v2 offset:4096
    ds_read_b64_tr_b16 v[14:15], v2 offset:4352
    s_waitcnt lgkmcnt(4)
    v_mfma_f32_32x32x16_bf16 v[24:39], v[16:19], a[12:15], v[24:39]
    v_mfma_f32_32x32x16_bf16 v[40:55], v[20:23], a[12:15], v[40:55]
    s_mov_b32 m0, s40
    s_add_u32 s40, s40, 1024
    global_load_lds_dwordx4 v3, s[16:17]
    v_add_u32 v3, s39, v3
    v_mfma_f32_32x32x16_bf16 v[56:71], v[16:19], a[156:159], v[56:71]
    v_mfma_f32_32x32x16_bf16 v[72:87], v[20:23], a[156:159], v[72:87]
    ds_read_b64_tr_b16 v[16:17], v1 offset:5120
    ds_read_b64_tr_b16 v[18:19], v1 offset:5376
    ds_read_b64_tr_b16 v[20:21], v2 offset:5120
    ds_read_b64_tr_b16 v[22:23], v2 offset:5376
    s_waitcnt lgkmcnt(4)
    v_mfma_f32_32x32x16_bf16 v[24:39], v[8:11], a[16:19], v[24:39]
    v_mfma_f32_32x32x16_bf16 v[40:55], v[12:15], a[16:19], v[40:55]
    s_mov_b32 m0, s40
    s_add_u32 s40, s40, 1024
    global_load_lds_dwordx4 v3, s[16:17]
    v_add_u32 v3, s39, v3
    v_mfma_f32_32x32x16_bf16 v[56:71], v[8:11], a[160:163], v[56:71]
    v_mfma_f32_32x32x16_bf16 v[72:87], v[12:15], a[160:163], v[72:87]
    ds_read_b64_tr_b16 v[8:9], v1 offset:6144
    ds_read_b64_tr_b16 v[10:11], v1 offset:6400
    ds_read_b64_tr_b16 v[12:13], v2 offset:6144
    ds_read_b64_tr_b16 v[14:15], v2 offset:6400
    s_waitcnt lgkmcnt(4)
    v_mfma_f32_32x32x16_bf16 v[24:39], v[16:19], a[20:23], v[24:39]
    v_mfma_f32_32x32x16_bf16 v[40:55], v[20:23], a[20:23], v[40:55]
    s_mov_b32 m0, s40
    s_add_u32 s40, s40, 1024
    global_load_lds_dwordx4 v3, s[16:17]
    v_add_u32 v3, s39, v3
    v_mfma_f32_32x32x16_bf16 v[56:71], v[16:19], a[164:167], v[56:71]
    v_mfma_f32_32x32x16_bf16 v[72:87], v[20:23], a[164:167], v[72:87]
    ds_read_b64_tr_b16 v[16:17], v1 offset:7168
    ds_read_b64_tr_b16 v[18:19], v1 offset:7424
    ds_read_b64_tr_b16 v[20:21], v2 offset:7168
    ds_read_b64_tr_b16 v[22:23], v2 offset:7424
    s_waitcnt lgkmcnt(4)
    v_mfma_f32_32x32x16_bf16 v[24:39], v[8:11], a[24:27], v[24:39]
    v_mfma_f32_32x32x16_bf16 v[40:55], v[12:15], a[24:27], v[40:55]
    s_mov_b32 m0, s40
    s_add_u32 s40, s40, 1024
    global_load_lds_dwordx4 v3, s[16:17]
    v_add_u32 v3, s39, v3
    v_mfma_f32_32x32x16_bf16 v[56:71], v[8:11], a[168:171], v[56:71]
    v_mfma_f32_32x32x16_bf16 v[72:87], v[12:15], a[168:171], v[72:87]
    ds_read_b64_tr_b16 v[8:9], v1 offset:8192
    ds_read_b64_tr_b16 v[10:11], v1 offset:8448
    ds_read_b64_tr_b16 v[12:13], v2 offset:8192
    ds_read_b64_tr_b16 v[14:15], v2 offset:8448
    s_waitcnt lgkmcnt(4)
    v_mfma_f32_32x32x16_bf16 v[24:39], v[16:19], a[28:31], v[24:39]
    v_mfma_f32_32x32x16_bf16 v[40:55], v[20:23], a[28:31], v[40:55]
    s_mov_b32 m0, s40
    s_add_u32 s40, s40, 1024
    global_load_lds_dwordx4 v3, s[16:17]
    v_add_u32 v3, s39, v3
    v_mfma_f32_32x32x16_bf16 v[56:71], v[16:19], a[172:175], v[56:71]
    v_mfma_f32_32x32x16_bf16 v[72:87], v[20:23], a[172:175], v[72:87]
    ds_read_b64_tr_b16 v[16:17], v1 offset:9216
    ds_read_b64_tr_b16 v[18:19], v1 offset:9472
    ds_read_b64_tr_b16 v[20:21], v2 offset:9216
    ds_read_b64_tr_b16 v[22:23], v2 offset:9472
    s_waitcnt lgkmcnt(4)
    v_mfma_f32_32x32x16_bf16 v[24:39], v[8:11], a[32:35], v[24:39]
    v_mfma_f32_32x32x16_bf16 v[40:55], v[12:15], a[32:35], v[40:55]
    s_mov_b32 m0, s40
    s_add_u32 s40, s40, 1024
    global_load_lds_dwordx4 v3, s[16:17]
    v_add_u32 v3, s39, v3
    v_mfma_f32_32x32x16_bf16 v[56:71], v[8:11], a[176:179], v[56:71]
    v_mfma_f32_32x32x16_bf16 v[72:87], v[12:15], a[176:179], v[72:87]
    ds_read_b64_tr_b16 v[8:9], v1 offset:10240
    ds_read_b64_tr_b16 v[10:11], v1 offset:10496
    ds_read_b64_tr_b16 v[12:13], v2 offset:10240
    ds_read_b64_tr_b16 v[14:15], v2 offset:10496
    s_waitcnt lgkmcnt(4)
    v_mfma_f32_32x32x16_bf16 v[24:39], v[16:19], a[36:39], v[24:39]
    v_mfma_f32_32x32x16_bf16 v[40:55], v[20:23], a[36:39], v[40:55]
    s_mov_b32 m0, s40
    s_add_u32 s40, s40, 1024
    global_load_lds_dwordx4 v3, s[16:17]
    v_add_u32 v3, s39, v3
    v_mfma_f32_32x32x16_bf16 v[56:71], v[16:19], a[180:183], v[56:71]
    v_mfma_f32_32x32x16_bf16 v[72:87], v[20:23], a[180:183], v[72:87]
    ds_read_b64_tr_b16 v[16:17], v1 offset:11264
    ds_read_b64_tr_b16 v[18:19], v1 offset:11520
    ds_read_b64_tr_b16 v[20:21], v2 offset:11264
    ds_read_b64_tr_b16 v[22:23], v2 offset:11520
    s_waitcnt lgkmcnt(4)
    v_mfma_f32_32x32x16_bf16 v[24:39], v[8:11], a[40:43], v[24:39]
    v_mfma_f32_32x32x16_bf16 v[40:55], v[12:15], a[40:43], v[40:55]
    s_mov_b32 m0, s40
    s_add_u32 s40, s40, 1024
    global_load_lds_dwordx4 v3, s[16:17]
    v_add_u32 v3, s39, v3
    v_mfma_f32_32x32x16_bf16 v[56:71], v[8:11], a[184:187], v[56:71]
    v_mfma_f32_32x32x16_bf16 v[72:87], v[12:15], a[184:187], v[72:87]
    ds_read_b64_tr_b16 v[8:9], v1 offset:12288
    ds_read_b64_tr_b16 v[10:11], v1 offset:12544
    ds_read_b64_tr_b16 v[12:13], v2 offset:12288
    ds_read_b64_tr_b16 v[14:15], v2 offset:12544
    s_waitcnt lgkmcnt(4)
    v_mfma_f32_32x32x16_bf16 v[24:39], v[16:19], a[44:47], v[24:39]
    v_mfma_f32_32x32x16_bf16 v[40:55], v[20:23], a[44:47], v[40:55]
    s_mov_b32 m0, s40
    s_add_u32 s40, s40, 1024
    global_load_lds_dwordx4 v3, s[16:17]
    v_add_u32 v3, s39, v3
    v_mfma_f32_32x32x16_bf16 v[56:71], v[16:19], a[188:191], v[56:71]
    v_mfma_f32_32x32x16_bf16 v[72:87], v[20:23], a[188:191], v[72:87]
    ds_read_b64_tr_b16 v[16:17], v1 offset:13312
    ds_read_b64_tr_b16 v[18:19], v1 offset:13568
    ds_read_b64_tr_b16 v[20:21], v2 offset:13312
    ds_read_b64_tr_b16 v[22:23], v2 offset:13568
    s_waitcnt lgkmcnt(4)
    v_mfma_f32_32x32x16_bf16 v[24:39], v[8:11], a[48:51], v[24:39]
    v_mfma_f32_32x32x16_bf16 v[40:55], v[12:15], a[48:51], v[40:55]
    s_mov_b32 m0, s40
    s_add_u32 s40, s40, 1024
    global_load_lds_dwordx4 v3, s[16:17]
    v_add_u32 v3, s39, v3
    v_mfma_f32_32x32x16_bf16 v[56:71], v[8:11], a[192:195], v[56:71]
    v_mfma_f32_32x32x16_bf16 v[72:87], v[12:15], a[192:195], v[72:87]
    ds_read_b64_tr_b16 v[8:9], v1 offset:14336
    ds_read_b64_tr_b16 v[10:11], v1 offset:14592
    ds_read_b64_tr_b16 v[12:13], v2 offset:14336
    ds_read_b64_tr_b16 v[14:15], v2 offset:14592
    s_waitcnt lgkmcnt(4)
    v_mfma_f32_32x32x16_bf16 v[24:39], v[16:19], a[52:55], v[24:39]
    v_mfma_f32_32x32x16_bf16 v[40:55], v[20:23], a[52:55], v[40:55]
    s_mov_b32 m0, s40
    s_add_u32 s40, s40, 1024
    global_load_lds_dwordx4 v3, s[16:17]
    v_add_u32 v3, s39, v3
    v_mfma_f32_32x32x16_bf16 v[56:71], v[16:19], a[196:199], v[56:71]
    v_mfma_f32_32x32x16_bf16 v[72:87], v[20:23], a[196:199], v[72:87]
    ds_read_b64_tr_b16 v[16:17], v1 offset:15360
    ds_read_b64_tr_b16 v[18:19], v1 offset:15616
    ds_read_b64_tr_b16 v[20:21], v2 offset:15360
    ds_read_b64_tr_b16 v[22:23], v2 offset:15616
    s_waitcnt lgkmcnt(4)
    v_mfma_f32_32x32x16_bf16 v[24:39], v[8:11], a[56:59], v[24:39]
    v_mfma_f32_32x32x16_bf16 v[40:55], v[12:15], a[56:59], v[40:55]
    s_mov_b32 m0, s40
    s_add_u32 s40, s40, 1024
    global_load_lds_dwordx4 v3, s[16:17]
    v_add_u32 v3, s39, v3
    v_mfma_f32_32x32x16_bf16 v[56:71], v[8:11], a[200:203], v[56:71]
    v_mfma_f32_32x32x16_bf16 v[72:87], v[12:15], a[200:203], v[72:87]
    ds_read_b64_tr_b16 v[8:9], v1 offset:16384
    ds_read_b64_tr_b16 v[10:11], v1 offset:16640
    ds_read_b64_tr_b16 v[12:13], v2 offset:16384
    ds_read_b64_tr_b16 v[14:15], v2 offset:16640
    s_waitcnt lgkmcnt(4)
    v_mfma_f32_32x32x16_bf16 v[24:39], v[16:19], a[60:63], v[24:39]
    v_mfma_f32_32x32x16_bf16 v[40:55], v[20:23], a[60:63], v[40:55]
    s_mov_b32 m0, s40
    s_add_u32 s40, s40, 1024
    global_load_lds_dwordx4 v3, s[16:17]
    v_add_u32 v3, s39, v3
    v_mfma_f32_32x32x16_bf16 v[56:71], v[16:19], a[204:207], v[56:71]
    v_mfma_f32_32x32x16_bf16 v[72:87], v[20:23], a[204:207], v[72:87]
    ds_read_b64_tr_b16 v[16:17], v1 offset:17408
    ds_read_b64_tr_b16 v[18:19], v1 offset:17664
    ds_read_b64_tr_b16 v[20:21], v2 offset:17408
    ds_read_b64_tr_b16 v[22:23], v2 offset:17664
    s_waitcnt lgkmcnt(4)
    v_mfma_f32_32x32x16_bf16 v[24:39], v[8:11], a[64:67], v[24:39]
    v_mfma_f32_32x32x16_bf16 v[40:55], v[12:15], a[64:67], v[40:55]
    s_mov_b32 m0, s40
    s_add_u32 s40, s40, 1024
    global_load_lds_dwordx4 v3, s[16:17]
    v_add_u32 v3, s39, v3
    v_mfma_f32_32x32x16_bf16 v[56:71], v[8:11], a[208:211], v[56:71]
    v_mfma_f32_32x32x16_bf16 v[72:87], v[12:15], a[208:211], v[72:87]
    ds_read_b64_tr_b16 v[8:9], v1 offset:18432
    ds_read_b64_tr_b16 v[10:11], v1 offset:18688
    ds_read_b64_tr_b16 v[12:13], v2 offset:18432
    ds_read_b64_tr_b16 v[14:15], v2 offset:18688
    s_waitcnt lgkmcnt(4)
    v_mfma_f32_32x32x16_bf16 v[24:39], v[16:19], a[68:71], v[24:39]
    v_mfma_f32_32x32x16_bf16 v[40:55], v[20:23], a[68:71], v[40:55]
    s_mov_b32 m0, s40
    s_add_u32 s40, s40, 1024
    global_load_lds_dwordx4 v3, s[16:17]
    v_add_u32 v3, s39, v3
    v_mfma_f32_32x32x16_bf16 v[56:71], v[16:19], a[212:215], v[56:71]
    v_mfma_f32_32x32x16_bf16 v[72:87], v[20:23], a[212:215], v[72:87]
    ds_read_b64_tr_b16 v[16:17], v1 offset:19456
    ds_read_b64_tr_b16 v[18:19], v1 offset:19712
    ds_read_b64_tr_b16 v[20:21], v2 offset:19456
    ds_read_b64_tr_b16 v[22:23], v2 offset:19712
    s_waitcnt lgkmcnt(4)
    v_mfma_f32_32x32x16_bf16 v[24:39], v[8:11], a[72:75], v[24:39]
    v_mfma_f32_32x32x16_bf16 v[40:55], v[12:15], a[72:75], v[40:55]
    v_mfma_f32_32x32x16_bf16 v[56:71], v[8:11], a[216:219], v[56:71]
    v_mfma_f32_32x32x16_bf16 v[72:87], v[12:15], a[216:219], v[72:87]
    ds_read_b64_tr_b16 v[8:9], v1 offset:20480
    ds_read_b64_tr_b16 v[10:11], v1 offset:20736
    ds_read_b64_tr_b16 v[12:13], v2 offset:20480
    ds_read_b64_tr_b16 v[14:15], v2 offset:20736
    s_waitcnt lgkmcnt(4)
    v_mfma_f32_32x32x16_bf16 v[24:39], v[16:19], a[76:79], v[24:39]
    v_mfma_f32_32x32x16_bf16 v[40:55], v[20:23], a[76:79], v[40:55]
    v_mfma_f32_32x32x16_bf16 v[56:71], v[16:19], a[220:223], v[56:71]
    v_mfma_f32_32x32x16_bf16 v[72:87], v[20:23], a[220:223], v[72:87]
    ds_read_b64_tr_b16 v[16:17], v1 offset:21504
    ds_read_b64_tr_b16 v[18:19], v1 offset:21760
    ds_read_b64_tr_b16 v[20:21], v2 offset:21504
    ds_read_b64_tr_b16 v[22:23], v2 offset:21760
    s_waitcnt lgkmcnt(4)
    v_mfma_f32_32x32x16_bf16 v[24:39], v[8:11], a[80:83], v[24:39]
    v_mfma_f32_32x32x16_bf16 v[40:55], v[12:15], a[80:83], v[40:55]
    v_mfma_f32_32x32x16_bf16 v[56:71], v[8:11], a[224:227], v[56:71]
    v_mfma_f32_32x32x16_bf16 v[72:87], v[12:15], a[224:227], v[72:87]
    ds_read_b64_tr_b16 v[8:9], v1 offset:22528
    ds_read_b64_tr_b16 v[10:11], v1 offset:22784
    ds_read_b64_tr_b16 v[12:13], v2 offset:22528
    ds_read_b64_tr_b16 v[14:15], v2 offset:22784
    s_waitcnt lgkmcnt(4)
    v_mfma_f32_32x32x16_bf16 v[24:39], v[16:19], a[84:87], v[24:39]
    v_mfma_f32_32x32x16_bf16 v[40:55], v[20:23], a[84:87], v[40:55]
    v_mfma_f32_32x32x16_bf16 v[56:71], v[16:19], a[228:231], v[56:71]
    v_mfma_f32_32x32x16_bf16 v[72:87], v[20:23], a[228:231], v[72:87]
    ds_read_b64_tr_b16 v[16:17], v1 offset:23552
    ds_read_b64_tr_b16 v[18:19], v1 offset:23808
    ds_read_b64_tr_b16 v[20:21], v2 offset:23552
    ds_read_b64_tr_b16 v[22:23], v2 offset:23808
    s_waitcnt lgkmcnt(4)
    v_mfma_f32_32x32x16_bf16 v[24:39], v[8:11], a[88:91], v[24:39]
    v_mfma_f32_32x32x16_bf16 v[40:55], v[12:15], a[88:91], v[40:55]
    v_mfma_f32_32x32x16_bf16 v[56:71], v[8:11], a[232:235], v[56:71]
    v_mfma_f32_32x32x16_bf16 v[72:87], v[12:15], a[232:235], v[72:87]
    ds_read_b64_tr_b16 v[8:9], v1 offset:24576
    ds_read_b64_tr_b16 v[10:11], v1 offset:24832
    ds_read_b64_tr_b16 v[12:13], v2 offset:24576
    ds_read_b64_tr_b16 v[14:15], v2 offset:24832
    s_waitcnt lgkmcnt(4)
    v_mfma_f32_32x32x16_bf16 v[24:39], v[16:19], a[92:95], v[24:39]
    v_mfma_f32_32x32x16_bf16 v[40:55], v[20:23], a[92:95], v[40:55]
    v_mfma_f32_32x32x16_bf16 v[56:71], v[16:19], a[236:239], v[56:71]
    v_mfma_f32_32x32x16_bf16 v[72:87], v[20:23], a[236:239], v[72:87]
    ds_read_b64_tr_b16 v[16:17], v1 offset:25600
    ds_read_b64_tr_b16 v[18:19], v1 offset:25856
    ds_read_b64_tr_b16 v[20:21], v2 offset:25600
    ds_read_b64_tr_b16 v[22:23], v2 offset:25856
    s_waitcnt lgkmcnt(4)
    v_mfma_f32_32x32x16_bf16 v[24:39], v[8:11], a[96:99], v[24:39]
    v_mfma_f32_32x32x16_bf16 v[40:55], v[12:15], a[96:99], v[40:55]
    v_mfma_f32_32x32x16_bf16 v[56:71], v[8:11], a[240:243], v[56:71]
    v_mfma_f32_32x32x16_bf16 v[72:87], v[12:15], a[240:243], v[72:87]
    ds_read_b64_tr_b16 v[8:9], v1 offset:26624
    ds_read_b64_tr_b16 v[10:11], v1 offset:26880
    ds_read_b64_tr_b16 v[12:13], v2 offset:26624
    ds_read_b64_tr_b16 v[14:15], v2 offset:26880
    s_waitcnt lgkmcnt(4)
    v_mfma_f32_32x32x16_bf16 v[24:39], v[16:19], a[100:103], v[24:39]
    v_mfma_f32_32x32x16_bf16 v[40:55], v[20:23], a[100:103], v[40:55]
    v_mfma_f32_32x32x16_bf16 v[56:71], v[16:19], a[244:247], v[56:71]
    v_mfma_f32_32x32x16_bf16 v[72:87], v[20:23], a[244:247], v[72:87]
    ds_read_b64_tr_b16 v[16:17], v1 offset:27648
    ds_read_b64_tr_b16 v[18:19], v1 offset:27904
    ds_read_b64_tr_b16 v[20:21], v2 offset:27648
    ds_read_b64_tr_b16 v[22:23], v2 offset:27904
    s_waitcnt lgkmcnt(4)
    v_mfma_f32_32x32x16_bf16 v[24:39], v[8:11], a[104:107], v[24:39]
    v_mfma_f32_32x32x16_bf16 v[40:55], v[12:15], a[104:107], v[40:55]
    v_mfma_f32_32x32x16_bf16 v[56:71], v[8:11], a[248:251], v[56:71]
    v_mfma_f32_32x32x16_bf16 v[72:87], v[12:15], a[248:251], v[72:87]
    ds_read_b64_tr_b16 v[8:9], v1 offset:28672
    ds_read_b64_tr_b16 v[10:11], v1 offset:28928
    ds_read_b64_tr_b16 v[12:13], v2 offset:28672
    ds_read_b64_tr_b16 v[14:15], v2 offset:28928
    s_waitcnt lgkmcnt(4)
    v_mfma_f32_32x32x16_bf16 v[24:39], v[16:19], a[108:111], v[24:39]
    v_mfma_f32_32x32x16_bf16 v[40:55], v[20:23], a[108:111], v[40:55]
    v_mfma_f32_32x32x16_bf16 v[56:71], v[16:19], a[252:255], v[56:71]
    v_mfma_f32_32x32x16_bf16 v[72:87], v[20:23], a[252:255], v[72:87]
    ds_read_b64_tr_b16 v[16:17], v1 offset:29696
    ds_read_b64_tr_b16 v[18:19], v1 offset:29952
    ds_read_b64_tr_b16 v[20:21], v2 offset:29696
    ds_read_b64_tr_b16 v[22:23], v2 offset:29952
    s_waitcnt lgkmcnt(4)
    v_mfma_f32_32x32x16_bf16 v[24:39], v[8:11], a[112:115], v[24:39]
    v_mfma_f32_32x32x16_bf16 v[40:55], v[12:15], a[112:115], v[40:55]
    v_mfma_f32_32x32x16_bf16 v[56:71], v[8:11], v[224:227], v[56:71]
    v_mfma_f32_32x32x16_bf16 v[72:87], v[12:15], v[224:227], v[72:87]
    ds_read_b64_tr_b16 v[8:9], v1 offset:30720
    ds_read_b64_tr_b16 v[10:11], v1 offset:30976
    ds_read_b64_tr_b16 v[12:13], v2 offset:30720
    ds_read_b64_tr_b16 v[14:15], v2 offset:30976
    s_waitcnt lgkmcnt(4)
    v_mfma_f32_32x32x16_bf16 v[24:39], v[16:19], a[116:119], v[24:39]
    v_mfma_f32_32x32x16_bf16 v[40:55], v[20:23], a[116:119], v[40:55]
    v_mfma_f32_32x32x16_bf16 v[56:71], v[16:19], v[228:231], v[56:71]
    v_mfma_f32_32x32x16_bf16 v[72:87], v[20:23], v[228:231], v[72:87]
    ds_read_b64_tr_b16 v[16:17], v1 offset:31744
    ds_read_b64_tr_b16 v[18:19], v1 offset:32000
    ds_read_b64_tr_b16 v[20:21], v2 offset:31744
    ds_read_b64_tr_b16 v[22:23], v2 offset:32000
    s_waitcnt lgkmcnt(4)
    v_mfma_f32_32x32x16_bf16 v[24:39], v[8:11], a[120:123], v[24:39]
    v_mfma_f32_32x32x16_bf16 v[40:55], v[12:15], a[120:123], v[40:55]
    v_mfma_f32_32x32x16_bf16 v[56:71], v[8:11], v[232:235], v[56:71]
    v_mfma_f32_32x32x16_bf16 v[72:87], v[12:15], v[232:235], v[72:87]
    ds_read_b64_tr_b16 v[8:9], v1 offset:32768
    ds_read_b64_tr_b16 v[10:11], v1 offset:33024
    ds_read_b64_tr_b16 v[12:13], v2 offset:32768
    ds_read_b64_tr_b16 v[14:15], v2 offset:33024
    s_waitcnt lgkmcnt(4)
    v_mfma_f32_32x32x16_bf16 v[24:39], v[16:19], a[124:127], v[24:39]
    v_mfma_f32_32x32x16_bf16 v[40:55], v[20:23], a[124:127], v[40:55]
    v_mfma_f32_32x32x16_bf16 v[56:71], v[16:19], v[236:239], v[56:71]
    v_mfma_f32_32x32x16_bf16 v[72:87], v[20:23], v[236:239], v[72:87]
    ds_read_b64_tr_b16 v[16:17], v1 offset:33792
    ds_read_b64_tr_b16 v[18:19], v1 offset:34048
    ds_read_b64_tr_b16 v[20:21], v2 offset:33792
    ds_read_b64_tr_b16 v[22:23], v2 offset:34048
    s_waitcnt lgkmcnt(4)
    v_mfma_f32_32x32x16_bf16 v[24:39], v[8:11], a[128:131], v[24:39]
    v_mfma_f32_32x32x16_bf16 v[40:55], v[12:15], a[128:131], v[40:55]
    v_mfma_f32_32x32x16_bf16 v[56:71], v[8:11], v[240:243], v[56:71]
    v_mfma_f32_32x32x16_bf16 v[72:87], v[12:15], v[240:243], v[72:87]
    ds_read_b64_tr_b16 v[8:9], v1 offset:34816
    ds_read_b64_tr_b16 v[10:11], v1 offset:35072
    ds_read_b64_tr_b16 v[12:13], v2 offset:34816
    ds_read_b64_tr_b16 v[14:15], v2 offset:35072
    s_waitcnt lgkmcnt(4)
    v_mfma_f32_32x32x16_bf16 v[24:39], v[16:19], a[132:135], v[24:39]
    v_mfma_f32_32x32x16_bf16 v[40:55], v[20:23], a[132:135], v[40:55]
    v_mfma_f32_32x32x16_bf16 v[56:71], v[16:19], v[244:247], v[56:71]
    v_mfma_f32_32x32x16_bf16 v[72:87], v[20:23], v[244:247], v[72:87]
    ds_read_b64_tr_b16 v[16:17], v1 offset:35840
    ds_read_b64_tr_b16 v[18:19], v1 offset:36096
    ds_read_b64_tr_b16 v[20:21], v2 offset:35840
    ds_read_b64_tr_b16 v[22:23], v2 offset:36096
    s_waitcnt lgkmcnt(4)
    v_mfma_f32_32x32x16_bf16 v[24:39], v[8:11], a[136:139], v[24:39]
    v_mfma_f32_32x32x16_bf16 v[40:55], v[12:15], a[136:139], v[40:55]
    v_mfma_f32_32x32x16_bf16 v[56:71], v[8:11], v[248:251], v[56:71]
    v_mfma_f32_32x32x16_bf16 v[72:87], v[12:15], v[248:251], v[72:87]
    s_waitcnt lgkmcnt(0)
    v_mfma_f32_32x32x16_bf16 v[24:39], v[16:19], a[140:143], v[24:39]
    v_mfma_f32_32x32x16_bf16 v[40:55], v[20:23], a[140:143], v[40:55]
    v_mfma_f32_32x32x16_bf16 v[56:71], v[16:19], v[252:255], v[56:71]
    v_mfma_f32_32x32x16_bf16 v[72:87], v[20:23], v[252:255], v[72:87]
    s_nop 8
    v_mul_f32 v88, s42, v24
    v_mul_f32 v89, s42, v25
    v_mul_f32 v90, s42, v26
    v_mul_f32 v91, s42, v27
    v_mul_f32 v92, s42, v28
    v_mul_f32 v93, s42, v29
    v_mul_f32 v94, s42, v30
    v_mul_f32 v95, s42, v31
    v_mul_f32 v96, s42, v32
    v_mul_f32 v97, s42, v33
    v_mul_f32 v98, s42, v34
    v_mul_f32 v99, s42, v35
    v_mul_f32 v100, s42, v36
    v_mul_f32 v101, s42, v37
    v_mul_f32 v102, s42, v38
    v_mul_f32 v103, s42, v39
    v_exp_f32 v88, v88
    v_exp_f32 v89, v89
    v_exp_f32 v90, v90
    v_exp_f32 v91, v91
    v_exp_f32 v92, v92
    v_exp_f32 v93, v93
    v_exp_f32 v94, v94
    v_exp_f32 v95, v95
    v_exp_f32 v96, v96
    v_exp_f32 v97, v97
    v_exp_f32 v98, v98
    v_exp_f32 v99, v99
    v_exp_f32 v100, v100
    v_exp_f32 v101, v101
    v_exp_f32 v102, v102
    v_exp_f32 v103, v103
    v_pk_mul_f32 v[24:25], v[24:25], v[40:41]
    v_pk_mul_f32 v[26:27], v[26:27], v[42:43]
    v_pk_mul_f32 v[28:29], v[28:29], v[44:45]
    v_pk_mul_f32 v[30:31], v[30:31], v[46:47]
    v_pk_mul_f32 v[32:33], v[32:33], v[48:49]
    v_pk_mul_f32 v[34:35], v[34:35], v[50:51]
    v_pk_mul_f32 v[36:37], v[36:37], v[52:53]
    v_pk_mul_f32 v[38:39], v[38:39], v[54:55]
    v_add_f32 v88, 1.0, v88
    v_add_f32 v89, 1.0, v89
    v_add_f32 v90, 1.0, v90
    v_add_f32 v91, 1.0, v91
    v_add_f32 v92, 1.0, v92
    v_add_f32 v93, 1.0, v93
    v_add_f32 v94, 1.0, v94
    v_add_f32 v95, 1.0, v95
    v_add_f32 v96, 1.0, v96
    v_add_f32 v97, 1.0, v97
    v_add_f32 v98, 1.0, v98
    v_add_f32 v99, 1.0, v99
    v_add_f32 v100, 1.0, v100
    v_add_f32 v101, 1.0, v101
    v_add_f32 v102, 1.0, v102
    v_add_f32 v103, 1.0, v103
    v_rcp_f32 v88, v88
    v_rcp_f32 v89, v89
    v_rcp_f32 v90, v90
    v_rcp_f32 v91, v91
    v_rcp_f32 v92, v92
    v_rcp_f32 v93, v93
    v_rcp_f32 v94, v94
    v_rcp_f32 v95, v95
    v_rcp_f32 v96, v96
    v_rcp_f32 v97, v97
    v_rcp_f32 v98, v98
    v_rcp_f32 v99, v99
    v_rcp_f32 v100, v100
    v_rcp_f32 v101, v101
    v_rcp_f32 v102, v102
    v_rcp_f32 v103, v103
    v_pk_mul_f32 v[24:25], v[24:25], v[88:89]
    v_pk_mul_f32 v[26:27], v[26:27], v[90:91]
    v_pk_mul_f32 v[28:29], v[28:29], v[92:93]
    v_pk_mul_f32 v[30:31], v[30:31], v[94:95]
    v_pk_mul_f32 v[32:33], v[32:33], v[96:97]
    v_pk_mul_f32 v[34:35], v[34:35], v[98:99]
    v_pk_mul_f32 v[36:37], v[36:37], v[100:101]
    v_pk_mul_f32 v[38:39], v[38:39], v[102:103]
    v_cvt_pk_bf16_f32 v88, v24, v25
    v_cvt_pk_bf16_f32 v89, v26, v27
    v_cvt_pk_bf16_f32 v90, v28, v29
    v_cvt_pk_bf16_f32 v91, v30, v31
    v_cvt_pk_bf16_f32 v92, v32, v33
    v_cvt_pk_bf16_f32 v93, v34, v35
    v_cvt_pk_bf16_f32 v94, v36, v37
    v_cvt_pk_bf16_f32 v95, v38, v39
    v_permlane32_swap_b32 v88, v90
    v_permlane32_swap_b32 v89, v91
    v_permlane32_swap_b32 v92, v94
    v_permlane32_swap_b32 v93, v95
    v_mov_b32 v7, v4
    global_store_dwordx4 v7, v[88:91], s[20:21] offset:0 sc1
    global_store_dwordx4 v7, v[92:95], s[20:21] offset:1024 sc1
    v_mul_f32 v104, s42, v56
    v_mul_f32 v105, s42, v57
    v_mul_f32 v106, s42, v58
    v_mul_f32 v107, s42, v59
    v_mul_f32 v108, s42, v60
    v_mul_f32 v109, s42, v61
    v_mul_f32 v110, s42, v62
    v_mul_f32 v111, s42, v63
    v_mul_f32 v112, s42, v64
    v_mul_f32 v113, s42, v65
    v_mul_f32 v114, s42, v66
    v_mul_f32 v115, s42, v67
    v_mul_f32 v116, s42, v68
    v_mul_f32 v117, s42, v69
    v_mul_f32 v118, s42, v70
    v_mul_f32 v119, s42, v71
    v_exp_f32 v104, v104
    v_exp_f32 v105, v105
    v_exp_f32 v106, v106
    v_exp_f32 v107, v107
    v_exp_f32 v108, v108
    v_exp_f32 v109, v109
    v_exp_f32 v110, v110
    v_exp_f32 v111, v111
    v_exp_f32 v112, v112
    v_exp_f32 v113, v113
    v_exp_f32 v114, v114
    v_exp_f32 v115, v115
    v_exp_f32 v116, v116
    v_exp_f32 v117, v117
    v_exp_f32 v118, v118
    v_exp_f32 v119, v119
    v_pk_mul_f32 v[56:57], v[56:57], v[72:73]
    v_pk_mul_f32 v[58:59], v[58:59], v[74:75]
    v_pk_mul_f32 v[60:61], v[60:61], v[76:77]
    v_pk_mul_f32 v[62:63], v[62:63], v[78:79]
    v_pk_mul_f32 v[64:65], v[64:65], v[80:81]
    v_pk_mul_f32 v[66:67], v[66:67], v[82:83]
    v_pk_mul_f32 v[68:69], v[68:69], v[84:85]
    v_pk_mul_f32 v[70:71], v[70:71], v[86:87]
    v_add_f32 v104, 1.0, v104
    v_add_f32 v105, 1.0, v105
    v_add_f32 v106, 1.0, v106
    v_add_f32 v107, 1.0, v107
    v_add_f32 v108, 1.0, v108
    v_add_f32 v109, 1.0, v109
    v_add_f32 v110, 1.0, v110
    v_add_f32 v111, 1.0, v111
    v_add_f32 v112, 1.0, v112
    v_add_f32 v113, 1.0, v113
    v_add_f32 v114, 1.0, v114
    v_add_f32 v115, 1.0, v115
    v_add_f32 v116, 1.0, v116
    v_add_f32 v117, 1.0, v117
    v_add_f32 v118, 1.0, v118
    v_add_f32 v119, 1.0, v119
    v_rcp_f32 v104, v104
    v_rcp_f32 v105, v105
    v_rcp_f32 v106, v106
    v_rcp_f32 v107, v107
    v_rcp_f32 v108, v108
    v_rcp_f32 v109, v109
    v_rcp_f32 v110, v110
    v_rcp_f32 v111, v111
    v_rcp_f32 v112, v112
    v_rcp_f32 v113, v113
    v_rcp_f32 v114, v114
    v_rcp_f32 v115, v115
    v_rcp_f32 v116, v116
    v_rcp_f32 v117, v117
    v_rcp_f32 v118, v118
    v_rcp_f32 v119, v119
    v_pk_mul_f32 v[56:57], v[56:57], v[104:105]
    v_pk_mul_f32 v[58:59], v[58:59], v[106:107]
    v_pk_mul_f32 v[60:61], v[60:61], v[108:109]
    v_pk_mul_f32 v[62:63], v[62:63], v[110:111]
    v_pk_mul_f32 v[64:65], v[64:65], v[112:113]
    v_pk_mul_f32 v[66:67], v[66:67], v[114:115]
    v_pk_mul_f32 v[68:69], v[68:69], v[116:117]
    v_pk_mul_f32 v[70:71], v[70:71], v[118:119]
    v_cvt_pk_bf16_f32 v104, v56, v57
    v_cvt_pk_bf16_f32 v105, v58, v59
    v_cvt_pk_bf16_f32 v106, v60, v61
    v_cvt_pk_bf16_f32 v107, v62, v63
    v_cvt_pk_bf16_f32 v108, v64, v65
    v_cvt_pk_bf16_f32 v109, v66, v67
    v_cvt_pk_bf16_f32 v110, v68, v69
    v_cvt_pk_bf16_f32 v111, v70, v71
    v_permlane32_swap_b32 v104, v106
    v_permlane32_swap_b32 v105, v107
    v_permlane32_swap_b32 v108, v110
    v_permlane32_swap_b32 v109, v111
    v_add_u32 v7, 294912, v4
    global_store_dwordx4 v7, v[104:107], s[20:21] offset:0 sc1
    global_store_dwordx4 v7, v[108:111], s[20:21] offset:1024 sc1
    s_waitcnt vmcnt(4)
L_p1e_18:
    s_add_u32 s22, s12, 1
    s_cmp_lg_u32 s22, s62
    s_cbranch_scc1 L_kv2_34
    s_cmp_eq_u32 s67, 0
    s_mov_b32 s23, 168
    s_cselect_b32 s23, 60, s23
    s_waitcnt vmcnt(0)
    s_barrier
    s_cmp_lg_u32 s8, 0
    s_cbranch_scc1 L_sig_35
    v_mov_b32 v7, s23
    v_mov_b32 v88, 1
    s_mov_b64 exec, 1
    global_atomic_add v7, v88, s[6:7]
    s_mov_b64 exec, -1
L_sig_35:
    s_branch L_nokv_33
L_kv2_34:
    s_cmp_lg_u32 s22, s65
    s_cbranch_scc1 L_nokv_33
    s_waitcnt vmcnt(0)
    s_barrier
    s_cmp_lg_u32 s8, 0
    s_cbranch_scc1 L_sig_36
    v_mov_b32 v7, 80
    v_mov_b32 v88, 1
    s_mov_b64 exec, 1
    global_atomic_add v7, v88, s[6:7]
    s_mov_b64 exec, -1
L_sig_36:
    s_cmp_lg_u32 s8, 0
    s_cbranch_scc1 L_kvb_37
    s_cmp_lg_u32 s10, 1
    s_cbranch_scc1 L_kvb_37
    v_mov_b32 v7, 168
    v_mov_b32 v88, 1
    s_mov_b64 exec, 1
    global_atomic_add v7, v88, s[6:7]
    s_mov_b64 exec, -1
L_kvb_37:
L_nokv_33:
    s_cmp_lg_u32 s12, 0
    s_cbranch_scc1 L_nofill_38
    s_waitcnt vmcnt(0)
    s_barrier
    s_cmp_lg_u32 s8, 0
    s_cbranch_scc1 L_sig_39
    v_mov_b32 v7, 160
    v_mov_b32 v88, 1
    s_mov_b64 exec, 1
    global_atomic_add v7, v88, s[6:7]
    s_mov_b64 exec, -1
L_sig_39:
L_nofill_38:
    s_sub_u32 s41, 73728, s41
    s_cmp_eq_u32 s41, 0
    s_mov_b32 s22, 73728
    s_cselect_b32 s22, 4294893568, s22
    v_add_u32 v1, s22, v1
    v_add_u32 v2, s22, v2
    s_add_u32 s12, s12, 1
    s_cmp_lt_u32 s12, s49
    s_cbranch_scc1 L_p1loop_15
    s_cmp_lg_u32 s11, 8
    s_cbranch_scc1 L_nogate_40
    v_lshrrev_b32 v7, 5, v6
    v_lshlrev_b32 v7, 4, v7
    global_load_dwordx4 v[88:91], v7, s[36:37] offset:0
    global_load_dwordx4 v[92:95], v7, s[36:37] offset:32
    global_load_dwordx4 v[96:99], v7, s[36:37] offset:64
    global_load_dwordx4 v[100:103], v7, s[36:37] offset:96
    global_load_dwordx4 v[104:107], v7, s[36:37] offset:128
    global_load_dwordx4 v[108:111], v7, s[36:37] offset:160
    s_waitcnt vmcnt(0)
    v_mfma_f32_32x32x16_bf16 v[24:39], v[88:91], a[0:3], 0
    v_mfma_f32_32x32x16_bf16 v[56:71], v[88:91], a[144:147], 0
    v_mfma_f32_32x32x16_bf16 v[24:39], v[92:95], a[4:7], v[24:39]
    v_mfma_f32_32x32x16_bf16 v[56:71], v[92:95], a[148:151], v[56:71]
    v_mfma_f32_32x32x16_bf16 v[24:39], v[96:99], a[8:11], v[24:39]
    v_mfma_f32_32x32x16_bf16 v[56:71], v[96:99], a[152:155], v[56:71]
    v_mfma_f32_32x32x16_bf16 v[24:39], v[100:103], a[12:15], v[24:39]
    v_mfma_f32_32x32x16_bf16 v[56:71], v[100:103], a[156:159], v[56:71]
    v_mfma_f32_32x32x16_bf16 v[24:39], v[104:107], a[16:19], v[24:39]
    v_mfma_f32_32x32x16_bf16 v[56:71], v[104:107], a[160:163], v[56:71]
    v_mfma_f32_32x32x16_bf16 v[24:39], v[108:111], a[20:23], v[24:39]
    v_mfma_f32_32x32x16_bf16 v[56:71], v[108:111], a[164:167], v[56:71]
    global_load_dwordx4 v[88:91], v7, s[36:37] offset:192
    global_load_dwordx4 v[92:95], v7, s[36:37] offset:224
    global_load_dwordx4 v[96:99], v7, s[36:37] offset:256
    global_load_dwordx4 v[100:103], v7, s[36:37] offset:288
    global_load_dwordx4 v[104:107], v7, s[36:37] offset:320
    global_load_dwordx4 v[108:111], v7, s[36:37] offset:352
    s_waitcnt vmcnt(0)
    v_mfma_f32_32x32x16_bf16 v[24:39], v[88:91], a[24:27], v[24:39]
    v_mfma_f32_32x32x16_bf16 v[56:71], v[88:91], a[168:171], v[56:71]
    v_mfma_f32_32x32x16_bf16 v[24:39], v[92:95], a[28:31], v[24:39]
    v_mfma_f32_32x32x16_bf16 v[56:71], v[92:95], a[172:175], v[56:71]
    v_mfma_f32_32x32x16_bf16 v[24:39], v[96:99], a[32:35], v[24:39]
    v_mfma_f32_32x32x16_bf16 v[56:71], v[96:99], a[176:179], v[56:71]
    v_mfma_f32_32x32x16_bf16 v[24:39], v[100:103], a[36:39], v[24:39]
    v_mfma_f32_32x32x16_bf16 v[56:71], v[100:103], a[180:183], v[56:71]
    v_mfma_f32_32x32x16_bf16 v[24:39], v[104:107], a[40:43], v[24:39]
    v_mfma_f32_32x32x16_bf16 v[56:71], v[104:107], a[184:187], v[56:71]
    v_mfma_f32_32x32x16_bf16 v[24:39], v[108:111], a[44:47], v[24:39]
    v_mfma_f32_32x32x16_bf16 v[56:71], v[108:111], a[188:191], v[56:71]
    global_load_dwordx4 v[88:91], v7, s[36:37] offset:384
    global_load_dwordx4 v[92:95], v7, s[36:37] offset:416
    global_load_dwordx4 v[96:99], v7, s[36:37] offset:448
    global_load_dwordx4 v[100:103], v7, s[36:37] offset:480
    global_load_dwordx4 v[104:107], v7, s[36:37] offset:512
    global_load_dwordx4 v[108:111], v7, s[36:37] offset:544
    s_waitcnt vmcnt(0)
    v_mfma_f32_32x32x16_bf16 v[24:39], v[88:91], a[48:51], v[24:39]
    v_mfma_f32_32x32x16_bf16 v[56:71], v[88:91], a[192:195], v[56:71]
    v_mfma_f32_32x32x16_bf16 v[24:39], v[92:95], a[52:55], v[24:39]
    v_mfma_f32_32x32x16_bf16 v[56:71], v[92:95], a[196:199], v[56:71]
    v_mfma_f32_32x32x16_bf16 v[24:39], v[96:99], a[56:59], v[24:39]
    v_mfma_f32_32x32x16_bf16 v[56:71], v[96:99], a[200:203], v[56:71]
    v_mfma_f32_32x32x16_bf16 v[24:39], v[100:103], a[60:63], v[24:39]
    v_mfma_f32_32x32x16_bf16 v[56:71], v[100:103], a[204:207], v[56:71]
    v_mfma_f32_32x32x16_bf16 v[24:39], v[104:107], a[64:67], v[24:39]
    v_mfma_f32_32x32x16_bf16 v[56:71], v[104:107], a[208:211], v[56:71]
    v_mfma_f32_32x32x16_bf16 v[24:39], v[108:111], a[68:71], v[24:39]
    v_mfma_f32_32x32x16_bf16 v[56:71], v[108:111], a[212:215], v[56:71]
    global_load_dwordx4 v[88:91], v7, s[36:37] offset:576
    global_load_dwordx4 v[92:95], v7, s[36:37] offset:608
    global_load_dwordx4 v[96:99], v7, s[36:37] offset:640
    global_load_dwordx4 v[100:103], v7, s[36:37] offset:672
    global_load_dwordx4 v[104:107], v7, s[36:37] offset:704
    global_load_dwordx4 v[108:111], v7, s[36:37] offset:736
    s_waitcnt vmcnt(0)
    v_mfma_f32_32x32x16_bf16 v[24:39], v[88:91], a[72:75], v[24:39]
    v_mfma_f32_32x32x16_bf16 v[56:71], v[88:91], a[216:219], v[56:71]
    v_mfma_f32_32x32x16_bf16 v[24:39], v[92:95], a[76:79], v[24:39]
    v_mfma_f32_32x32x16_bf16 v[56:71], v[92:95], a[220:223], v[56:71]
    v_mfma_f32_32x32x16_bf16 v[24:39], v[96:99], a[80:83], v[24:39]
    v_mfma_f32_32x32x16_bf16 v[56:71], v[96:99], a[224:227], v[56:71]
    v_mfma_f32_32x32x16_bf16 v[24:39], v[100:103], a[84:87], v[24:39]
    v_mfma_f32_32x32x16_bf16 v[56:71], v[100:103], a[228:231], v[56:71]
    v_mfma_f32_32x32x16_bf16 v[24:39], v[104:107], a[88:91], v[24:39]
    v_mfma_f32_32x32x16_bf16 v[56:71], v[104:107], a[232:235], v[56:71]
    v_mfma_f32_32x32x16_bf16 v[24:39], v[108:111], a[92:95], v[24:39]
    v_mfma_f32_32x32x16_bf16 v[56:71], v[108:111], a[236:239], v[56:71]
    global_load_dwordx4 v[88:91], v7, s[36:37] offset:768
    global_load_dwordx4 v[92:95], v7, s[36:37] offset:800
    global_load_dwordx4 v[96:99], v7, s[36:37] offset:832
    global_load_dwordx4 v[100:103], v7, s[36:37] offset:864
    global_load_dwordx4 v[104:107], v7, s[36:37] offset:896
    global_load_dwordx4 v[108:111], v7, s[36:37] offset:928
    s_waitcnt vmcnt(0)
    v_mfma_f32_32x32x16_bf16 v[24:39], v[88:91], a[96:99], v[24:39]
    v_mfma_f32_32x32x16_bf16 v[56:71], v[88:91], a[240:243], v[56:71]
    v_mfma_f32_32x32x16_bf16 v[24:39], v[92:95], a[100:103], v[24:39]
    v_mfma_f32_32x32x16_bf16 v[56:71], v[92:95], a[244:247], v[56:71]
    v_mfma_f32_32x32x16_bf16 v[24:39], v[96:99], a[104:107], v[24:39]
    v_mfma_f32_32x32x16_bf16 v[56:71], v[96:99], a[248:251], v[56:71]
    v_mfma_f32_32x32x16_bf16 v[24:39], v[100:103], a[108:111], v[24:39]
    v_mfma_f32_32x32x16_bf16 v[56:71], v[100:103], a[252:255], v[56:71]
    v_mfma_f32_32x32x16_bf16 v[24:39], v[104:107], a[112:115], v[24:39]
    v_mfma_f32_32x32x16_bf16 v[56:71], v[104:107], v[224:227], v[56:71]
    v_mfma_f32_32x32x16_bf16 v[24:39], v[108:111], a[116:119], v[24:39]
    v_mfma_f32_32x32x16_bf16 v[56:71], v[108:111], v[228:231], v[56:71]
    global_load_dwordx4 v[88:91], v7, s[36:37] offset:960
    global_load_dwordx4 v[92:95], v7, s[36:37] offset:992
    global_load_dwordx4 v[96:99], v7, s[36:37] offset:1024
    global_load_dwordx4 v[100:103], v7, s[36:37] offset:1056
    global_load_dwordx4 v[104:107], v7, s[36:37] offset:1088
    global_load_dwordx4 v[108:111], v7, s[36:37] offset:1120
    s_waitcnt vmcnt(0)
    v_mfma_f32_32x32x16_bf16 v[24:39], v[88:91], a[120:123], v[24:39]
    v_mfma_f32_32x32x16_bf16 v[56:71], v[88:91], v[232:235], v[56:71]
    v_mfma_f32_32x32x16_bf16 v[24:39], v[92:95], a[124:127], v[24:39]
    v_mfma_f32_32x32x16_bf16 v[56:71], v[92:95], v[236:239], v[56:71]
    v_mfma_f32_32x32x16_bf16 v[24:39], v[96:99], a[128:131], v[24:39]
    v_mfma_f32_32x32x16_bf16 v[56:71], v[96:99], v[240:243], v[56:71]
    v_mfma_f32_32x32x16_bf16 v[24:39], v[100:103], a[132:135], v[24:39]
    v_mfma_f32_32x32x16_bf16 v[56:71], v[100:103], v[244:247], v[56:71]
    v_mfma_f32_32x32x16_bf16 v[24:39], v[104:107], a[136:139], v[24:39]
    v_mfma_f32_32x32x16_bf16 v[56:71], v[104:107], v[248:251], v[56:71]
    v_mfma_f32_32x32x16_bf16 v[24:39], v[108:111], a[140:143], v[24:39]
    v_mfma_f32_32x32x16_bf16 v[56:71], v[108:111], v[252:255], v[56:71]
    s_nop 10
    v_mul_f32 v88, s42, v24
    v_exp_f32 v88, v88
    s_nop 0
    v_add_f32 v88, 1.0, v88
    v_rcp_f32 v88, v88
    v_mul_f32 v89, s42, v56
    v_exp_f32 v89, v89
    s_nop 0
    v_add_f32 v89, 1.0, v89
    v_rcp_f32 v89, v89
    v_and_b32 v7, 31, v6
    s_lshl_b32 s22, s64, 8
    s_lshl_b32 s23, s8, 6
    s_add_u32 s22, s22, s23
    v_add_u32 v7, s22, v7
    v_lshlrev_b32 v7, 2, v7
    s_add_u32 s44, s4, 87031808
    s_addc_u32 s45, s5, 0
    s_mov_b32 exec_hi, 0
    global_store_dword v7, v88, s[44:45] sc1
    global_store_dword v7, v89, s[44:45] offset:128 sc1
    s_mov_b64 exec, -1
L_nogate_40:
    s_cmp_eq_u32 s38, 1
    s_cbranch_scc0 L_p1q_41
    s_add_u32 s22, s10, 22
    s_lshl_b32 s22, s22, 2
    s_waitcnt vmcnt(0)
    s_barrier
    s_cmp_lg_u32 s8, 0
    s_cbranch_scc1 L_sig_42
    v_mov_b32 v7, s22
    v_mov_b32 v88, 1
    s_mov_b64 exec, 1
    global_atomic_add v7, v88, s[6:7]
    s_mov_b64 exec, -1
L_sig_42:
    s_branch L_p1fin_19
L_p1q_41:
    s_waitcnt vmcnt(0)
    s_barrier
    s_cmp_lg_u32 s8, 0
    s_cbranch_scc1 L_sig_43
    v_mov_b32 v7, 120
    v_mov_b32 v88, 1
    s_mov_b64 exec, 1
    global_atomic_add v7, v88, s[6:7]
    s_mov_b64 exec, -1
L_sig_43:
L_p1fin_19:
    s_cmp_ge_u32 s9, 192
    s_cbranch_scc1 L_p2skip_44
    s_load_dwordx2 s[14:15], s[0:1], 80
    s_lshr_b32 s22, s9, 5
    s_lshl_b32 s22, s22, 1
    s_and_b32 s23, s9, 1
    s_add_u32 s22, s22, s23
    s_mul_i32 s12, s22, 21846
    s_lshr_b32 s12, s12, 16
    s_mul_i32 s23, s12, 3
    s_sub_u32 s11, s22, s23
    s_bfe_u32 s10, s9, 0x40001
    v_and_b32 v6, 63, v0
    s_lshr_b32 s23, s10, 1
    s_add_u32 s23, s23, 22
    s_lshl_b32 s23, s23, 2
    s_cmp_lg_u32 s8, 0
    s_cbranch_scc1 L_p2w_45
    v_mov_b32 v7, s23
L_sp_46:
    global_load_dword v2, v7, s[6:7] sc1
    s_waitcnt vmcnt(0)
    v_readfirstlane_b32 s22, v2
    s_cmp_ge_u32 s22, 19
    s_cbranch_scc1 L_spok_47
    s_sub_u32 s43, s43, 1
    s_cbranch_scc1 L_bail
    s_sleep 64
    s_branch L_sp_46
L_spok_47:
L_p2w_45:
    s_barrier
    s_waitcnt lgkmcnt(0)
    s_mul_i32 s22, s12, 1327104
    s_mul_i32 s23, s11, 384
    s_add_u32 s22, s22, s23
    s_add_u32 s14, s14, s22
    s_addc_u32 s15, s15, 0
    v_lshrrev_b32 v3, 2, v6
    v_mul_u32_u24 v3, 1152, v3
    v_and_b32 v7, 3, v6
    v_lshl_add_u32 v3, v7, 4, v3
    s_lshl_b32 s22, s10, 2
    s_add_u32 s22, s22, s8
    s_mul_i32 s22, s22, 288
    s_mul_i32 s23, s12, 72
    s_add_u32 s22, s22, s23
    s_lshl_b32 s22, s22, 10
    s_add_u32 s22, s22, 67108864
    s_add_u32 s16, s4, s22
    s_addc_u32 s17, s5, 0
    v_lshlrev_b32 v4, 4, v6
    v_lshrrev_b32 v1, 5, v6
    v_lshlrev_b32 v1, 3, v1
    v_bfe_u32 v7, v6, 2, 2
    v_add_u32 v1, v1, v7
    v_lshlrev_b32 v1, 6, v1
    v_bfe_u32 v7, v6, 4, 1
    v_lshl_add_u32 v1, v7, 5, v1
    v_and_b32 v7, 3, v6
    v_lshl_add_u32 v1, v7, 3, v1
    s_mul_i32 s22, s8, 6
    s_add_u32 s22, s22, 0
    s_lshr_b32 s23, s22, 2
    s_and_b32 s22, s22, 3
    s_lshl_b32 s70, s23, 12
    s_lshl_b32 s24, s22, 10
    s_add_u32 s70, s70, s24
    s_mul_i32 s76, s22, 18432
    s_lshl_b32 s24, s23, 6
    s_add_u32 s76, s76, s24
    s_mul_i32 s22, s8, 6
    s_add_u32 s22, s22, 1
    s_lshr_b32 s23, s22, 2
    s_and_b32 s22, s22, 3
    s_lshl_b32 s71, s23, 12
    s_lshl_b32 s24, s22, 10
    s_add_u32 s71, s71, s24
    s_mul_i32 s77, s22, 18432
    s_lshl_b32 s24, s23, 6
    s_add_u32 s77, s77, s24
    s_mul_i32 s22, s8, 6
    s_add_u32 s22, s22, 2
    s_lshr_b32 s23, s22, 2
    s_and_b32 s22, s22, 3
    s_lshl_b32 s72, s23, 12
    s_lshl_b32 s24, s22, 10
    s_add_u32 s72, s72, s24
    s_mul_i32 s78, s22, 18432
    s_lshl_b32 s24, s23, 6
    s_add_u32 s78, s78, s24
    s_mul_i32 s22, s8, 6
    s_add_u32 s22, s22, 3
    s_lshr_b32 s23, s22, 2
    s_and_b32 s22, s22, 3
    s_lshl_b32 s73, s23, 12
    s_lshl_b32 s24, s22, 10
    s_add_u32 s73, s73, s24
    s_mul_i32 s79, s22, 18432
    s_lshl_b32 s24, s23, 6
    s_add_u32 s79, s79, s24
    s_mul_i32 s22, s8, 6
    s_add_u32 s22, s22, 4
    s_lshr_b32 s23, s22, 2
    s_and_b32 s22, s22, 3
    s_lshl_b32 s74, s23, 12
    s_lshl_b32 s24, s22, 10
    s_add_u32 s74, s74, s24
    s_mul_i32 s80, s22, 18432
    s_lshl_b32 s24, s23, 6
    s_add_u32 s80, s80, s24
    s_mul_i32 s22, s8, 6
    s_add_u32 s22, s22, 5
    s_lshr_b32 s23, s22, 2
    s_and_b32 s22, s22, 3
    s_lshl_b32 s75, s23, 12
    s_lshl_b32 s24, s22, 10
    s_add_u32 s75, s75, s24
    s_mul_i32 s81, s22, 18432
    s_lshl_b32 s24, s23, 6
    s_add_u32 s81, s81, s24
    s_add_u32 m0, s70, 0
    v_add_u32 v2, s76, v3
    global_load_lds_dwordx4 v2, s[14:15]
    s_add_u32 m0, s71, 0
    v_add_u32 v2, s77, v3
    global_load_lds_dwordx4 v2, s[14:15]
    s_add_u32 m0, s72, 0
    v_add_u32 v2, s78, v3
    global_load_lds_dwordx4 v2, s[14:15]
    s_add_u32 m0, s73, 0
    v_add_u32 v2, s79, v3
    global_load_lds_dwordx4 v2, s[14:15]
    s_add_u32 m0, s74, 0
    v_add_u32 v2, s80, v3
    global_load_lds_dwordx4 v2, s[14:15]
    s_add_u32 m0, s75, 0
    v_add_u32 v2, s81, v3
    global_load_lds_dwordx4 v2, s[14:15]
    s_add_u32 s14, s14, 73728
    s_addc_u32 s15, s15, 0
    s_add_u32 m0, s70, 24576
    v_add_u32 v2, s76, v3
    global_load_lds_dwordx4 v2, s[14:15]
    s_add_u32 m0, s71, 24576
    v_add_u32 v2, s77, v3
    global_load_lds_dwordx4 v2, s[14:15]
    s_add_u32 m0, s72, 24576
    v_add_u32 v2, s78, v3
    global_load_lds_dwordx4 v2, s[14:15]
    s_add_u32 m0, s73, 24576
    v_add_u32 v2, s79, v3
    global_load_lds_dwordx4 v2, s[14:15]
    s_add_u32 m0, s74, 24576
    v_add_u32 v2, s80, v3
    global_load_lds_dwordx4 v2, s[14:15]
    s_add_u32 m0, s75, 24576
    v_add_u32 v2, s81, v3
    global_load_lds_dwordx4 v2, s[14:15]
    s_add_u32 s14, s14, 73728
    s_addc_u32 s15, s15, 0
    s_add_u32 m0, s70, 49152
    v_add_u32 v2, s76, v3
    global_load_lds_dwordx4 v2, s[14:15]
    s_add_u32 m0, s71, 49152
    v_add_u32 v2, s77, v3
    global_load_lds_dwordx4 v2, s[14:15]
    s_add_u32 m0, s72, 49152
    v_add_u32 v2, s78, v3
    global_load_lds_dwordx4 v2, s[14:15]
    s_add_u32 m0, s73, 49152
    v_add_u32 v2, s79, v3
    global_load_lds_dwordx4 v2, s[14:15]
    s_add_u32 m0, s74, 49152
    v_add_u32 v2, s80, v3
    global_load_lds_dwordx4 v2, s[14:15]
    s_add_u32 m0, s75, 49152
    v_add_u32 v2, s81, v3
    global_load_lds_dwordx4 v2, s[14:15]
    s_add_u32 s14, s14, 73728
    s_addc_u32 s15, s15, 0
    global_load_dwordx4 v[56:59], v4, s[16:17] offset:0 sc1
    global_load_dwordx4 v[60:63], v4, s[16:17] offset:1024 sc1
    global_load_dwordx4 v[64:67], v4, s[16:17] offset:2048 sc1
    global_load_dwordx4 v[68:71], v4, s[16:17] offset:3072 sc1
    s_add_u32 s16, s16, 4096
    s_addc_u32 s17, s17, 0
    global_load_dwordx4 v[72:75], v4, s[16:17] offset:0 sc1
    global_load_dwordx4 v[76:79], v4, s[16:17] offset:1024 sc1
    global_load_dwordx4 v[80:83], v4, s[16:17] offset:2048 sc1
    global_load_dwordx4 v[84:87], v4, s[16:17] offset:3072 sc1
    s_add_u32 s16, s16, 4096
    s_addc_u32 s17, s17, 0
    v_add_u32 v5, 49152, v1
    s_waitcnt vmcnt(20)
    s_barrier
    s_add_u32 m0, s70, 73728
    v_add_u32 v2, s76, v3
    global_load_lds_dwordx4 v2, s[14:15]
    s_add_u32 m0, s71, 73728
    v_add_u32 v2, s77, v3
    global_load_lds_dwordx4 v2, s[14:15]
    s_add_u32 m0, s72, 73728
    v_add_u32 v2, s78, v3
    global_load_lds_dwordx4 v2, s[14:15]
    s_add_u32 m0, s73, 73728
    v_add_u32 v2, s79, v3
    global_load_lds_dwordx4 v2, s[14:15]
    s_add_u32 m0, s74, 73728
    v_add_u32 v2, s80, v3
    global_load_lds_dwordx4 v2, s[14:15]
    s_add_u32 m0, s75, 73728
    v_add_u32 v2, s81, v3
    global_load_lds_dwordx4 v2, s[14:15]
    s_add_u32 s14, s14, 73728
    s_addc_u32 s15, s15, 0
    ds_read_b64_tr_b16 v[8:9], v1 offset:0
    ds_read_b64_tr_b16 v[10:11], v1 offset:256
    ds_read_b64_tr_b16 v[12:13], v1 offset:4096
    ds_read_b64_tr_b16 v[14:15], v1 offset:4352
    ds_read_b64_tr_b16 v[16:17], v1 offset:8192
    ds_read_b64_tr_b16 v[18:19], v1 offset:8448
    ds_read_b64_tr_b16 v[20:21], v1 offset:12288
    ds_read_b64_tr_b16 v[22:23], v1 offset:12544
    ds_read_b64_tr_b16 v[24:25], v1 offset:16384
    ds_read_b64_tr_b16 v[26:27], v1 offset:16640
    ds_read_b64_tr_b16 v[28:29], v1 offset:20480
    ds_read_b64_tr_b16 v[30:31], v1 offset:20736
    ds_read_b64_tr_b16 v[32:33], v1 offset:1024
    ds_read_b64_tr_b16 v[34:35], v1 offset:1280
    ds_read_b64_tr_b16 v[36:37], v1 offset:5120
    ds_read_b64_tr_b16 v[38:39], v1 offset:5376
    ds_read_b64_tr_b16 v[40:41], v1 offset:9216
    ds_read_b64_tr_b16 v[42:43], v1 offset:9472
    ds_read_b64_tr_b16 v[44:45], v1 offset:13312
    ds_read_b64_tr_b16 v[46:47], v1 offset:13568
    ds_read_b64_tr_b16 v[48:49], v1 offset:17408
    ds_read_b64_tr_b16 v[50:51], v1 offset:17664
    ds_read_b64_tr_b16 v[52:53], v1 offset:21504
    ds_read_b64_tr_b16 v[54:55], v1 offset:21760
    s_waitcnt vmcnt(13)
    s_waitcnt lgkmcnt(12)
    v_mfma_f32_32x32x16_bf16 v[96:111], v[8:11], v[56:59], 0
    v_mfma_f32_32x32x16_bf16 v[112:127], v[12:15], v[56:59], 0
    v_mfma_f32_32x32x16_bf16 v[128:143], v[16:19], v[56:59], 0
    v_mfma_f32_32x32x16_bf16 v[144:159], v[20:23], v[56:59], 0
    v_mfma_f32_32x32x16_bf16 v[160:175], v[24:27], v[56:59], 0
    v_mfma_f32_32x32x16_bf16 v[176:191], v[28:31], v[56:59], 0
    global_load_dwordx4 v[56:59], v4, s[16:17] offset:0 sc1
    ds_read_b64_tr_b16 v[8:9], v1 offset:2048
    ds_read_b64_tr_b16 v[10:11], v1 offset:2304
    ds_read_b64_tr_b16 v[12:13], v1 offset:6144
    ds_read_b64_tr_b16 v[14:15], v1 offset:6400
    ds_read_b64_tr_b16 v[16:17], v1 offset:10240
    ds_read_b64_tr_b16 v[18:19], v1 offset:10496
    ds_read_b64_tr_b16 v[20:21], v1 offset:14336
    ds_read_b64_tr_b16 v[22:23], v1 offset:14592
    ds_read_b64_tr_b16 v[24:25], v1 offset:18432
    ds_read_b64_tr_b16 v[26:27], v1 offset:18688
    ds_read_b64_tr_b16 v[28:29], v1 offset:22528
    ds_read_b64_tr_b16 v[30:31], v1 offset:22784
    s_waitcnt vmcnt(13)
    s_waitcnt lgkmcnt(12)
    v_mfma_f32_32x32x16_bf16 v[96:111], v[32:35], v[60:63], v[96:111]
    v_mfma_f32_32x32x16_bf16 v[112:127], v[36:39], v[60:63], v[112:127]
    v_mfma_f32_32x32x16_bf16 v[128:143], v[40:43], v[60:63], v[128:143]
    v_mfma_f32_32x32x16_bf16 v[144:159], v[44:47], v[60:63], v[144:159]
    v_mfma_f32_32x32x16_bf16 v[160:175], v[48:51], v[60:63], v[160:175]
    v_mfma_f32_32x32x16_bf16 v[176:191], v[52:55], v[60:63], v[176:191]
    global_load_dwordx4 v[60:63], v4, s[16:17] offset:1024 sc1
    ds_read_b64_tr_b16 v[32:33], v1 offset:3072
    ds_read_b64_tr_b16 v[34:35], v1 offset:3328
    ds_read_b64_tr_b16 v[36:37], v1 offset:7168
    ds_read_b64_tr_b16 v[38:39], v1 offset:7424
    ds_read_b64_tr_b16 v[40:41], v1 offset:11264
    ds_read_b64_tr_b16 v[42:43], v1 offset:11520
    ds_read_b64_tr_b16 v[44:45], v1 offset:15360
    ds_read_b64_tr_b16 v[46:47], v1 offset:15616
    ds_read_b64_tr_b16 v[48:49], v1 offset:19456
    ds_read_b64_tr_b16 v[50:51], v1 offset:19712
    ds_read_b64_tr_b16 v[52:53], v1 offset:23552
    ds_read_b64_tr_b16 v[54:55], v1 offset:23808
    s_waitcnt vmcnt(13)
    s_waitcnt lgkmcnt(12)
    v_mfma_f32_32x32x16_bf16 v[96:111], v[8:11], v[64:67], v[96:111]
    v_mfma_f32_32x32x16_bf16 v[112:127], v[12:15], v[64:67], v[112:127]
    v_mfma_f32_32x32x16_bf16 v[128:143], v[16:19], v[64:67], v[128:143]
    v_mfma_f32_32x32x16_bf16 v[144:159], v[20:23], v[64:67], v[144:159]
    v_mfma_f32_32x32x16_bf16 v[160:175], v[24:27], v[64:67], v[160:175]
    v_mfma_f32_32x32x16_bf16 v[176:191], v[28:31], v[64:67], v[176:191]
    global_load_dwordx4 v[64:67], v4, s[16:17] offset:2048 sc1
    s_waitcnt vmcnt(13)
    s_waitcnt lgkmcnt(0)
    v_mfma_f32_32x32x16_bf16 v[96:111], v[32:35], v[68:71], v[96:111]
    v_mfma_f32_32x32x16_bf16 v[112:127], v[36:39], v[68:71], v[112:127]
    v_mfma_f32_32x32x16_bf16 v[128:143], v[40:43], v[68:71], v[128:143]
    v_mfma_f32_32x32x16_bf16 v[144:159], v[44:47], v[68:71], v[144:159]
    v_mfma_f32_32x32x16_bf16 v[160:175], v[48:51], v[68:71], v[160:175]
    v_mfma_f32_32x32x16_bf16 v[176:191], v[52:55], v[68:71], v[176:191]
    global_load_dwordx4 v[68:71], v4, s[16:17] offset:3072 sc1
    s_add_u32 s16, s16, 4096
    s_addc_u32 s17, s17, 0
    s_barrier
    s_add_u32 m0, s70, 0
    v_add_u32 v2, s76, v3
    global_load_lds_dwordx4 v2, s[14:15]
    s_add_u32 m0, s71, 0
    v_add_u32 v2, s77, v3
    global_load_lds_dwordx4 v2, s[14:15]
    s_add_u32 m0, s72, 0
    v_add_u32 v2, s78, v3
    global_load_lds_dwordx4 v2, s[14:15]
    s_add_u32 m0, s73, 0
    v_add_u32 v2, s79, v3
    global_load_lds_dwordx4 v2, s[14:15]
    s_add_u32 m0, s74, 0
    v_add_u32 v2, s80, v3
    global_load_lds_dwordx4 v2, s[14:15]
    s_add_u32 m0, s75, 0
    v_add_u32 v2, s81, v3
    global_load_lds_dwordx4 v2, s[14:15]
    s_add_u32 s14, s14, 73728
    s_addc_u32 s15, s15, 0
    ds_read_b64_tr_b16 v[8:9], v1 offset:24576
    ds_read_b64_tr_b16 v[10:11], v1 offset:24832
    ds_read_b64_tr_b16 v[12:13], v1 offset:28672
    ds_read_b64_tr_b16 v[14:15], v1 offset:28928
    ds_read_b64_tr_b16 v[16:17], v1 offset:32768
    ds_read_b64_tr_b16 v[18:19], v1 offset:33024
    ds_read_b64_tr_b16 v[20:21], v1 offset:36864
    ds_read_b64_tr_b16 v[22:23], v1 offset:37120
    ds_read_b64_tr_b16 v[24:25], v1 offset:40960
    ds_read_b64_tr_b16 v[26:27], v1 offset:41216
    ds_read_b64_tr_b16 v[28:29], v1 offset:45056
    ds_read_b64_tr_b16 v[30:31], v1 offset:45312
    ds_read_b64_tr_b16 v[32:33], v1 offset:25600
    ds_read_b64_tr_b16 v[34:35], v1 offset:25856
    ds_read_b64_tr_b16 v[36:37], v1 offset:29696
    ds_read_b64_tr_b16 v[38:39], v1 offset:29952
    ds_read_b64_tr_b16 v[40:41], v1 offset:33792
    ds_read_b64_tr_b16 v[42:43], v1 offset:34048
    ds_read_b64_tr_b16 v[44:45], v1 offset:37888
    ds_read_b64_tr_b16 v[46:47], v1 offset:38144
    ds_read_b64_tr_b16 v[48:49], v1 offset:41984
    ds_read_b64_tr_b16 v[50:51], v1 offset:42240
    ds_read_b64_tr_b16 v[52:53], v1 offset:46080
    ds_read_b64_tr_b16 v[54:55], v1 offset:46336
    s_waitcnt vmcnt(19)
    s_waitcnt lgkmcnt(12)
    v_mfma_f32_32x32x16_bf16 v[96:111], v[8:11], v[72:75], v[96:111]
    v_mfma_f32_32x32x16_bf16 v[112:127], v[12:15], v[72:75], v[112:127]
    v_mfma_f32_32x32x16_bf16 v[128:143], v[16:19], v[72:75], v[128:143]
    v_mfma_f32_32x32x16_bf16 v[144:159], v[20:23], v[72:75], v[144:159]
    v_mfma_f32_32x32x16_bf16 v[160:175], v[24:27], v[72:75], v[160:175]
    v_mfma_f32_32x32x16_bf16 v[176:191], v[28:31], v[72:75], v[176:191]
    global_load_dwordx4 v[72:75], v4, s[16:17] offset:0 sc1
    ds_read_b64_tr_b16 v[8:9], v1 offset:26624
    ds_read_b64_tr_b16 v[10:11], v1 offset:26880
    ds_read_b64_tr_b16 v[12:13], v1 offset:30720
    ds_read_b64_tr_b16 v[14:15], v1 offset:30976
    ds_read_b64_tr_b16 v[16:17], v1 offset:34816
    ds_read_b64_tr_b16 v[18:19], v1 offset:35072
    ds_read_b64_tr_b16 v[20:21], v1 offset:38912
    ds_read_b64_tr_b16 v[22:23], v1 offset:39168
    ds_read_b64_tr_b16 v[24:25], v1 offset:43008
    ds_read_b64_tr_b16 v[26:27], v1 offset:43264
    ds_read_b64_tr_b16 v[28:29], v1 offset:47104
    ds_read_b64_tr_b16 v[30:31], v1 offset:47360
    s_waitcnt vmcnt(19)
    s_waitcnt lgkmcnt(12)
    v_mfma_f32_32x32x16_bf16 v[96:111], v[32:35], v[76:79], v[96:111]
    v_mfma_f32_32x32x16_bf16 v[112:127], v[36:39], v[76:79], v[112:127]
    v_mfma_f32_32x32x16_bf16 v[128:143], v[40:43], v[76:79], v[128:143]
    v_mfma_f32_32x32x16_bf16 v[144:159], v[44:47], v[76:79], v[144:159]
    v_mfma_f32_32x32x16_bf16 v[160:175], v[48:51], v[76:79], v[160:175]
    v_mfma_f32_32x32x16_bf16 v[176:191], v[52:55], v[76:79], v[176:191]
    global_load_dwordx4 v[76:79], v4, s[16:17] offset:1024 sc1
    ds_read_b64_tr_b16 v[32:33], v1 offset:27648
    ds_read_b64_tr_b16 v[34:35], v1 offset:27904
    ds_read_b64_tr_b16 v[36:37], v1 offset:31744
    ds_read_b64_tr_b16 v[38:39], v1 offset:32000
    ds_read_b64_tr_b16 v[40:41], v1 offset:35840
    ds_read_b64_tr_b16 v[42:43], v1 offset:36096
    ds_read_b64_tr_b16 v[44:45], v1 offset:39936
    ds_read_b64_tr_b16 v[46:47], v1 offset:40192
    ds_read_b64_tr_b16 v[48:49], v1 offset:44032
    ds_read_b64_tr_b16 v[50:51], v1 offset:44288
    ds_read_b64_tr_b16 v[52:53], v1 offset:48128
    ds_read_b64_tr_b16 v[54:55], v1 offset:48384
    s_waitcnt vmcnt(19)
    s_waitcnt lgkmcnt(12)
    v_mfma_f32_32x32x16_bf16 v[96:111], v[8:11], v[80:83], v[96:111]
    v_mfma_f32_32x32x16_bf16 v[112:127], v[12:15], v[80:83], v[112:127]
    v_mfma_f32_32x32x16_bf16 v[128:143], v[16:19], v[80:83], v[128:143]
    v_mfma_f32_32x32x16_bf16 v[144:159], v[20:23], v[80:83], v[144:159]
    v_mfma_f32_32x32x16_bf16 v[160:175], v[24:27], v[80:83], v[160:175]
    v_mfma_f32_32x32x16_bf16 v[176:191], v[28:31], v[80:83], v[176:191]
    global_load_dwordx4 v[80:83], v4, s[16:17] offset:2048 sc1
    s_waitcnt vmcnt(19)
    s_waitcnt lgkmcnt(0)
    v_mfma_f32_32x32x16_bf16 v[96:111], v[32:35], v[84:87], v[96:111]
    v_mfma_f32_32x32x16_bf16 v[112:127], v[36:39], v[84:87], v[112:127]
    v_mfma_f32_32x32x16_bf16 v[128:143], v[40:43], v[84:87], v[128:143]
    v_mfma_f32_32x32x16_bf16 v[144:159], v[44:47], v[84:87], v[144:159]
    v_mfma_f32_32x32x16_bf16 v[160:175], v[48:51], v[84:87], v[160:175]
    v_mfma_f32_32x32x16_bf16 v[176:191], v[52:55], v[84:87], v[176:191]
    global_load_dwordx4 v[84:87], v4, s[16:17] offset:3072 sc1
    s_add_u32 s16, s16, 4096
    s_addc_u32 s17, s17, 0
    s_barrier
    s_add_u32 m0, s70, 24576
    v_add_u32 v2, s76, v3
    global_load_lds_dwordx4 v2, s[14:15]
    s_add_u32 m0, s71, 24576
    v_add_u32 v2, s77, v3
    global_load_lds_dwordx4 v2, s[14:15]
    s_add_u32 m0, s72, 24576
    v_add_u32 v2, s78, v3
    global_load_lds_dwordx4 v2, s[14:15]
    s_add_u32 m0, s73, 24576
    v_add_u32 v2, s79, v3
    global_load_lds_dwordx4 v2, s[14:15]
    s_add_u32 m0, s74, 24576
    v_add_u32 v2, s80, v3
    global_load_lds_dwordx4 v2, s[14:15]
    s_add_u32 m0, s75, 24576
    v_add_u32 v2, s81, v3
    global_load_lds_dwordx4 v2, s[14:15]
    s_add_u32 s14, s14, 73728
    s_addc_u32 s15, s15, 0
    ds_read_b64_tr_b16 v[8:9], v1 offset:49152
    ds_read_b64_tr_b16 v[10:11], v1 offset:49408
    ds_read_b64_tr_b16 v[12:13], v1 offset:53248
    ds_read_b64_tr_b16 v[14:15], v1 offset:53504
    ds_read_b64_tr_b16 v[16:17], v1 offset:57344
    ds_read_b64_tr_b16 v[18:19], v1 offset:57600
    ds_read_b64_tr_b16 v[20:21], v1 offset:61440
    ds_read_b64_tr_b16 v[22:23], v1 offset:61696
    ds_read_b64_tr_b16 v[24:25], v5 offset:16384
    ds_read_b64_tr_b16 v[26:27], v5 offset:16640
    ds_read_b64_tr_b16 v[28:29], v5 offset:20480
    ds_read_b64_tr_b16 v[30:31], v5 offset:20736
    ds_read_b64_tr_b16 v[32:33], v1 offset:50176
    ds_read_b64_tr_b16 v[34:35], v1 offset:50432
    ds_read_b64_tr_b16 v[36:37], v1 offset:54272
    ds_read_b64_tr_b16 v[38:39], v1 offset:54528
    ds_read_b64_tr_b16 v[40:41], v1 offset:58368
    ds_read_b64_tr_b16 v[42:43], v1 offset:58624
    ds_read_b64_tr_b16 v[44:45], v1 offset:62464
    ds_read_b64_tr_b16 v[46:47], v1 offset:62720
    ds_read_b64_tr_b16 v[48:49], v5 offset:17408
    ds_read_b64_tr_b16 v[50:51], v5 offset:17664
    ds_read_b64_tr_b16 v[52:53], v5 offset:21504
    ds_read_b64_tr_b16 v[54:55], v5 offset:21760
    s_waitcnt vmcnt(19)
    s_waitcnt lgkmcnt(12)
    v_mfma_f32_32x32x16_bf16 v[96:111], v[8:11], v[56:59], v[96:111]
    v_mfma_f32_32x32x16_bf16 v[112:127], v[12:15], v[56:59], v[112:127]
    v_mfma_f32_32x32x16_bf16 v[128:143], v[16:19], v[56:59], v[128:143]
    v_mfma_f32_32x32x16_bf16 v[144:159], v[20:23], v[56:59], v[144:159]
    v_mfma_f32_32x32x16_bf16 v[160:175], v[24:27], v[56:59], v[160:175]
    v_mfma_f32_32x32x16_bf16 v[176:191], v[28:31], v[56:59], v[176:191]
    global_load_dwordx4 v[56:59], v4, s[16:17] offset:0 sc1
    ds_read_b64_tr_b16 v[8:9], v1 offset:51200
    ds_read_b64_tr_b16 v[10:11], v1 offset:51456
    ds_read_b64_tr_b16 v[12:13], v1 offset:55296
    ds_read_b64_tr_b16 v[14:15], v1 offset:55552
    ds_read_b64_tr_b16 v[16:17], v1 offset:59392
    ds_read_b64_tr_b16 v[18:19], v1 offset:59648
    ds_read_b64_tr_b16 v[20:21], v1 offset:63488
    ds_read_b64_tr_b16 v[22:23], v1 offset:63744
    ds_read_b64_tr_b16 v[24:25], v5 offset:18432
    ds_read_b64_tr_b16 v[26:27], v5 offset:18688
    ds_read_b64_tr_b16 v[28:29], v5 offset:22528
    ds_read_b64_tr_b16 v[30:31], v5 offset:22784
    s_waitcnt vmcnt(19)
    s_waitcnt lgkmcnt(12)
    v_mfma_f32_32x32x16_bf16 v[96:111], v[32:35], v[60:63], v[96:111]
    v_mfma_f32_32x32x16_bf16 v[112:127], v[36:39], v[60:63], v[112:127]
    v_mfma_f32_32x32x16_bf16 v[128:143], v[40:43], v[60:63], v[128:143]
    v_mfma_f32_32x32x16_bf16 v[144:159], v[44:47], v[60:63], v[144:159]
    v_mfma_f32_32x32x16_bf16 v[160:175], v[48:51], v[60:63], v[160:175]
    v_mfma_f32_32x32x16_bf16 v[176:191], v[52:55], v[60:63], v[176:191]
    global_load_dwordx4 v[60:63], v4, s[16:17] offset:1024 sc1
    ds_read_b64_tr_b16 v[32:33], v1 offset:52224
    ds_read_b64_tr_b16 v[34:35], v1 offset:52480
    ds_read_b64_tr_b16 v[36:37], v1 offset:56320
    ds_read_b64_tr_b16 v[38:39], v1 offset:56576
    ds_read_b64_tr_b16 v[40:41], v1 offset:60416
    ds_read_b64_tr_b16 v[42:43], v1 offset:60672
    ds_read_b64_tr_b16 v[44:45], v1 offset:64512
    ds_read_b64_tr_b16 v[46:47], v1 offset:64768
    ds_read_b64_tr_b16 v[48:49], v5 offset:19456
    ds_read_b64_tr_b16 v[50:51], v5 offset:19712
    ds_read_b64_tr_b16 v[52:53], v5 offset:23552
    ds_read_b64_tr_b16 v[54:55], v5 offset:23808
    s_waitcnt vmcnt(19)
    s_waitcnt lgkmcnt(12)
    v_mfma_f32_32x32x16_bf16 v[96:111], v[8:11], v[64:67], v[96:111]
    v_mfma_f32_32x32x16_bf16 v[112:127], v[12:15], v[64:67], v[112:127]
    v_mfma_f32_32x32x16_bf16 v[128:143], v[16:19], v[64:67], v[128:143]
    v_mfma_f32_32x32x16_bf16 v[144:159], v[20:23], v[64:67], v[144:159]
    v_mfma_f32_32x32x16_bf16 v[160:175], v[24:27], v[64:67], v[160:175]
    v_mfma_f32_32x32x16_bf16 v[176:191], v[28:31], v[64:67], v[176:191]
    global_load_dwordx4 v[64:67], v4, s[16:17] offset:2048 sc1
    s_waitcnt vmcnt(19)
    s_waitcnt lgkmcnt(0)
    v_mfma_f32_32x32x16_bf16 v[96:111], v[32:35], v[68:71], v[96:111]
    v_mfma_f32_32x32x16_bf16 v[112:127], v[36:39], v[68:71], v[112:127]
    v_mfma_f32_32x32x16_bf16 v[128:143], v[40:43], v[68:71], v[128:143]
    v_mfma_f32_32x32x16_bf16 v[144:159], v[44:47], v[68:71], v[144:159]
    v_mfma_f32_32x32x16_bf16 v[160:175], v[48:51], v[68:71], v[160:175]
    v_mfma_f32_32x32x16_bf16 v[176:191], v[52:55], v[68:71], v[176:191]
    global_load_dwordx4 v[68:71], v4, s[16:17] offset:3072 sc1
    s_add_u32 s16, s16, 4096
    s_addc_u32 s17, s17, 0
    s_barrier
    s_add_u32 m0, s70, 49152
    v_add_u32 v2, s76, v3
    global_load_lds_dwordx4 v2, s[14:15]
    s_add_u32 m0, s71, 49152
    v_add_u32 v2, s77, v3
    global_load_lds_dwordx4 v2, s[14:15]
    s_add_u32 m0, s72, 49152
    v_add_u32 v2, s78, v3
    global_load_lds_dwordx4 v2, s[14:15]
    s_add_u32 m0, s73, 49152
    v_add_u32 v2, s79, v3
    global_load_lds_dwordx4 v2, s[14:15]
    s_add_u32 m0, s74, 49152
    v_add_u32 v2, s80, v3
    global_load_lds_dwordx4 v2, s[14:15]
    s_add_u32 m0, s75, 49152
    v_add_u32 v2, s81, v3
    global_load_lds_dwordx4 v2, s[14:15]
    s_add_u32 s14, s14, 73728
    s_addc_u32 s15, s15, 0
    ds_read_b64_tr_b16 v[8:9], v5 offset:24576
    ds_read_b64_tr_b16 v[10:11], v5 offset:24832
    ds_read_b64_tr_b16 v[12:13], v5 offset:28672
    ds_read_b64_tr_b16 v[14:15], v5 offset:28928
    ds_read_b64_tr_b16 v[16:17], v5 offset:32768
    ds_read_b64_tr_b16 v[18:19], v5 offset:33024
    ds_read_b64_tr_b16 v[20:21], v5 offset:36864
    ds_read_b64_tr_b16 v[22:23], v5 offset:37120
    ds_read_b64_tr_b16 v[24:25], v5 offset:40960
    ds_read_b64_tr_b16 v[26:27], v5 offset:41216
    ds_read_b64_tr_b16 v[28:29], v5 offset:45056
    ds_read_b64_tr_b16 v[30:31], v5 offset:45312
    ds_read_b64_tr_b16 v[32:33], v5 offset:25600
    ds_read_b64_tr_b16 v[34:35], v5 offset:25856
    ds_read_b64_tr_b16 v[36:37], v5 offset:29696
    ds_read_b64_tr_b16 v[38:39], v5 offset:29952
    ds_read_b64_tr_b16 v[40:41], v5 offset:33792
    ds_read_b64_tr_b16 v[42:43], v5 offset:34048
    ds_read_b64_tr_b16 v[44:45], v5 offset:37888
    ds_read_b64_tr_b16 v[46:47], v5 offset:38144
    ds_read_b64_tr_b16 v[48:49], v5 offset:41984
    ds_read_b64_tr_b16 v[50:51], v5 offset:42240
    ds_read_b64_tr_b16 v[52:53], v5 offset:46080
    ds_read_b64_tr_b16 v[54:55], v5 offset:46336
    s_waitcnt vmcnt(19)
    s_waitcnt lgkmcnt(12)
    v_mfma_f32_32x32x16_bf16 v[96:111], v[8:11], v[72:75], v[96:111]
    v_mfma_f32_32x32x16_bf16 v[112:127], v[12:15], v[72:75], v[112:127]
    v_mfma_f32_32x32x16_bf16 v[128:143], v[16:19], v[72:75], v[128:143]
    v_mfma_f32_32x32x16_bf16 v[144:159], v[20:23], v[72:75], v[144:159]
    v_mfma_f32_32x32x16_bf16 v[160:175], v[24:27], v[72:75], v[160:175]
    v_mfma_f32_32x32x16_bf16 v[176:191], v[28:31], v[72:75], v[176:191]
    global_load_dwordx4 v[72:75], v4, s[16:17] offset:0 sc1
    ds_read_b64_tr_b16 v[8:9], v5 offset:26624
    ds_read_b64_tr_b16 v[10:11], v5 offset:26880
    ds_read_b64_tr_b16 v[12:13], v5 offset:30720
    ds_read_b64_tr_b16 v[14:15], v5 offset:30976
    ds_read_b64_tr_b16 v[16:17], v5 offset:34816
    ds_read_b64_tr_b16 v[18:19], v5 offset:35072
    ds_read_b64_tr_b16 v[20:21], v5 offset:38912
    ds_read_b64_tr_b16 v[22:23], v5 offset:39168
    ds_read_b64_tr_b16 v[24:25], v5 offset:43008
    ds_read_b64_tr_b16 v[26:27], v5 offset:43264
    ds_read_b64_tr_b16 v[28:29], v5 offset:47104
    ds_read_b64_tr_b16 v[30:31], v5 offset:47360
    s_waitcnt vmcnt(19)
    s_waitcnt lgkmcnt(12)
    v_mfma_f32_32x32x16_bf16 v[96:111], v[32:35], v[76:79], v[96:111]
    v_mfma_f32_32x32x16_bf16 v[112:127], v[36:39], v[76:79], v[112:127]
    v_mfma_f32_32x32x16_bf16 v[128:143], v[40:43], v[76:79], v[128:143]
    v_mfma_f32_32x32x16_bf16 v[144:159], v[44:47], v[76:79], v[144:159]
    v_mfma_f32_32x32x16_bf16 v[160:175], v[48:51], v[76:79], v[160:175]
    v_mfma_f32_32x32x16_bf16 v[176:191], v[52:55], v[76:79], v[176:191]
    global_load_dwordx4 v[76:79], v4, s[16:17] offset:1024 sc1
    ds_read_b64_tr_b16 v[32:33], v5 offset:27648
    ds_read_b64_tr_b16 v[34:35], v5 offset:27904
    ds_read_b64_tr_b16 v[36:37], v5 offset:31744
    ds_read_b64_tr_b16 v[38:39], v5 offset:32000
    ds_read_b64_tr_b16 v[40:41], v5 offset:35840
    ds_read_b64_tr_b16 v[42:43], v5 offset:36096
    ds_read_b64_tr_b16 v[44:45], v5 offset:39936
    ds_read_b64_tr_b16 v[46:47], v5 offset:40192
    ds_read_b64_tr_b16 v[48:49], v5 offset:44032
    ds_read_b64_tr_b16 v[50:51], v5 offset:44288
    ds_read_b64_tr_b16 v[52:53], v5 offset:48128
    ds_read_b64_tr_b16 v[54:55], v5 offset:48384
    s_waitcnt vmcnt(19)
    s_waitcnt lgkmcnt(12)
    v_mfma_f32_32x32x16_bf16 v[96:111], v[8:11], v[80:83], v[96:111]
    v_mfma_f32_32x32x16_bf16 v[112:127], v[12:15], v[80:83], v[112:127]
    v_mfma_f32_32x32x16_bf16 v[128:143], v[16:19], v[80:83], v[128:143]
    v_mfma_f32_32x32x16_bf16 v[144:159], v[20:23], v[80:83], v[144:159]
    v_mfma_f32_32x32x16_bf16 v[160:175], v[24:27], v[80:83], v[160:175]
    v_mfma_f32_32x32x16_bf16 v[176:191], v[28:31], v[80:83], v[176:191]
    global_load_dwordx4 v[80:83], v4, s[16:17] offset:2048 sc1
    s_waitcnt vmcnt(19)
    s_waitcnt lgkmcnt(0)
    v_mfma_f32_32x32x16_bf16 v[96:111], v[32:35], v[84:87], v[96:111]
    v_mfma_f32_32x32x16_bf16 v[112:127], v[36:39], v[84:87], v[112:127]
    v_mfma_f32_32x32x16_bf16 v[128:143], v[40:43], v[84:87], v[128:143]
    v_mfma_f32_32x32x16_bf16 v[144:159], v[44:47], v[84:87], v[144:159]
    v_mfma_f32_32x32x16_bf16 v[160:175], v[48:51], v[84:87], v[160:175]
    v_mfma_f32_32x32x16_bf16 v[176:191], v[52:55], v[84:87], v[176:191]
    global_load_dwordx4 v[84:87], v4, s[16:17] offset:3072 sc1
    s_add_u32 s16, s16, 4096
    s_addc_u32 s17, s17, 0
    s_barrier
    s_add_u32 m0, s70, 73728
    v_add_u32 v2, s76, v3
    global_load_lds_dwordx4 v2, s[14:15]
    s_add_u32 m0, s71, 73728
    v_add_u32 v2, s77, v3
    global_load_lds_dwordx4 v2, s[14:15]
    s_add_u32 m0, s72, 73728
    v_add_u32 v2, s78, v3
    global_load_lds_dwordx4 v2, s[14:15]
    s_add_u32 m0, s73, 73728
    v_add_u32 v2, s79, v3
    global_load_lds_dwordx4 v2, s[14:15]
    s_add_u32 m0, s74, 73728
    v_add_u32 v2, s80, v3
    global_load_lds_dwordx4 v2, s[14:15]
    s_add_u32 m0, s75, 73728
    v_add_u32 v2, s81, v3
    global_load_lds_dwordx4 v2, s[14:15]
    s_add_u32 s14, s14, 73728
    s_addc_u32 s15, s15, 0
    ds_read_b64_tr_b16 v[8:9], v1 offset:0
    ds_read_b64_tr_b16 v[10:11], v1 offset:256
    ds_read_b64_tr_b16 v[12:13], v1 offset:4096
    ds_read_b64_tr_b16 v[14:15], v1 offset:4352
    ds_read_b64_tr_b16 v[16:17], v1 offset:8192
    ds_read_b64_tr_b16 v[18:19], v1 offset:8448
    ds_read_b64_tr_b16 v[20:21], v1 offset:12288
    ds_read_b64_tr_b16 v[22:23], v1 offset:12544
    ds_read_b64_tr_b16 v[24:25], v1 offset:16384
    ds_read_b64_tr_b16 v[26:27], v1 offset:16640
    ds_read_b64_tr_b16 v[28:29], v1 offset:20480
    ds_read_b64_tr_b16 v[30:31], v1 offset:20736
    ds_read_b64_tr_b16 v[32:33], v1 offset:1024
    ds_read_b64_tr_b16 v[34:35], v1 offset:1280
    ds_read_b64_tr_b16 v[36:37], v1 offset:5120
    ds_read_b64_tr_b16 v[38:39], v1 offset:5376
    ds_read_b64_tr_b16 v[40:41], v1 offset:9216
    ds_read_b64_tr_b16 v[42:43], v1 offset:9472
    ds_read_b64_tr_b16 v[44:45], v1 offset:13312
    ds_read_b64_tr_b16 v[46:47], v1 offset:13568
    ds_read_b64_tr_b16 v[48:49], v1 offset:17408
    ds_read_b64_tr_b16 v[50:51], v1 offset:17664
    ds_read_b64_tr_b16 v[52:53], v1 offset:21504
    ds_read_b64_tr_b16 v[54:55], v1 offset:21760
    s_waitcnt vmcnt(19)
    s_waitcnt lgkmcnt(12)
    v_mfma_f32_32x32x16_bf16 v[96:111], v[8:11], v[56:59], v[96:111]
    v_mfma_f32_32x32x16_bf16 v[112:127], v[12:15], v[56:59], v[112:127]
    v_mfma_f32_32x32x16_bf16 v[128:143], v[16:19], v[56:59], v[128:143]
    v_mfma_f32_32x32x16_bf16 v[144:159], v[20:23], v[56:59], v[144:159]
    v_mfma_f32_32x32x16_bf16 v[160:175], v[24:27], v[56:59], v[160:175]
    v_mfma_f32_32x32x16_bf16 v[176:191], v[28:31], v[56:59], v[176:191]
    global_load_dwordx4 v[56:59], v4, s[16:17] offset:0 sc1
    ds_read_b64_tr_b16 v[8:9], v1 offset:2048
    ds_read_b64_tr_b16 v[10:11], v1 offset:2304
    ds_read_b64_tr_b16 v[12:13], v1 offset:6144
    ds_read_b64_tr_b16 v[14:15], v1 offset:6400
    ds_read_b64_tr_b16 v[16:17], v1 offset:10240
    ds_read_b64_tr_b16 v[18:19], v1 offset:10496
    ds_read_b64_tr_b16 v[20:21], v1 offset:14336
    ds_read_b64_tr_b16 v[22:23], v1 offset:14592
    ds_read_b64_tr_b16 v[24:25], v1 offset:18432
    ds_read_b64_tr_b16 v[26:27], v1 offset:18688
    ds_read_b64_tr_b16 v[28:29], v1 offset:22528
    ds_read_b64_tr_b16 v[30:31], v1 offset:22784
    s_waitcnt vmcnt(19)
    s_waitcnt lgkmcnt(12)
    v_mfma_f32_32x32x16_bf16 v[96:111], v[32:35], v[60:63], v[96:111]
    v_mfma_f32_32x32x16_bf16 v[112:127], v[36:39], v[60:63], v[112:127]
    v_mfma_f32_32x32x16_bf16 v[128:143], v[40:43], v[60:63], v[128:143]
    v_mfma_f32_32x32x16_bf16 v[144:159], v[44:47], v[60:63], v[144:159]
    v_mfma_f32_32x32x16_bf16 v[160:175], v[48:51], v[60:63], v[160:175]
    v_mfma_f32_32x32x16_bf16 v[176:191], v[52:55], v[60:63], v[176:191]
    global_load_dwordx4 v[60:63], v4, s[16:17] offset:1024 sc1
    ds_read_b64_tr_b16 v[32:33], v1 offset:3072
    ds_read_b64_tr_b16 v[34:35], v1 offset:3328
    ds_read_b64_tr_b16 v[36:37], v1 offset:7168
    ds_read_b64_tr_b16 v[38:39], v1 offset:7424
    ds_read_b64_tr_b16 v[40:41], v1 offset:11264
    ds_read_b64_tr_b16 v[42:43], v1 offset:11520
    ds_read_b64_tr_b16 v[44:45], v1 offset:15360
    ds_read_b64_tr_b16 v[46:47], v1 offset:15616
    ds_read_b64_tr_b16 v[48:49], v1 offset:19456
    ds_read_b64_tr_b16 v[50:51], v1 offset:19712
    ds_read_b64_tr_b16 v[52:53], v1 offset:23552
    ds_read_b64_tr_b16 v[54:55], v1 offset:23808
    s_waitcnt vmcnt(19)
    s_waitcnt lgkmcnt(12)
    v_mfma_f32_32x32x16_bf16 v[96:111], v[8:11], v[64:67], v[96:111]
    v_mfma_f32_32x32x16_bf16 v[112:127], v[12:15], v[64:67], v[112:127]
    v_mfma_f32_32x32x16_bf16 v[128:143], v[16:19], v[64:67], v[128:143]
    v_mfma_f32_32x32x16_bf16 v[144:159], v[20:23], v[64:67], v[144:159]
    v_mfma_f32_32x32x16_bf16 v[160:175], v[24:27], v[64:67], v[160:175]
    v_mfma_f32_32x32x16_bf16 v[176:191], v[28:31], v[64:67], v[176:191]
    global_load_dwordx4 v[64:67], v4, s[16:17] offset:2048 sc1
    s_waitcnt vmcnt(19)
    s_waitcnt lgkmcnt(0)
    v_mfma_f32_32x32x16_bf16 v[96:111], v[32:35], v[68:71], v[96:111]
    v_mfma_f32_32x32x16_bf16 v[112:127], v[36:39], v[68:71], v[112:127]
    v_mfma_f32_32x32x16_bf16 v[128:143], v[40:43], v[68:71], v[128:143]
    v_mfma_f32_32x32x16_bf16 v[144:159], v[44:47], v[68:71], v[144:159]
    v_mfma_f32_32x32x16_bf16 v[160:175], v[48:51], v[68:71], v[160:175]
    v_mfma_f32_32x32x16_bf16 v[176:191], v[52:55], v[68:71], v[176:191]
    global_load_dwordx4 v[68:71], v4, s[16:17] offset:3072 sc1
    s_add_u32 s16, s16, 4096
    s_addc_u32 s17, s17, 0
    s_barrier
    s_add_u32 m0, s70, 0
    v_add_u32 v2, s76, v3
    global_load_lds_dwordx4 v2, s[14:15]
    s_add_u32 m0, s71, 0
    v_add_u32 v2, s77, v3
    global_load_lds_dwordx4 v2, s[14:15]
    s_add_u32 m0, s72, 0
    v_add_u32 v2, s78, v3
    global_load_lds_dwordx4 v2, s[14:15]
    s_add_u32 m0, s73, 0
    v_add_u32 v2, s79, v3
    global_load_lds_dwordx4 v2, s[14:15]
    s_add_u32 m0, s74, 0
    v_add_u32 v2, s80, v3
    global_load_lds_dwordx4 v2, s[14:15]
    s_add_u32 m0, s75, 0
    v_add_u32 v2, s81, v3
    global_load_lds_dwordx4 v2, s[14:15]
    s_add_u32 s14, s14, 73728
    s_addc_u32 s15, s15, 0
    ds_read_b64_tr_b16 v[8:9], v1 offset:24576
    ds_read_b64_tr_b16 v[10:11], v1 offset:24832
    ds_read_b64_tr_b16 v[12:13], v1 offset:28672
    ds_read_b64_tr_b16 v[14:15], v1 offset:28928
    ds_read_b64_tr_b16 v[16:17], v1 offset:32768
    ds_read_b64_tr_b16 v[18:19], v1 offset:33024
    ds_read_b64_tr_b16 v[20:21], v1 offset:36864
    ds_read_b64_tr_b16 v[22:23], v1 offset:37120
    ds_read_b64_tr_b16 v[24:25], v1 offset:40960
    ds_read_b64_tr_b16 v[26:27], v1 offset:41216
    ds_read_b64_tr_b16 v[28:29], v1 offset:45056
    ds_read_b64_tr_b16 v[30:31], v1 offset:45312
    ds_read_b64_tr_b16 v[32:33], v1 offset:25600
    ds_read_b64_tr_b16 v[34:35], v1 offset:25856
    ds_read_b64_tr_b16 v[36:37], v1 offset:29696
    ds_read_b64_tr_b16 v[38:39], v1 offset:29952
    ds_read_b64_tr_b16 v[40:41], v1 offset:33792
    ds_read_b64_tr_b16 v[42:43], v1 offset:34048
    ds_read_b64_tr_b16 v[44:45], v1 offset:37888
    ds_read_b64_tr_b16 v[46:47], v1 offset:38144
    ds_read_b64_tr_b16 v[48:49], v1 offset:41984
    ds_read_b64_tr_b16 v[50:51], v1 offset:42240
    ds_read_b64_tr_b16 v[52:53], v1 offset:46080
    ds_read_b64_tr_b16 v[54:55], v1 offset:46336
    s_waitcnt vmcnt(19)
    s_waitcnt lgkmcnt(12)
    v_mfma_f32_32x32x16_bf16 v[96:111], v[8:11], v[72:75], v[96:111]
    v_mfma_f32_32x32x16_bf16 v[112:127], v[12:15], v[72:75], v[112:127]
    v_mfma_f32_32x32x16_bf16 v[128:143], v[16:19], v[72:75], v[128:143]
    v_mfma_f32_32x32x16_bf16 v[144:159], v[20:23], v[72:75], v[144:159]
    v_mfma_f32_32x32x16_bf16 v[160:175], v[24:27], v[72:75], v[160:175]
    v_mfma_f32_32x32x16_bf16 v[176:191], v[28:31], v[72:75], v[176:191]
    global_load_dwordx4 v[72:75], v4, s[16:17] offset:0 sc1
    ds_read_b64_tr_b16 v[8:9], v1 offset:26624
    ds_read_b64_tr_b16 v[10:11], v1 offset:26880
    ds_read_b64_tr_b16 v[12:13], v1 offset:30720
    ds_read_b64_tr_b16 v[14:15], v1 offset:30976
    ds_read_b64_tr_b16 v[16:17], v1 offset:34816
    ds_read_b64_tr_b16 v[18:19], v1 offset:35072
    ds_read_b64_tr_b16 v[20:21], v1 offset:38912
    ds_read_b64_tr_b16 v[22:23], v1 offset:39168
    ds_read_b64_tr_b16 v[24:25], v1 offset:43008
    ds_read_b64_tr_b16 v[26:27], v1 offset:43264
    ds_read_b64_tr_b16 v[28:29], v1 offset:47104
    ds_read_b64_tr_b16 v[30:31], v1 offset:47360
    s_waitcnt vmcnt(19)
    s_waitcnt lgkmcnt(12)
    v_mfma_f32_32x32x16_bf16 v[96:111], v[32:35], v[76:79], v[96:111]
    v_mfma_f32_32x32x16_bf16 v[112:127], v[36:39], v[76:79], v[112:127]
    v_mfma_f32_32x32x16_bf16 v[128:143], v[40:43], v[76:79], v[128:143]
    v_mfma_f32_32x32x16_bf16 v[144:159], v[44:47], v[76:79], v[144:159]
    v_mfma_f32_32x32x16_bf16 v[160:175], v[48:51], v[76:79], v[160:175]
    v_mfma_f32_32x32x16_bf16 v[176:191], v[52:55], v[76:79], v[176:191]
    global_load_dwordx4 v[76:79], v4, s[16:17] offset:1024 sc1
    ds_read_b64_tr_b16 v[32:33], v1 offset:27648
    ds_read_b64_tr_b16 v[34:35], v1 offset:27904
    ds_read_b64_tr_b16 v[36:37], v1 offset:31744
    ds_read_b64_tr_b16 v[38:39], v1 offset:32000
    ds_read_b64_tr_b16 v[40:41], v1 offset:35840
    ds_read_b64_tr_b16 v[42:43], v1 offset:36096
    ds_read_b64_tr_b16 v[44:45], v1 offset:39936
    ds_read_b64_tr_b16 v[46:47], v1 offset:40192
    ds_read_b64_tr_b16 v[48:49], v1 offset:44032
    ds_read_b64_tr_b16 v[50:51], v1 offset:44288
    ds_read_b64_tr_b16 v[52:53], v1 offset:48128
    ds_read_b64_tr_b16 v[54:55], v1 offset:48384
    s_waitcnt vmcnt(19)
    s_waitcnt lgkmcnt(12)
    v_mfma_f32_32x32x16_bf16 v[96:111], v[8:11], v[80:83], v[96:111]
    v_mfma_f32_32x32x16_bf16 v[112:127], v[12:15], v[80:83], v[112:127]
    v_mfma_f32_32x32x16_bf16 v[128:143], v[16:19], v[80:83], v[128:143]
    v_mfma_f32_32x32x16_bf16 v[144:159], v[20:23], v[80:83], v[144:159]
    v_mfma_f32_32x32x16_bf16 v[160:175], v[24:27], v[80:83], v[160:175]
    v_mfma_f32_32x32x16_bf16 v[176:191], v[28:31], v[80:83], v[176:191]
    global_load_dwordx4 v[80:83], v4, s[16:17] offset:2048 sc1
    s_waitcnt vmcnt(19)
    s_waitcnt lgkmcnt(0)
    v_mfma_f32_32x32x16_bf16 v[96:111], v[32:35], v[84:87], v[96:111]
    v_mfma_f32_32x32x16_bf16 v[112:127], v[36:39], v[84:87], v[112:127]
    v_mfma_f32_32x32x16_bf16 v[128:143], v[40:43], v[84:87], v[128:143]
    v_mfma_f32_32x32x16_bf16 v[144:159], v[44:47], v[84:87], v[144:159]
    v_mfma_f32_32x32x16_bf16 v[160:175], v[48:51], v[84:87], v[160:175]
    v_mfma_f32_32x32x16_bf16 v[176:191], v[52:55], v[84:87], v[176:191]
    global_load_dwordx4 v[84:87], v4, s[16:17] offset:3072 sc1
    s_add_u32 s16, s16, 4096
    s_addc_u32 s17, s17, 0
    s_barrier
    s_add_u32 m0, s70, 24576
    v_add_u32 v2, s76, v3
    global_load_lds_dwordx4 v2, s[14:15]
    s_add_u32 m0, s71, 24576
    v_add_u32 v2, s77, v3
    global_load_lds_dwordx4 v2, s[14:15]
    s_add_u32 m0, s72, 24576
    v_add_u32 v2, s78, v3
    global_load_lds_dwordx4 v2, s[14:15]
    s_add_u32 m0, s73, 24576
    v_add_u32 v2, s79, v3
    global_load_lds_dwordx4 v2, s[14:15]
    s_add_u32 m0, s74, 24576
    v_add_u32 v2, s80, v3
    global_load_lds_dwordx4 v2, s[14:15]
    s_add_u32 m0, s75, 24576
    v_add_u32 v2, s81, v3
    global_load_lds_dwordx4 v2, s[14:15]
    s_add_u32 s14, s14, 73728
    s_addc_u32 s15, s15, 0
    ds_read_b64_tr_b16 v[8:9], v1 offset:49152
    ds_read_b64_tr_b16 v[10:11], v1 offset:49408
    ds_read_b64_tr_b16 v[12:13], v1 offset:53248
    ds_read_b64_tr_b16 v[14:15], v1 offset:53504
    ds_read_b64_tr_b16 v[16:17], v1 offset:57344
    ds_read_b64_tr_b16 v[18:19], v1 offset:57600
    ds_read_b64_tr_b16 v[20:21], v1 offset:61440
    ds_read_b64_tr_b16 v[22:23], v1 offset:61696
    ds_read_b64_tr_b16 v[24:25], v5 offset:16384
    ds_read_b64_tr_b16 v[26:27], v5 offset:16640
    ds_read_b64_tr_b16 v[28:29], v5 offset:20480
    ds_read_b64_tr_b16 v[30:31], v5 offset:20736
    ds_read_b64_tr_b16 v[32:33], v1 offset:50176
    ds_read_b64_tr_b16 v[34:35], v1 offset:50432
    ds_read_b64_tr_b16 v[36:37], v1 offset:54272
    ds_read_b64_tr_b16 v[38:39], v1 offset:54528
    ds_read_b64_tr_b16 v[40:41], v1 offset:58368
    ds_read_b64_tr_b16 v[42:43], v1 offset:58624
    ds_read_b64_tr_b16 v[44:45], v1 offset:62464
    ds_read_b64_tr_b16 v[46:47], v1 offset:62720
    ds_read_b64_tr_b16 v[48:49], v5 offset:17408
    ds_read_b64_tr_b16 v[50:51], v5 offset:17664
    ds_read_b64_tr_b16 v[52:53], v5 offset:21504
    ds_read_b64_tr_b16 v[54:55], v5 offset:21760
    s_waitcnt vmcnt(19)
    s_waitcnt lgkmcnt(12)
    v_mfma_f32_32x32x16_bf16 v[96:111], v[8:11], v[56:59], v[96:111]
    v_mfma_f32_32x32x16_bf16 v[112:127], v[12:15], v[56:59], v[112:127]
    v_mfma_f32_32x32x16_bf16 v[128:143], v[16:19], v[56:59], v[128:143]
    v_mfma_f32_32x32x16_bf16 v[144:159], v[20:23], v[56:59], v[144:159]
    v_mfma_f32_32x32x16_bf16 v[160:175], v[24:27], v[56:59], v[160:175]
    v_mfma_f32_32x32x16_bf16 v[176:191], v[28:31], v[56:59], v[176:191]
    global_load_dwordx4 v[56:59], v4, s[16:17] offset:0 sc1
    ds_read_b64_tr_b16 v[8:9], v1 offset:51200
    ds_read_b64_tr_b16 v[10:11], v1 offset:51456
    ds_read_b64_tr_b16 v[12:13], v1 offset:55296
    ds_read_b64_tr_b16 v[14:15], v1 offset:55552
    ds_read_b64_tr_b16 v[16:17], v1 offset:59392
    ds_read_b64_tr_b16 v[18:19], v1 offset:59648
    ds_read_b64_tr_b16 v[20:21], v1 offset:63488
    ds_read_b64_tr_b16 v[22:23], v1 offset:63744
    ds_read_b64_tr_b16 v[24:25], v5 offset:18432
    ds_read_b64_tr_b16 v[26:27], v5 offset:18688
    ds_read_b64_tr_b16 v[28:29], v5 offset:22528
    ds_read_b64_tr_b16 v[30:31], v5 offset:22784
    s_waitcnt vmcnt(19)
    s_waitcnt lgkmcnt(12)
    v_mfma_f32_32x32x16_bf16 v[96:111], v[32:35], v[60:63], v[96:111]
    v_mfma_f32_32x32x16_bf16 v[112:127], v[36:39], v[60:63], v[112:127]
    v_mfma_f32_32x32x16_bf16 v[128:143], v[40:43], v[60:63], v[128:143]
    v_mfma_f32_32x32x16_bf16 v[144:159], v[44:47], v[60:63], v[144:159]
    v_mfma_f32_32x32x16_bf16 v[160:175], v[48:51], v[60:63], v[160:175]
    v_mfma_f32_32x32x16_bf16 v[176:191], v[52:55], v[60:63], v[176:191]
    global_load_dwordx4 v[60:63], v4, s[16:17] offset:1024 sc1
    ds_read_b64_tr_b16 v[32:33], v1 offset:52224
    ds_read_b64_tr_b16 v[34:35], v1 offset:52480
    ds_read_b64_tr_b16 v[36:37], v1 offset:56320
    ds_read_b64_tr_b16 v[38:39], v1 offset:56576
    ds_read_b64_tr_b16 v[40:41], v1 offset:60416
    ds_read_b64_tr_b16 v[42:43], v1 offset:60672
    ds_read_b64_tr_b16 v[44:45], v1 offset:64512
    ds_read_b64_tr_b16 v[46:47], v1 offset:64768
    ds_read_b64_tr_b16 v[48:49], v5 offset:19456
    ds_read_b64_tr_b16 v[50:51], v5 offset:19712
    ds_read_b64_tr_b16 v[52:53], v5 offset:23552
    ds_read_b64_tr_b16 v[54:55], v5 offset:23808
    s_waitcnt vmcnt(19)
    s_waitcnt lgkmcnt(12)
    v_mfma_f32_32x32x16_bf16 v[96:111], v[8:11], v[64:67], v[96:111]
    v_mfma_f32_32x32x16_bf16 v[112:127], v[12:15], v[64:67], v[112:127]
    v_mfma_f32_32x32x16_bf16 v[128:143], v[16:19], v[64:67], v[128:143]
    v_mfma_f32_32x32x16_bf16 v[144:159], v[20:23], v[64:67], v[144:159]
    v_mfma_f32_32x32x16_bf16 v[160:175], v[24:27], v[64:67], v[160:175]
    v_mfma_f32_32x32x16_bf16 v[176:191], v[28:31], v[64:67], v[176:191]
    global_load_dwordx4 v[64:67], v4, s[16:17] offset:2048 sc1
    s_waitcnt vmcnt(19)
    s_waitcnt lgkmcnt(0)
    v_mfma_f32_32x32x16_bf16 v[96:111], v[32:35], v[68:71], v[96:111]
    v_mfma_f32_32x32x16_bf16 v[112:127], v[36:39], v[68:71], v[112:127]
    v_mfma_f32_32x32x16_bf16 v[128:143], v[40:43], v[68:71], v[128:143]
    v_mfma_f32_32x32x16_bf16 v[144:159], v[44:47], v[68:71], v[144:159]
    v_mfma_f32_32x32x16_bf16 v[160:175], v[48:51], v[68:71], v[160:175]
    v_mfma_f32_32x32x16_bf16 v[176:191], v[52:55], v[68:71], v[176:191]
    global_load_dwordx4 v[68:71], v4, s[16:17] offset:3072 sc1
    s_add_u32 s16, s16, 4096
    s_addc_u32 s17, s17, 0
    s_barrier
    s_add_u32 m0, s70, 49152
    v_add_u32 v2, s76, v3
    global_load_lds_dwordx4 v2, s[14:15]
    s_add_u32 m0, s71, 49152
    v_add_u32 v2, s77, v3
    global_load_lds_dwordx4 v2, s[14:15]
    s_add_u32 m0, s72, 49152
    v_add_u32 v2, s78, v3
    global_load_lds_dwordx4 v2, s[14:15]
    s_add_u32 m0, s73, 49152
    v_add_u32 v2, s79, v3
    global_load_lds_dwordx4 v2, s[14:15]
    s_add_u32 m0, s74, 49152
    v_add_u32 v2, s80, v3
    global_load_lds_dwordx4 v2, s[14:15]
    s_add_u32 m0, s75, 49152
    v_add_u32 v2, s81, v3
    global_load_lds_dwordx4 v2, s[14:15]
    s_add_u32 s14, s14, 73728
    s_addc_u32 s15, s15, 0
    ds_read_b64_tr_b16 v[8:9], v5 offset:24576
    ds_read_b64_tr_b16 v[10:11], v5 offset:24832
    ds_read_b64_tr_b16 v[12:13], v5 offset:28672
    ds_read_b64_tr_b16 v[14:15], v5 offset:28928
    ds_read_b64_tr_b16 v[16:17], v5 offset:32768
    ds_read_b64_tr_b16 v[18:19], v5 offset:33024
    ds_read_b64_tr_b16 v[20:21], v5 offset:36864
    ds_read_b64_tr_b16 v[22:23], v5 offset:37120
    ds_read_b64_tr_b16 v[24:25], v5 offset:40960
    ds_read_b64_tr_b16 v[26:27], v5 offset:41216
    ds_read_b64_tr_b16 v[28:29], v5 offset:45056
    ds_read_b64_tr_b16 v[30:31], v5 offset:45312
    ds_read_b64_tr_b16 v[32:33], v5 offset:25600
    ds_read_b64_tr_b16 v[34:35], v5 offset:25856
    ds_read_b64_tr_b16 v[36:37], v5 offset:29696
    ds_read_b64_tr_b16 v[38:39], v5 offset:29952
    ds_read_b64_tr_b16 v[40:41], v5 offset:33792
    ds_read_b64_tr_b16 v[42:43], v5 offset:34048
    ds_read_b64_tr_b16 v[44:45], v5 offset:37888
    ds_read_b64_tr_b16 v[46:47], v5 offset:38144
    ds_read_b64_tr_b16 v[48:49], v5 offset:41984
    ds_read_b64_tr_b16 v[50:51], v5 offset:42240
    ds_read_b64_tr_b16 v[52:53], v5 offset:46080
    ds_read_b64_tr_b16 v[54:55], v5 offset:46336
    s_waitcnt vmcnt(19)
    s_waitcnt lgkmcnt(12)
    v_mfma_f32_32x32x16_bf16 v[96:111], v[8:11], v[72:75], v[96:111]
    v_mfma_f32_32x32x16_bf16 v[112:127], v[12:15], v[72:75], v[112:127]
    v_mfma_f32_32x32x16_bf16 v[128:143], v[16:19], v[72:75], v[128:143]
    v_mfma_f32_32x32x16_bf16 v[144:159], v[20:23], v[72:75], v[144:159]
    v_mfma_f32_32x32x16_bf16 v[160:175], v[24:27], v[72:75], v[160:175]
    v_mfma_f32_32x32x16_bf16 v[176:191], v[28:31], v[72:75], v[176:191]
    global_load_dwordx4 v[72:75], v4, s[16:17] offset:0 sc1
    ds_read_b64_tr_b16 v[8:9], v5 offset:26624
    ds_read_b64_tr_b16 v[10:11], v5 offset:26880
    ds_read_b64_tr_b16 v[12:13], v5 offset:30720
    ds_read_b64_tr_b16 v[14:15], v5 offset:30976
    ds_read_b64_tr_b16 v[16:17], v5 offset:34816
    ds_read_b64_tr_b16 v[18:19], v5 offset:35072
    ds_read_b64_tr_b16 v[20:21], v5 offset:38912
    ds_read_b64_tr_b16 v[22:23], v5 offset:39168
    ds_read_b64_tr_b16 v[24:25], v5 offset:43008
    ds_read_b64_tr_b16 v[26:27], v5 offset:43264
    ds_read_b64_tr_b16 v[28:29], v5 offset:47104
    ds_read_b64_tr_b16 v[30:31], v5 offset:47360
    s_waitcnt vmcnt(19)
    s_waitcnt lgkmcnt(12)
    v_mfma_f32_32x32x16_bf16 v[96:111], v[32:35], v[76:79], v[96:111]
    v_mfma_f32_32x32x16_bf16 v[112:127], v[36:39], v[76:79], v[112:127]
    v_mfma_f32_32x32x16_bf16 v[128:143], v[40:43], v[76:79], v[128:143]
    v_mfma_f32_32x32x16_bf16 v[144:159], v[44:47], v[76:79], v[144:159]
    v_mfma_f32_32x32x16_bf16 v[160:175], v[48:51], v[76:79], v[160:175]
    v_mfma_f32_32x32x16_bf16 v[176:191], v[52:55], v[76:79], v[176:191]
    global_load_dwordx4 v[76:79], v4, s[16:17] offset:1024 sc1
    ds_read_b64_tr_b16 v[32:33], v5 offset:27648
    ds_read_b64_tr_b16 v[34:35], v5 offset:27904
    ds_read_b64_tr_b16 v[36:37], v5 offset:31744
    ds_read_b64_tr_b16 v[38:39], v5 offset:32000
    ds_read_b64_tr_b16 v[40:41], v5 offset:35840
    ds_read_b64_tr_b16 v[42:43], v5 offset:36096
    ds_read_b64_tr_b16 v[44:45], v5 offset:39936
    ds_read_b64_tr_b16 v[46:47], v5 offset:40192
    ds_read_b64_tr_b16 v[48:49], v5 offset:44032
    ds_read_b64_tr_b16 v[50:51], v5 offset:44288
    ds_read_b64_tr_b16 v[52:53], v5 offset:48128
    ds_read_b64_tr_b16 v[54:55], v5 offset:48384
    s_waitcnt vmcnt(19)
    s_waitcnt lgkmcnt(12)
    v_mfma_f32_32x32x16_bf16 v[96:111], v[8:11], v[80:83], v[96:111]
    v_mfma_f32_32x32x16_bf16 v[112:127], v[12:15], v[80:83], v[112:127]
    v_mfma_f32_32x32x16_bf16 v[128:143], v[16:19], v[80:83], v[128:143]
    v_mfma_f32_32x32x16_bf16 v[144:159], v[20:23], v[80:83], v[144:159]
    v_mfma_f32_32x32x16_bf16 v[160:175], v[24:27], v[80:83], v[160:175]
    v_mfma_f32_32x32x16_bf16 v[176:191], v[28:31], v[80:83], v[176:191]
    global_load_dwordx4 v[80:83], v4, s[16:17] offset:2048 sc1
    s_waitcnt vmcnt(19)
    s_waitcnt lgkmcnt(0)
    v_mfma_f32_32x32x16_bf16 v[96:111], v[32:35], v[84:87], v[96:111]
    v_mfma_f32_32x32x16_bf16 v[112:127], v[36:39], v[84:87], v[112:127]
    v_mfma_f32_32x32x16_bf16 v[128:143], v[40:43], v[84:87], v[128:143]
    v_mfma_f32_32x32x16_bf16 v[144:159], v[44:47], v[84:87], v[144:159]
    v_mfma_f32_32x32x16_bf16 v[160:175], v[48:51], v[84:87], v[160:175]
    v_mfma_f32_32x32x16_bf16 v[176:191], v[52:55], v[84:87], v[176:191]
    global_load_dwordx4 v[84:87], v4, s[16:17] offset:3072 sc1
    s_add_u32 s16, s16, 4096
    s_addc_u32 s17, s17, 0
    s_barrier
    s_add_u32 m0, s70, 73728
    v_add_u32 v2, s76, v3
    global_load_lds_dwordx4 v2, s[14:15]
    s_add_u32 m0, s71, 73728
    v_add_u32 v2, s77, v3
    global_load_lds_dwordx4 v2, s[14:15]
    s_add_u32 m0, s72, 73728
    v_add_u32 v2, s78, v3
    global_load_lds_dwordx4 v2, s[14:15]
    s_add_u32 m0, s73, 73728
    v_add_u32 v2, s79, v3
    global_load_lds_dwordx4 v2, s[14:15]
    s_add_u32 m0, s74, 73728
    v_add_u32 v2, s80, v3
    global_load_lds_dwordx4 v2, s[14:15]
    s_add_u32 m0, s75, 73728
    v_add_u32 v2, s81, v3
    global_load_lds_dwordx4 v2, s[14:15]
    s_add_u32 s14, s14, 73728
    s_addc_u32 s15, s15, 0
    ds_read_b64_tr_b16 v[8:9], v1 offset:0
    ds_read_b64_tr_b16 v[10:11], v1 offset:256
    ds_read_b64_tr_b16 v[12:13], v1 offset:4096
    ds_read_b64_tr_b16 v[14:15], v1 offset:4352
    ds_read_b64_tr_b16 v[16:17], v1 offset:8192
    ds_read_b64_tr_b16 v[18:19], v1 offset:8448
    ds_read_b64_tr_b16 v[20:21], v1 offset:12288
    ds_read_b64_tr_b16 v[22:23], v1 offset:12544
    ds_read_b64_tr_b16 v[24:25], v1 offset:16384
    ds_read_b64_tr_b16 v[26:27], v1 offset:16640
    ds_read_b64_tr_b16 v[28:29], v1 offset:20480
    ds_read_b64_tr_b16 v[30:31], v1 offset:20736
    ds_read_b64_tr_b16 v[32:33], v1 offset:1024
    ds_read_b64_tr_b16 v[34:35], v1 offset:1280
    ds_read_b64_tr_b16 v[36:37], v1 offset:5120
    ds_read_b64_tr_b16 v[38:39], v1 offset:5376
    ds_read_b64_tr_b16 v[40:41], v1 offset:9216
    ds_read_b64_tr_b16 v[42:43], v1 offset:9472
    ds_read_b64_tr_b16 v[44:45], v1 offset:13312
    ds_read_b64_tr_b16 v[46:47], v1 offset:13568
    ds_read_b64_tr_b16 v[48:49], v1 offset:17408
    ds_read_b64_tr_b16 v[50:51], v1 offset:17664
    ds_read_b64_tr_b16 v[52:53], v1 offset:21504
    ds_read_b64_tr_b16 v[54:55], v1 offset:21760
    s_waitcnt vmcnt(19)
    s_waitcnt lgkmcnt(12)
    v_mfma_f32_32x32x16_bf16 v[96:111], v[8:11], v[56:59], v[96:111]
    v_mfma_f32_32x32x16_bf16 v[112:127], v[12:15], v[56:59], v[112:127]
    v_mfma_f32_32x32x16_bf16 v[128:143], v[16:19], v[56:59], v[128:143]
    v_mfma_f32_32x32x16_bf16 v[144:159], v[20:23], v[56:59], v[144:159]
    v_mfma_f32_32x32x16_bf16 v[160:175], v[24:27], v[56:59], v[160:175]
    v_mfma_f32_32x32x16_bf16 v[176:191], v[28:31], v[56:59], v[176:191]
    global_load_dwordx4 v[56:59], v4, s[16:17] offset:0 sc1
    ds_read_b64_tr_b16 v[8:9], v1 offset:2048
    ds_read_b64_tr_b16 v[10:11], v1 offset:2304
    ds_read_b64_tr_b16 v[12:13], v1 offset:6144
    ds_read_b64_tr_b16 v[14:15], v1 offset:6400
    ds_read_b64_tr_b16 v[16:17], v1 offset:10240
    ds_read_b64_tr_b16 v[18:19], v1 offset:10496
    ds_read_b64_tr_b16 v[20:21], v1 offset:14336
    ds_read_b64_tr_b16 v[22:23], v1 offset:14592
    ds_read_b64_tr_b16 v[24:25], v1 offset:18432
    ds_read_b64_tr_b16 v[26:27], v1 offset:18688
    ds_read_b64_tr_b16 v[28:29], v1 offset:22528
    ds_read_b64_tr_b16 v[30:31], v1 offset:22784
    s_waitcnt vmcnt(19)
    s_waitcnt lgkmcnt(12)
    v_mfma_f32_32x32x16_bf16 v[96:111], v[32:35], v[60:63], v[96:111]
    v_mfma_f32_32x32x16_bf16 v[112:127], v[36:39], v[60:63], v[112:127]
    v_mfma_f32_32x32x16_bf16 v[128:143], v[40:43], v[60:63], v[128:143]
    v_mfma_f32_32x32x16_bf16 v[144:159], v[44:47], v[60:63], v[144:159]
    v_mfma_f32_32x32x16_bf16 v[160:175], v[48:51], v[60:63], v[160:175]
    v_mfma_f32_32x32x16_bf16 v[176:191], v[52:55], v[60:63], v[176:191]
    global_load_dwordx4 v[60:63], v4, s[16:17] offset:1024 sc1
    ds_read_b64_tr_b16 v[32:33], v1 offset:3072
    ds_read_b64_tr_b16 v[34:35], v1 offset:3328
    ds_read_b64_tr_b16 v[36:37], v1 offset:7168
    ds_read_b64_tr_b16 v[38:39], v1 offset:7424
    ds_read_b64_tr_b16 v[40:41], v1 offset:11264
    ds_read_b64_tr_b16 v[42:43], v1 offset:11520
    ds_read_b64_tr_b16 v[44:45], v1 offset:15360
    ds_read_b64_tr_b16 v[46:47], v1 offset:15616
    ds_read_b64_tr_b16 v[48:49], v1 offset:19456
    ds_read_b64_tr_b16 v[50:51], v1 offset:19712
    ds_read_b64_tr_b16 v[52:53], v1 offset:23552
    ds_read_b64_tr_b16 v[54:55], v1 offset:23808
    s_waitcnt vmcnt(19)
    s_waitcnt lgkmcnt(12)
    v_mfma_f32_32x32x16_bf16 v[96:111], v[8:11], v[64:67], v[96:111]
    v_mfma_f32_32x32x16_bf16 v[112:127], v[12:15], v[64:67], v[112:127]
    v_mfma_f32_32x32x16_bf16 v[128:143], v[16:19], v[64:67], v[128:143]
    v_mfma_f32_32x32x16_bf16 v[144:159], v[20:23], v[64:67], v[144:159]
    v_mfma_f32_32x32x16_bf16 v[160:175], v[24:27], v[64:67], v[160:175]
    v_mfma_f32_32x32x16_bf16 v[176:191], v[28:31], v[64:67], v[176:191]
    global_load_dwordx4 v[64:67], v4, s[16:17] offset:2048 sc1
    s_waitcnt vmcnt(19)
    s_waitcnt lgkmcnt(0)
    v_mfma_f32_32x32x16_bf16 v[96:111], v[32:35], v[68:71], v[96:111]
    v_mfma_f32_32x32x16_bf16 v[112:127], v[36:39], v[68:71], v[112:127]
    v_mfma_f32_32x32x16_bf16 v[128:143], v[40:43], v[68:71], v[128:143]
    v_mfma_f32_32x32x16_bf16 v[144:159], v[44:47], v[68:71], v[144:159]
    v_mfma_f32_32x32x16_bf16 v[160:175], v[48:51], v[68:71], v[160:175]
    v_mfma_f32_32x32x16_bf16 v[176:191], v[52:55], v[68:71], v[176:191]
    global_load_dwordx4 v[68:71], v4, s[16:17] offset:3072 sc1
    s_add_u32 s16, s16, 4096
    s_addc_u32 s17, s17, 0
    s_barrier
    s_add_u32 m0, s70, 0
    v_add_u32 v2, s76, v3
    global_load_lds_dwordx4 v2, s[14:15]
    s_add_u32 m0, s71, 0
    v_add_u32 v2, s77, v3
    global_load_lds_dwordx4 v2, s[14:15]
    s_add_u32 m0, s72, 0
    v_add_u32 v2, s78, v3
    global_load_lds_dwordx4 v2, s[14:15]
    s_add_u32 m0, s73, 0
    v_add_u32 v2, s79, v3
    global_load_lds_dwordx4 v2, s[14:15]
    s_add_u32 m0, s74, 0
    v_add_u32 v2, s80, v3
    global_load_lds_dwordx4 v2, s[14:15]
    s_add_u32 m0, s75, 0
    v_add_u32 v2, s81, v3
    global_load_lds_dwordx4 v2, s[14:15]
    s_add_u32 s14, s14, 73728
    s_addc_u32 s15, s15, 0
    ds_read_b64_tr_b16 v[8:9], v1 offset:24576
    ds_read_b64_tr_b16 v[10:11], v1 offset:24832
    ds_read_b64_tr_b16 v[12:13], v1 offset:28672
    ds_read_b64_tr_b16 v[14:15], v1 offset:28928
    ds_read_b64_tr_b16 v[16:17], v1 offset:32768
    ds_read_b64_tr_b16 v[18:19], v1 offset:33024
    ds_read_b64_tr_b16 v[20:21], v1 offset:36864
    ds_read_b64_tr_b16 v[22:23], v1 offset:37120
    ds_read_b64_tr_b16 v[24:25], v1 offset:40960
    ds_read_b64_tr_b16 v[26:27], v1 offset:41216
    ds_read_b64_tr_b16 v[28:29], v1 offset:45056
    ds_read_b64_tr_b16 v[30:31], v1 offset:45312
    ds_read_b64_tr_b16 v[32:33], v1 offset:25600
    ds_read_b64_tr_b16 v[34:35], v1 offset:25856
    ds_read_b64_tr_b16 v[36:37], v1 offset:29696
    ds_read_b64_tr_b16 v[38:39], v1 offset:29952
    ds_read_b64_tr_b16 v[40:41], v1 offset:33792
    ds_read_b64_tr_b16 v[42:43], v1 offset:34048
    ds_read_b64_tr_b16 v[44:45], v1 offset:37888
    ds_read_b64_tr_b16 v[46:47], v1 offset:38144
    ds_read_b64_tr_b16 v[48:49], v1 offset:41984
    ds_read_b64_tr_b16 v[50:51], v1 offset:42240
    ds_read_b64_tr_b16 v[52:53], v1 offset:46080
    ds_read_b64_tr_b16 v[54:55], v1 offset:46336
    s_waitcnt vmcnt(19)
    s_waitcnt lgkmcnt(12)
    v_mfma_f32_32x32x16_bf16 v[96:111], v[8:11], v[72:75], v[96:111]
    v_mfma_f32_32x32x16_bf16 v[112:127], v[12:15], v[72:75], v[112:127]
    v_mfma_f32_32x32x16_bf16 v[128:143], v[16:19], v[72:75], v[128:143]
    v_mfma_f32_32x32x16_bf16 v[144:159], v[20:23], v[72:75], v[144:159]
    v_mfma_f32_32x32x16_bf16 v[160:175], v[24:27], v[72:75], v[160:175]
    v_mfma_f32_32x32x16_bf16 v[176:191], v[28:31], v[72:75], v[176:191]
    global_load_dwordx4 v[72:75], v4, s[16:17] offset:0 sc1
    ds_read_b64_tr_b16 v[8:9], v1 offset:26624
    ds_read_b64_tr_b16 v[10:11], v1 offset:26880
    ds_read_b64_tr_b16 v[12:13], v1 offset:30720
    ds_read_b64_tr_b16 v[14:15], v1 offset:30976
    ds_read_b64_tr_b16 v[16:17], v1 offset:34816
    ds_read_b64_tr_b16 v[18:19], v1 offset:35072
    ds_read_b64_tr_b16 v[20:21], v1 offset:38912
    ds_read_b64_tr_b16 v[22:23], v1 offset:39168
    ds_read_b64_tr_b16 v[24:25], v1 offset:43008
    ds_read_b64_tr_b16 v[26:27], v1 offset:43264
    ds_read_b64_tr_b16 v[28:29], v1 offset:47104
    ds_read_b64_tr_b16 v[30:31], v1 offset:47360
    s_waitcnt vmcnt(19)
    s_waitcnt lgkmcnt(12)
    v_mfma_f32_32x32x16_bf16 v[96:111], v[32:35], v[76:79], v[96:111]
    v_mfma_f32_32x32x16_bf16 v[112:127], v[36:39], v[76:79], v[112:127]
    v_mfma_f32_32x32x16_bf16 v[128:143], v[40:43], v[76:79], v[128:143]
    v_mfma_f32_32x32x16_bf16 v[144:159], v[44:47], v[76:79], v[144:159]
    v_mfma_f32_32x32x16_bf16 v[160:175], v[48:51], v[76:79], v[160:175]
    v_mfma_f32_32x32x16_bf16 v[176:191], v[52:55], v[76:79], v[176:191]
    global_load_dwordx4 v[76:79], v4, s[16:17] offset:1024 sc1
    ds_read_b64_tr_b16 v[32:33], v1 offset:27648
    ds_read_b64_tr_b16 v[34:35], v1 offset:27904
    ds_read_b64_tr_b16 v[36:37], v1 offset:31744
    ds_read_b64_tr_b16 v[38:39], v1 offset:32000
    ds_read_b64_tr_b16 v[40:41], v1 offset:35840
    ds_read_b64_tr_b16 v[42:43], v1 offset:36096
    ds_read_b64_tr_b16 v[44:45], v1 offset:39936
    ds_read_b64_tr_b16 v[46:47], v1 offset:40192
    ds_read_b64_tr_b16 v[48:49], v1 offset:44032
    ds_read_b64_tr_b16 v[50:51], v1 offset:44288
    ds_read_b64_tr_b16 v[52:53], v1 offset:48128
    ds_read_b64_tr_b16 v[54:55], v1 offset:48384
    s_waitcnt vmcnt(19)
    s_waitcnt lgkmcnt(12)
    v_mfma_f32_32x32x16_bf16 v[96:111], v[8:11], v[80:83], v[96:111]
    v_mfma_f32_32x32x16_bf16 v[112:127], v[12:15], v[80:83], v[112:127]
    v_mfma_f32_32x32x16_bf16 v[128:143], v[16:19], v[80:83], v[128:143]
    v_mfma_f32_32x32x16_bf16 v[144:159], v[20:23], v[80:83], v[144:159]
    v_mfma_f32_32x32x16_bf16 v[160:175], v[24:27], v[80:83], v[160:175]
    v_mfma_f32_32x32x16_bf16 v[176:191], v[28:31], v[80:83], v[176:191]
    global_load_dwordx4 v[80:83], v4, s[16:17] offset:2048 sc1
    s_waitcnt vmcnt(19)
    s_waitcnt lgkmcnt(0)
    v_mfma_f32_32x32x16_bf16 v[96:111], v[32:35], v[84:87], v[96:111]
    v_mfma_f32_32x32x16_bf16 v[112:127], v[36:39], v[84:87], v[112:127]
    v_mfma_f32_32x32x16_bf16 v[128:143], v[40:43], v[84:87], v[128:143]
    v_mfma_f32_32x32x16_bf16 v[144:159], v[44:47], v[84:87], v[144:159]
    v_mfma_f32_32x32x16_bf16 v[160:175], v[48:51], v[84:87], v[160:175]
    v_mfma_f32_32x32x16_bf16 v[176:191], v[52:55], v[84:87], v[176:191]
    global_load_dwordx4 v[84:87], v4, s[16:17] offset:3072 sc1
    s_add_u32 s16, s16, 4096
    s_addc_u32 s17, s17, 0
    s_barrier
    s_add_u32 m0, s70, 24576
    v_add_u32 v2, s76, v3
    global_load_lds_dwordx4 v2, s[14:15]
    s_add_u32 m0, s71, 24576
    v_add_u32 v2, s77, v3
    global_load_lds_dwordx4 v2, s[14:15]
    s_add_u32 m0, s72, 24576
    v_add_u32 v2, s78, v3
    global_load_lds_dwordx4 v2, s[14:15]
    s_add_u32 m0, s73, 24576
    v_add_u32 v2, s79, v3
    global_load_lds_dwordx4 v2, s[14:15]
    s_add_u32 m0, s74, 24576
    v_add_u32 v2, s80, v3
    global_load_lds_dwordx4 v2, s[14:15]
    s_add_u32 m0, s75, 24576
    v_add_u32 v2, s81, v3
    global_load_lds_dwordx4 v2, s[14:15]
    s_add_u32 s14, s14, 73728
    s_addc_u32 s15, s15, 0
    ds_read_b64_tr_b16 v[8:9], v1 offset:49152
    ds_read_b64_tr_b16 v[10:11], v1 offset:49408
    ds_read_b64_tr_b16 v[12:13], v1 offset:53248
    ds_read_b64_tr_b16 v[14:15], v1 offset:53504
    ds_read_b64_tr_b16 v[16:17], v1 offset:57344
    ds_read_b64_tr_b16 v[18:19], v1 offset:57600
    ds_read_b64_tr_b16 v[20:21], v1 offset:61440
    ds_read_b64_tr_b16 v[22:23], v1 offset:61696
    ds_read_b64_tr_b16 v[24:25], v5 offset:16384
    ds_read_b64_tr_b16 v[26:27], v5 offset:16640
    ds_read_b64_tr_b16 v[28:29], v5 offset:20480
    ds_read_b64_tr_b16 v[30:31], v5 offset:20736
    ds_read_b64_tr_b16 v[32:33], v1 offset:50176
    ds_read_b64_tr_b16 v[34:35], v1 offset:50432
    ds_read_b64_tr_b16 v[36:37], v1 offset:54272
    ds_read_b64_tr_b16 v[38:39], v1 offset:54528
    ds_read_b64_tr_b16 v[40:41], v1 offset:58368
    ds_read_b64_tr_b16 v[42:43], v1 offset:58624
    ds_read_b64_tr_b16 v[44:45], v1 offset:62464
    ds_read_b64_tr_b16 v[46:47], v1 offset:62720
    ds_read_b64_tr_b16 v[48:49], v5 offset:17408
    ds_read_b64_tr_b16 v[50:51], v5 offset:17664
    ds_read_b64_tr_b16 v[52:53], v5 offset:21504
    ds_read_b64_tr_b16 v[54:55], v5 offset:21760
    s_waitcnt vmcnt(19)
    s_waitcnt lgkmcnt(12)
    v_mfma_f32_32x32x16_bf16 v[96:111], v[8:11], v[56:59], v[96:111]
    v_mfma_f32_32x32x16_bf16 v[112:127], v[12:15], v[56:59], v[112:127]
    v_mfma_f32_32x32x16_bf16 v[128:143], v[16:19], v[56:59], v[128:143]
    v_mfma_f32_32x32x16_bf16 v[144:159], v[20:23], v[56:59], v[144:159]
    v_mfma_f32_32x32x16_bf16 v[160:175], v[24:27], v[56:59], v[160:175]
    v_mfma_f32_32x32x16_bf16 v[176:191], v[28:31], v[56:59], v[176:191]
    global_load_dwordx4 v[56:59], v4, s[16:17] offset:0 sc1
    ds_read_b64_tr_b16 v[8:9], v1 offset:51200
    ds_read_b64_tr_b16 v[10:11], v1 offset:51456
    ds_read_b64_tr_b16 v[12:13], v1 offset:55296
    ds_read_b64_tr_b16 v[14:15], v1 offset:55552
    ds_read_b64_tr_b16 v[16:17], v1 offset:59392
    ds_read_b64_tr_b16 v[18:19], v1 offset:59648
    ds_read_b64_tr_b16 v[20:21], v1 offset:63488
    ds_read_b64_tr_b16 v[22:23], v1 offset:63744
    ds_read_b64_tr_b16 v[24:25], v5 offset:18432
    ds_read_b64_tr_b16 v[26:27], v5 offset:18688
    ds_read_b64_tr_b16 v[28:29], v5 offset:22528
    ds_read_b64_tr_b16 v[30:31], v5 offset:22784
    s_waitcnt vmcnt(19)
    s_waitcnt lgkmcnt(12)
    v_mfma_f32_32x32x16_bf16 v[96:111], v[32:35], v[60:63], v[96:111]
    v_mfma_f32_32x32x16_bf16 v[112:127], v[36:39], v[60:63], v[112:127]
    v_mfma_f32_32x32x16_bf16 v[128:143], v[40:43], v[60:63], v[128:143]
    v_mfma_f32_32x32x16_bf16 v[144:159], v[44:47], v[60:63], v[144:159]
    v_mfma_f32_32x32x16_bf16 v[160:175], v[48:51], v[60:63], v[160:175]
    v_mfma_f32_32x32x16_bf16 v[176:191], v[52:55], v[60:63], v[176:191]
    global_load_dwordx4 v[60:63], v4, s[16:17] offset:1024 sc1
    ds_read_b64_tr_b16 v[32:33], v1 offset:52224
    ds_read_b64_tr_b16 v[34:35], v1 offset:52480
    ds_read_b64_tr_b16 v[36:37], v1 offset:56320
    ds_read_b64_tr_b16 v[38:39], v1 offset:56576
    ds_read_b64_tr_b16 v[40:41], v1 offset:60416
    ds_read_b64_tr_b16 v[42:43], v1 offset:60672
    ds_read_b64_tr_b16 v[44:45], v1 offset:64512
    ds_read_b64_tr_b16 v[46:47], v1 offset:64768
    ds_read_b64_tr_b16 v[48:49], v5 offset:19456
    ds_read_b64_tr_b16 v[50:51], v5 offset:19712
    ds_read_b64_tr_b16 v[52:53], v5 offset:23552
    ds_read_b64_tr_b16 v[54:55], v5 offset:23808
    s_waitcnt vmcnt(19)
    s_waitcnt lgkmcnt(12)
    v_mfma_f32_32x32x16_bf16 v[96:111], v[8:11], v[64:67], v[96:111]
    v_mfma_f32_32x32x16_bf16 v[112:127], v[12:15], v[64:67], v[112:127]
    v_mfma_f32_32x32x16_bf16 v[128:143], v[16:19], v[64:67], v[128:143]
    v_mfma_f32_32x32x16_bf16 v[144:159], v[20:23], v[64:67], v[144:159]
    v_mfma_f32_32x32x16_bf16 v[160:175], v[24:27], v[64:67], v[160:175]
    v_mfma_f32_32x32x16_bf16 v[176:191], v[28:31], v[64:67], v[176:191]
    global_load_dwordx4 v[64:67], v4, s[16:17] offset:2048 sc1
    s_waitcnt vmcnt(19)
    s_waitcnt lgkmcnt(0)
    v_mfma_f32_32x32x16_bf16 v[96:111], v[32:35], v[68:71], v[96:111]
    v_mfma_f32_32x32x16_bf16 v[112:127], v[36:39], v[68:71], v[112:127]
    v_mfma_f32_32x32x16_bf16 v[128:143], v[40:43], v[68:71], v[128:143]
    v_mfma_f32_32x32x16_bf16 v[144:159], v[44:47], v[68:71], v[144:159]
    v_mfma_f32_32x32x16_bf16 v[160:175], v[48:51], v[68:71], v[160:175]
    v_mfma_f32_32x32x16_bf16 v[176:191], v[52:55], v[68:71], v[176:191]
    global_load_dwordx4 v[68:71], v4, s[16:17] offset:3072 sc1
    s_add_u32 s16, s16, 4096
    s_addc_u32 s17, s17, 0
    s_barrier
    s_add_u32 m0, s70, 49152
    v_add_u32 v2, s76, v3
    global_load_lds_dwordx4 v2, s[14:15]
    s_add_u32 m0, s71, 49152
    v_add_u32 v2, s77, v3
    global_load_lds_dwordx4 v2, s[14:15]
    s_add_u32 m0, s72, 49152
    v_add_u32 v2, s78, v3
    global_load_lds_dwordx4 v2, s[14:15]
    s_add_u32 m0, s73, 49152
    v_add_u32 v2, s79, v3
    global_load_lds_dwordx4 v2, s[14:15]
    s_add_u32 m0, s74, 49152
    v_add_u32 v2, s80, v3
    global_load_lds_dwordx4 v2, s[14:15]
    s_add_u32 m0, s75, 49152
    v_add_u32 v2, s81, v3
    global_load_lds_dwordx4 v2, s[14:15]
    s_add_u32 s14, s14, 73728
    s_addc_u32 s15, s15, 0
    ds_read_b64_tr_b16 v[8:9], v5 offset:24576
    ds_read_b64_tr_b16 v[10:11], v5 offset:24832
    ds_read_b64_tr_b16 v[12:13], v5 offset:28672
    ds_read_b64_tr_b16 v[14:15], v5 offset:28928
    ds_read_b64_tr_b16 v[16:17], v5 offset:32768
    ds_read_b64_tr_b16 v[18:19], v5 offset:33024
    ds_read_b64_tr_b16 v[20:21], v5 offset:36864
    ds_read_b64_tr_b16 v[22:23], v5 offset:37120
    ds_read_b64_tr_b16 v[24:25], v5 offset:40960
    ds_read_b64_tr_b16 v[26:27], v5 offset:41216
    ds_read_b64_tr_b16 v[28:29], v5 offset:45056
    ds_read_b64_tr_b16 v[30:31], v5 offset:45312
    ds_read_b64_tr_b16 v[32:33], v5 offset:25600
    ds_read_b64_tr_b16 v[34:35], v5 offset:25856
    ds_read_b64_tr_b16 v[36:37], v5 offset:29696
    ds_read_b64_tr_b16 v[38:39], v5 offset:29952
    ds_read_b64_tr_b16 v[40:41], v5 offset:33792
    ds_read_b64_tr_b16 v[42:43], v5 offset:34048
    ds_read_b64_tr_b16 v[44:45], v5 offset:37888
    ds_read_b64_tr_b16 v[46:47], v5 offset:38144
    ds_read_b64_tr_b16 v[48:49], v5 offset:41984
    ds_read_b64_tr_b16 v[50:51], v5 offset:42240
    ds_read_b64_tr_b16 v[52:53], v5 offset:46080
    ds_read_b64_tr_b16 v[54:55], v5 offset:46336
    s_waitcnt vmcnt(19)
    s_waitcnt lgkmcnt(12)
    v_mfma_f32_32x32x16_bf16 v[96:111], v[8:11], v[72:75], v[96:111]
    v_mfma_f32_32x32x16_bf16 v[112:127], v[12:15], v[72:75], v[112:127]
    v_mfma_f32_32x32x16_bf16 v[128:143], v[16:19], v[72:75], v[128:143]
    v_mfma_f32_32x32x16_bf16 v[144:159], v[20:23], v[72:75], v[144:159]
    v_mfma_f32_32x32x16_bf16 v[160:175], v[24:27], v[72:75], v[160:175]
    v_mfma_f32_32x32x16_bf16 v[176:191], v[28:31], v[72:75], v[176:191]
    global_load_dwordx4 v[72:75], v4, s[16:17] offset:0 sc1
    ds_read_b64_tr_b16 v[8:9], v5 offset:26624
    ds_read_b64_tr_b16 v[10:11], v5 offset:26880
    ds_read_b64_tr_b16 v[12:13], v5 offset:30720
    ds_read_b64_tr_b16 v[14:15], v5 offset:30976
    ds_read_b64_tr_b16 v[16:17], v5 offset:34816
    ds_read_b64_tr_b16 v[18:19], v5 offset:35072
    ds_read_b64_tr_b16 v[20:21], v5 offset:38912
    ds_read_b64_tr_b16 v[22:23], v5 offset:39168
    ds_read_b64_tr_b16 v[24:25], v5 offset:43008
    ds_read_b64_tr_b16 v[26:27], v5 offset:43264
    ds_read_b64_tr_b16 v[28:29], v5 offset:47104
    ds_read_b64_tr_b16 v[30:31], v5 offset:47360
    s_waitcnt vmcnt(19)
    s_waitcnt lgkmcnt(12)
    v_mfma_f32_32x32x16_bf16 v[96:111], v[32:35], v[76:79], v[96:111]
    v_mfma_f32_32x32x16_bf16 v[112:127], v[36:39], v[76:79], v[112:127]
    v_mfma_f32_32x32x16_bf16 v[128:143], v[40:43], v[76:79], v[128:143]
    v_mfma_f32_32x32x16_bf16 v[144:159], v[44:47], v[76:79], v[144:159]
    v_mfma_f32_32x32x16_bf16 v[160:175], v[48:51], v[76:79], v[160:175]
    v_mfma_f32_32x32x16_bf16 v[176:191], v[52:55], v[76:79], v[176:191]
    global_load_dwordx4 v[76:79], v4, s[16:17] offset:1024 sc1
    ds_read_b64_tr_b16 v[32:33], v5 offset:27648
    ds_read_b64_tr_b16 v[34:35], v5 offset:27904
    ds_read_b64_tr_b16 v[36:37], v5 offset:31744
    ds_read_b64_tr_b16 v[38:39], v5 offset:32000
    ds_read_b64_tr_b16 v[40:41], v5 offset:35840
    ds_read_b64_tr_b16 v[42:43], v5 offset:36096
    ds_read_b64_tr_b16 v[44:45], v5 offset:39936
    ds_read_b64_tr_b16 v[46:47], v5 offset:40192
    ds_read_b64_tr_b16 v[48:49], v5 offset:44032
    ds_read_b64_tr_b16 v[50:51], v5 offset:44288
    ds_read_b64_tr_b16 v[52:53], v5 offset:48128
    ds_read_b64_tr_b16 v[54:55], v5 offset:48384
    s_waitcnt vmcnt(19)
    s_waitcnt lgkmcnt(12)
    v_mfma_f32_32x32x16_bf16 v[96:111], v[8:11], v[80:83], v[96:111]
    v_mfma_f32_32x32x16_bf16 v[112:127], v[12:15], v[80:83], v[112:127]
    v_mfma_f32_32x32x16_bf16 v[128:143], v[16:19], v[80:83], v[128:143]
    v_mfma_f32_32x32x16_bf16 v[144:159], v[20:23], v[80:83], v[144:159]
    v_mfma_f32_32x32x16_bf16 v[160:175], v[24:27], v[80:83], v[160:175]
    v_mfma_f32_32x32x16_bf16 v[176:191], v[28:31], v[80:83], v[176:191]
    global_load_dwordx4 v[80:83], v4, s[16:17] offset:2048 sc1
    s_waitcnt vmcnt(19)
    s_waitcnt lgkmcnt(0)
    v_mfma_f32_32x32x16_bf16 v[96:111], v[32:35], v[84:87], v[96:111]
    v_mfma_f32_32x32x16_bf16 v[112:127], v[36:39], v[84:87], v[112:127]
    v_mfma_f32_32x32x16_bf16 v[128:143], v[40:43], v[84:87], v[128:143]
    v_mfma_f32_32x32x16_bf16 v[144:159], v[44:47], v[84:87], v[144:159]
    v_mfma_f32_32x32x16_bf16 v[160:175], v[48:51], v[84:87], v[160:175]
    v_mfma_f32_32x32x16_bf16 v[176:191], v[52:55], v[84:87], v[176:191]
    global_load_dwordx4 v[84:87], v4, s[16:17] offset:3072 sc1
    s_add_u32 s16, s16, 4096
    s_addc_u32 s17, s17, 0
    s_barrier
    s_add_u32 m0, s70, 73728
    v_add_u32 v2, s76, v3
    global_load_lds_dwordx4 v2, s[14:15]
    s_add_u32 m0, s71, 73728
    v_add_u32 v2, s77, v3
    global_load_lds_dwordx4 v2, s[14:15]
    s_add_u32 m0, s72, 73728
    v_add_u32 v2, s78, v3
    global_load_lds_dwordx4 v2, s[14:15]
    s_add_u32 m0, s73, 73728
    v_add_u32 v2, s79, v3
    global_load_lds_dwordx4 v2, s[14:15]
    s_add_u32 m0, s74, 73728
    v_add_u32 v2, s80, v3
    global_load_lds_dwordx4 v2, s[14:15]
    s_add_u32 m0, s75, 73728
    v_add_u32 v2, s81, v3
    global_load_lds_dwordx4 v2, s[14:15]
    s_add_u32 s14, s14, 73728
    s_addc_u32 s15, s15, 0
    ds_read_b64_tr_b16 v[8:9], v1 offset:0
    ds_read_b64_tr_b16 v[10:11], v1 offset:256
    ds_read_b64_tr_b16 v[12:13], v1 offset:4096
    ds_read_b64_tr_b16 v[14:15], v1 offset:4352
    ds_read_b64_tr_b16 v[16:17], v1 offset:8192
    ds_read_b64_tr_b16 v[18:19], v1 offset:8448
    ds_read_b64_tr_b16 v[20:21], v1 offset:12288
    ds_read_b64_tr_b16 v[22:23], v1 offset:12544
    ds_read_b64_tr_b16 v[24:25], v1 offset:16384
    ds_read_b64_tr_b16 v[26:27], v1 offset:16640
    ds_read_b64_tr_b16 v[28:29], v1 offset:20480
    ds_read_b64_tr_b16 v[30:31], v1 offset:20736
    ds_read_b64_tr_b16 v[32:33], v1 offset:1024
    ds_read_b64_tr_b16 v[34:35], v1 offset:1280
    ds_read_b64_tr_b16 v[36:37], v1 offset:5120
    ds_read_b64_tr_b16 v[38:39], v1 offset:5376
    ds_read_b64_tr_b16 v[40:41], v1 offset:9216
    ds_read_b64_tr_b16 v[42:43], v1 offset:9472
    ds_read_b64_tr_b16 v[44:45], v1 offset:13312
    ds_read_b64_tr_b16 v[46:47], v1 offset:13568
    ds_read_b64_tr_b16 v[48:49], v1 offset:17408
    ds_read_b64_tr_b16 v[50:51], v1 offset:17664
    ds_read_b64_tr_b16 v[52:53], v1 offset:21504
    ds_read_b64_tr_b16 v[54:55], v1 offset:21760
    s_waitcnt vmcnt(19)
    s_waitcnt lgkmcnt(12)
    v_mfma_f32_32x32x16_bf16 v[96:111], v[8:11], v[56:59], v[96:111]
    v_mfma_f32_32x32x16_bf16 v[112:127], v[12:15], v[56:59], v[112:127]
    v_mfma_f32_32x32x16_bf16 v[128:143], v[16:19], v[56:59], v[128:143]
    v_mfma_f32_32x32x16_bf16 v[144:159], v[20:23], v[56:59], v[144:159]
    v_mfma_f32_32x32x16_bf16 v[160:175], v[24:27], v[56:59], v[160:175]
    v_mfma_f32_32x32x16_bf16 v[176:191], v[28:31], v[56:59], v[176:191]
    global_load_dwordx4 v[56:59], v4, s[16:17] offset:0 sc1
    ds_read_b64_tr_b16 v[8:9], v1 offset:2048
    ds_read_b64_tr_b16 v[10:11], v1 offset:2304
    ds_read_b64_tr_b16 v[12:13], v1 offset:6144
    ds_read_b64_tr_b16 v[14:15], v1 offset:6400
    ds_read_b64_tr_b16 v[16:17], v1 offset:10240
    ds_read_b64_tr_b16 v[18:19], v1 offset:10496
    ds_read_b64_tr_b16 v[20:21], v1 offset:14336
    ds_read_b64_tr_b16 v[22:23], v1 offset:14592
    ds_read_b64_tr_b16 v[24:25], v1 offset:18432
    ds_read_b64_tr_b16 v[26:27], v1 offset:18688
    ds_read_b64_tr_b16 v[28:29], v1 offset:22528
    ds_read_b64_tr_b16 v[30:31], v1 offset:22784
    s_waitcnt vmcnt(19)
    s_waitcnt lgkmcnt(12)
    v_mfma_f32_32x32x16_bf16 v[96:111], v[32:35], v[60:63], v[96:111]
    v_mfma_f32_32x32x16_bf16 v[112:127], v[36:39], v[60:63], v[112:127]
    v_mfma_f32_32x32x16_bf16 v[128:143], v[40:43], v[60:63], v[128:143]
    v_mfma_f32_32x32x16_bf16 v[144:159], v[44:47], v[60:63], v[144:159]
    v_mfma_f32_32x32x16_bf16 v[160:175], v[48:51], v[60:63], v[160:175]
    v_mfma_f32_32x32x16_bf16 v[176:191], v[52:55], v[60:63], v[176:191]
    global_load_dwordx4 v[60:63], v4, s[16:17] offset:1024 sc1
    ds_read_b64_tr_b16 v[32:33], v1 offset:3072
    ds_read_b64_tr_b16 v[34:35], v1 offset:3328
    ds_read_b64_tr_b16 v[36:37], v1 offset:7168
    ds_read_b64_tr_b16 v[38:39], v1 offset:7424
    ds_read_b64_tr_b16 v[40:41], v1 offset:11264
    ds_read_b64_tr_b16 v[42:43], v1 offset:11520
    ds_read_b64_tr_b16 v[44:45], v1 offset:15360
    ds_read_b64_tr_b16 v[46:47], v1 offset:15616
    ds_read_b64_tr_b16 v[48:49], v1 offset:19456
    ds_read_b64_tr_b16 v[50:51], v1 offset:19712
    ds_read_b64_tr_b16 v[52:53], v1 offset:23552
    ds_read_b64_tr_b16 v[54:55], v1 offset:23808
    s_waitcnt vmcnt(19)
    s_waitcnt lgkmcnt(12)
    v_mfma_f32_32x32x16_bf16 v[96:111], v[8:11], v[64:67], v[96:111]
    v_mfma_f32_32x32x16_bf16 v[112:127], v[12:15], v[64:67], v[112:127]
    v_mfma_f32_32x32x16_bf16 v[128:143], v[16:19], v[64:67], v[128:143]
    v_mfma_f32_32x32x16_bf16 v[144:159], v[20:23], v[64:67], v[144:159]
    v_mfma_f32_32x32x16_bf16 v[160:175], v[24:27], v[64:67], v[160:175]
    v_mfma_f32_32x32x16_bf16 v[176:191], v[28:31], v[64:67], v[176:191]
    global_load_dwordx4 v[64:67], v4, s[16:17] offset:2048 sc1
    s_waitcnt vmcnt(19)
    s_waitcnt lgkmcnt(0)
    v_mfma_f32_32x32x16_bf16 v[96:111], v[32:35], v[68:71], v[96:111]
    v_mfma_f32_32x32x16_bf16 v[112:127], v[36:39], v[68:71], v[112:127]
    v_mfma_f32_32x32x16_bf16 v[128:143], v[40:43], v[68:71], v[128:143]
    v_mfma_f32_32x32x16_bf16 v[144:159], v[44:47], v[68:71], v[144:159]
    v_mfma_f32_32x32x16_bf16 v[160:175], v[48:51], v[68:71], v[160:175]
    v_mfma_f32_32x32x16_bf16 v[176:191], v[52:55], v[68:71], v[176:191]
    global_load_dwordx4 v[68:71], v4, s[16:17] offset:3072 sc1
    s_add_u32 s16, s16, 4096
    s_addc_u32 s17, s17, 0
    s_barrier
    s_add_u32 m0, s70, 0
    v_add_u32 v2, s76, v3
    global_load_lds_dwordx4 v2, s[14:15]
    s_add_u32 m0, s71, 0
    v_add_u32 v2, s77, v3
    global_load_lds_dwordx4 v2, s[14:15]
    s_add_u32 m0, s72, 0
    v_add_u32 v2, s78, v3
    global_load_lds_dwordx4 v2, s[14:15]
    s_add_u32 m0, s73, 0
    v_add_u32 v2, s79, v3
    global_load_lds_dwordx4 v2, s[14:15]
    s_add_u32 m0, s74, 0
    v_add_u32 v2, s80, v3
    global_load_lds_dwordx4 v2, s[14:15]
    s_add_u32 m0, s75, 0
    v_add_u32 v2, s81, v3
    global_load_lds_dwordx4 v2, s[14:15]
    s_add_u32 s14, s14, 73728
    s_addc_u32 s15, s15, 0
    ds_read_b64_tr_b16 v[8:9], v1 offset:24576
    ds_read_b64_tr_b16 v[10:11], v1 offset:24832
    ds_read_b64_tr_b16 v[12:13], v1 offset:28672
    ds_read_b64_tr_b16 v[14:15], v1 offset:28928
    ds_read_b64_tr_b16 v[16:17], v1 offset:32768
    ds_read_b64_tr_b16 v[18:19], v1 offset:33024
    ds_read_b64_tr_b16 v[20:21], v1 offset:36864
    ds_read_b64_tr_b16 v[22:23], v1 offset:37120
    ds_read_b64_tr_b16 v[24:25], v1 offset:40960
    ds_read_b64_tr_b16 v[26:27], v1 offset:41216
    ds_read_b64_tr_b16 v[28:29], v1 offset:45056
    ds_read_b64_tr_b16 v[30:31], v1 offset:45312
    ds_read_b64_tr_b16 v[32:33], v1 offset:25600
    ds_read_b64_tr_b16 v[34:35], v1 offset:25856
    ds_read_b64_tr_b16 v[36:37], v1 offset:29696
    ds_read_b64_tr_b16 v[38:39], v1 offset:29952
    ds_read_b64_tr_b16 v[40:41], v1 offset:33792
    ds_read_b64_tr_b16 v[42:43], v1 offset:34048
    ds_read_b64_tr_b16 v[44:45], v1 offset:37888
    ds_read_b64_tr_b16 v[46:47], v1 offset:38144
    ds_read_b64_tr_b16 v[48:49], v1 offset:41984
    ds_read_b64_tr_b16 v[50:51], v1 offset:42240
    ds_read_b64_tr_b16 v[52:53], v1 offset:46080
    ds_read_b64_tr_b16 v[54:55], v1 offset:46336
    s_waitcnt vmcnt(19)
    s_waitcnt lgkmcnt(12)
    v_mfma_f32_32x32x16_bf16 v[96:111], v[8:11], v[72:75], v[96:111]
    v_mfma_f32_32x32x16_bf16 v[112:127], v[12:15], v[72:75], v[112:127]
    v_mfma_f32_32x32x16_bf16 v[128:143], v[16:19], v[72:75], v[128:143]
    v_mfma_f32_32x32x16_bf16 v[144:159], v[20:23], v[72:75], v[144:159]
    v_mfma_f32_32x32x16_bf16 v[160:175], v[24:27], v[72:75], v[160:175]
    v_mfma_f32_32x32x16_bf16 v[176:191], v[28:31], v[72:75], v[176:191]
    global_load_dwordx4 v[72:75], v4, s[16:17] offset:0 sc1
    ds_read_b64_tr_b16 v[8:9], v1 offset:26624
    ds_read_b64_tr_b16 v[10:11], v1 offset:26880
    ds_read_b64_tr_b16 v[12:13], v1 offset:30720
    ds_read_b64_tr_b16 v[14:15], v1 offset:30976
    ds_read_b64_tr_b16 v[16:17], v1 offset:34816
    ds_read_b64_tr_b16 v[18:19], v1 offset:35072
    ds_read_b64_tr_b16 v[20:21], v1 offset:38912
    ds_read_b64_tr_b16 v[22:23], v1 offset:39168
    ds_read_b64_tr_b16 v[24:25], v1 offset:43008
    ds_read_b64_tr_b16 v[26:27], v1 offset:43264
    ds_read_b64_tr_b16 v[28:29], v1 offset:47104
    ds_read_b64_tr_b16 v[30:31], v1 offset:47360
    s_waitcnt vmcnt(19)
    s_waitcnt lgkmcnt(12)
    v_mfma_f32_32x32x16_bf16 v[96:111], v[32:35], v[76:79], v[96:111]
    v_mfma_f32_32x32x16_bf16 v[112:127], v[36:39], v[76:79], v[112:127]
    v_mfma_f32_32x32x16_bf16 v[128:143], v[40:43], v[76:79], v[128:143]
    v_mfma_f32_32x32x16_bf16 v[144:159], v[44:47], v[76:79], v[144:159]
    v_mfma_f32_32x32x16_bf16 v[160:175], v[48:51], v[76:79], v[160:175]
    v_mfma_f32_32x32x16_bf16 v[176:191], v[52:55], v[76:79], v[176:191]
    global_load_dwordx4 v[76:79], v4, s[16:17] offset:1024 sc1
    ds_read_b64_tr_b16 v[32:33], v1 offset:27648
    ds_read_b64_tr_b16 v[34:35], v1 offset:27904
    ds_read_b64_tr_b16 v[36:37], v1 offset:31744
    ds_read_b64_tr_b16 v[38:39], v1 offset:32000
    ds_read_b64_tr_b16 v[40:41], v1 offset:35840
    ds_read_b64_tr_b16 v[42:43], v1 offset:36096
    ds_read_b64_tr_b16 v[44:45], v1 offset:39936
    ds_read_b64_tr_b16 v[46:47], v1 offset:40192
    ds_read_b64_tr_b16 v[48:49], v1 offset:44032
    ds_read_b64_tr_b16 v[50:51], v1 offset:44288
    ds_read_b64_tr_b16 v[52:53], v1 offset:48128
    ds_read_b64_tr_b16 v[54:55], v1 offset:48384
    s_waitcnt vmcnt(19)
    s_waitcnt lgkmcnt(12)
    v_mfma_f32_32x32x16_bf16 v[96:111], v[8:11], v[80:83], v[96:111]
    v_mfma_f32_32x32x16_bf16 v[112:127], v[12:15], v[80:83], v[112:127]
    v_mfma_f32_32x32x16_bf16 v[128:143], v[16:19], v[80:83], v[128:143]
    v_mfma_f32_32x32x16_bf16 v[144:159], v[20:23], v[80:83], v[144:159]
    v_mfma_f32_32x32x16_bf16 v[160:175], v[24:27], v[80:83], v[160:175]
    v_mfma_f32_32x32x16_bf16 v[176:191], v[28:31], v[80:83], v[176:191]
    global_load_dwordx4 v[80:83], v4, s[16:17] offset:2048 sc1
    s_waitcnt vmcnt(19)
    s_waitcnt lgkmcnt(0)
    v_mfma_f32_32x32x16_bf16 v[96:111], v[32:35], v[84:87], v[96:111]
    v_mfma_f32_32x32x16_bf16 v[112:127], v[36:39], v[84:87], v[112:127]
    v_mfma_f32_32x32x16_bf16 v[128:143], v[40:43], v[84:87], v[128:143]
    v_mfma_f32_32x32x16_bf16 v[144:159], v[44:47], v[84:87], v[144:159]
    v_mfma_f32_32x32x16_bf16 v[160:175], v[48:51], v[84:87], v[160:175]
    v_mfma_f32_32x32x16_bf16 v[176:191], v[52:55], v[84:87], v[176:191]
    global_load_dwordx4 v[84:87], v4, s[16:17] offset:3072 sc1
    s_add_u32 s16, s16, 4096
    s_addc_u32 s17, s17, 0
    s_barrier
    s_add_u32 m0, s70, 24576
    v_add_u32 v2, s76, v3
    global_load_lds_dwordx4 v2, s[14:15]
    s_add_u32 m0, s71, 24576
    v_add_u32 v2, s77, v3
    global_load_lds_dwordx4 v2, s[14:15]
    s_add_u32 m0, s72, 24576
    v_add_u32 v2, s78, v3
    global_load_lds_dwordx4 v2, s[14:15]
    s_add_u32 m0, s73, 24576
    v_add_u32 v2, s79, v3
    global_load_lds_dwordx4 v2, s[14:15]
    s_add_u32 m0, s74, 24576
    v_add_u32 v2, s80, v3
    global_load_lds_dwordx4 v2, s[14:15]
    s_add_u32 m0, s75, 24576
    v_add_u32 v2, s81, v3
    global_load_lds_dwordx4 v2, s[14:15]
    s_add_u32 s14, s14, 73728
    s_addc_u32 s15, s15, 0
    ds_read_b64_tr_b16 v[8:9], v1 offset:49152
    ds_read_b64_tr_b16 v[10:11], v1 offset:49408
    ds_read_b64_tr_b16 v[12:13], v1 offset:53248
    ds_read_b64_tr_b16 v[14:15], v1 offset:53504
    ds_read_b64_tr_b16 v[16:17], v1 offset:57344
    ds_read_b64_tr_b16 v[18:19], v1 offset:57600
    ds_read_b64_tr_b16 v[20:21], v1 offset:61440
    ds_read_b64_tr_b16 v[22:23], v1 offset:61696
    ds_read_b64_tr_b16 v[24:25], v5 offset:16384
    ds_read_b64_tr_b16 v[26:27], v5 offset:16640
    ds_read_b64_tr_b16 v[28:29], v5 offset:20480
    ds_read_b64_tr_b16 v[30:31], v5 offset:20736
    ds_read_b64_tr_b16 v[32:33], v1 offset:50176
    ds_read_b64_tr_b16 v[34:35], v1 offset:50432
    ds_read_b64_tr_b16 v[36:37], v1 offset:54272
    ds_read_b64_tr_b16 v[38:39], v1 offset:54528
    ds_read_b64_tr_b16 v[40:41], v1 offset:58368
    ds_read_b64_tr_b16 v[42:43], v1 offset:58624
    ds_read_b64_tr_b16 v[44:45], v1 offset:62464
    ds_read_b64_tr_b16 v[46:47], v1 offset:62720
    ds_read_b64_tr_b16 v[48:49], v5 offset:17408
    ds_read_b64_tr_b16 v[50:51], v5 offset:17664
    ds_read_b64_tr_b16 v[52:53], v5 offset:21504
    ds_read_b64_tr_b16 v[54:55], v5 offset:21760
    s_waitcnt vmcnt(19)
    s_waitcnt lgkmcnt(12)
    v_mfma_f32_32x32x16_bf16 v[96:111], v[8:11], v[56:59], v[96:111]
    v_mfma_f32_32x32x16_bf16 v[112:127], v[12:15], v[56:59], v[112:127]
    v_mfma_f32_32x32x16_bf16 v[128:143], v[16:19], v[56:59], v[128:143]
    v_mfma_f32_32x32x16_bf16 v[144:159], v[20:23], v[56:59], v[144:159]
    v_mfma_f32_32x32x16_bf16 v[160:175], v[24:27], v[56:59], v[160:175]
    v_mfma_f32_32x32x16_bf16 v[176:191], v[28:31], v[56:59], v[176:191]
    global_load_dwordx4 v[56:59], v4, s[16:17] offset:0 sc1
    ds_read_b64_tr_b16 v[8:9], v1 offset:51200
    ds_read_b64_tr_b16 v[10:11], v1 offset:51456
    ds_read_b64_tr_b16 v[12:13], v1 offset:55296
    ds_read_b64_tr_b16 v[14:15], v1 offset:55552
    ds_read_b64_tr_b16 v[16:17], v1 offset:59392
    ds_read_b64_tr_b16 v[18:19], v1 offset:59648
    ds_read_b64_tr_b16 v[20:21], v1 offset:63488
    ds_read_b64_tr_b16 v[22:23], v1 offset:63744
    ds_read_b64_tr_b16 v[24:25], v5 offset:18432
    ds_read_b64_tr_b16 v[26:27], v5 offset:18688
    ds_read_b64_tr_b16 v[28:29], v5 offset:22528
    ds_read_b64_tr_b16 v[30:31], v5 offset:22784
    s_waitcnt vmcnt(19)
    s_waitcnt lgkmcnt(12)
    v_mfma_f32_32x32x16_bf16 v[96:111], v[32:35], v[60:63], v[96:111]
    v_mfma_f32_32x32x16_bf16 v[112:127], v[36:39], v[60:63], v[112:127]
    v_mfma_f32_32x32x16_bf16 v[128:143], v[40:43], v[60:63], v[128:143]
    v_mfma_f32_32x32x16_bf16 v[144:159], v[44:47], v[60:63], v[144:159]
    v_mfma_f32_32x32x16_bf16 v[160:175], v[48:51], v[60:63], v[160:175]
    v_mfma_f32_32x32x16_bf16 v[176:191], v[52:55], v[60:63], v[176:191]
    global_load_dwordx4 v[60:63], v4, s[16:17] offset:1024 sc1
    ds_read_b64_tr_b16 v[32:33], v1 offset:52224
    ds_read_b64_tr_b16 v[34:35], v1 offset:52480
    ds_read_b64_tr_b16 v[36:37], v1 offset:56320
    ds_read_b64_tr_b16 v[38:39], v1 offset:56576
    ds_read_b64_tr_b16 v[40:41], v1 offset:60416
    ds_read_b64_tr_b16 v[42:43], v1 offset:60672
    ds_read_b64_tr_b16 v[44:45], v1 offset:64512
    ds_read_b64_tr_b16 v[46:47], v1 offset:64768
    ds_read_b64_tr_b16 v[48:49], v5 offset:19456
    ds_read_b64_tr_b16 v[50:51], v5 offset:19712
    ds_read_b64_tr_b16 v[52:53], v5 offset:23552
    ds_read_b64_tr_b16 v[54:55], v5 offset:23808
    s_waitcnt vmcnt(19)
    s_waitcnt lgkmcnt(12)
    v_mfma_f32_32x32x16_bf16 v[96:111], v[8:11], v[64:67], v[96:111]
    v_mfma_f32_32x32x16_bf16 v[112:127], v[12:15], v[64:67], v[112:127]
    v_mfma_f32_32x32x16_bf16 v[128:143], v[16:19], v[64:67], v[128:143]
    v_mfma_f32_32x32x16_bf16 v[144:159], v[20:23], v[64:67], v[144:159]
    v_mfma_f32_32x32x16_bf16 v[160:175], v[24:27], v[64:67], v[160:175]
    v_mfma_f32_32x32x16_bf16 v[176:191], v[28:31], v[64:67], v[176:191]
    global_load_dwordx4 v[64:67], v4, s[16:17] offset:2048 sc1
    s_waitcnt vmcnt(19)
    s_waitcnt lgkmcnt(0)
    v_mfma_f32_32x32x16_bf16 v[96:111], v[32:35], v[68:71], v[96:111]
    v_mfma_f32_32x32x16_bf16 v[112:127], v[36:39], v[68:71], v[112:127]
    v_mfma_f32_32x32x16_bf16 v[128:143], v[40:43], v[68:71], v[128:143]
    v_mfma_f32_32x32x16_bf16 v[144:159], v[44:47], v[68:71], v[144:159]
    v_mfma_f32_32x32x16_bf16 v[160:175], v[48:51], v[68:71], v[160:175]
    v_mfma_f32_32x32x16_bf16 v[176:191], v[52:55], v[68:71], v[176:191]
    global_load_dwordx4 v[68:71], v4, s[16:17] offset:3072 sc1
    s_add_u32 s16, s16, 4096
    s_addc_u32 s17, s17, 0
    s_barrier
    ds_read_b64_tr_b16 v[8:9], v5 offset:24576
    ds_read_b64_tr_b16 v[10:11], v5 offset:24832
    ds_read_b64_tr_b16 v[12:13], v5 offset:28672
    ds_read_b64_tr_b16 v[14:15], v5 offset:28928
    ds_read_b64_tr_b16 v[16:17], v5 offset:32768
    ds_read_b64_tr_b16 v[18:19], v5 offset:33024
    ds_read_b64_tr_b16 v[20:21], v5 offset:36864
    ds_read_b64_tr_b16 v[22:23], v5 offset:37120
    ds_read_b64_tr_b16 v[24:25], v5 offset:40960
    ds_read_b64_tr_b16 v[26:27], v5 offset:41216
    ds_read_b64_tr_b16 v[28:29], v5 offset:45056
    ds_read_b64_tr_b16 v[30:31], v5 offset:45312
    ds_read_b64_tr_b16 v[32:33], v5 offset:25600
    ds_read_b64_tr_b16 v[34:35], v5 offset:25856
    ds_read_b64_tr_b16 v[36:37], v5 offset:29696
    ds_read_b64_tr_b16 v[38:39], v5 offset:29952
    ds_read_b64_tr_b16 v[40:41], v5 offset:33792
    ds_read_b64_tr_b16 v[42:43], v5 offset:34048
    ds_read_b64_tr_b16 v[44:45], v5 offset:37888
    ds_read_b64_tr_b16 v[46:47], v5 offset:38144
    ds_read_b64_tr_b16 v[48:49], v5 offset:41984
    ds_read_b64_tr_b16 v[50:51], v5 offset:42240
    ds_read_b64_tr_b16 v[52:53], v5 offset:46080
    ds_read_b64_tr_b16 v[54:55], v5 offset:46336
    s_waitcnt vmcnt(13)
    s_waitcnt lgkmcnt(12)
    v_mfma_f32_32x32x16_bf16 v[96:111], v[8:11], v[72:75], v[96:111]
    v_mfma_f32_32x32x16_bf16 v[112:127], v[12:15], v[72:75], v[112:127]
    v_mfma_f32_32x32x16_bf16 v[128:143], v[16:19], v[72:75], v[128:143]
    v_mfma_f32_32x32x16_bf16 v[144:159], v[20:23], v[72:75], v[144:159]
    v_mfma_f32_32x32x16_bf16 v[160:175], v[24:27], v[72:75], v[160:175]
    v_mfma_f32_32x32x16_bf16 v[176:191], v[28:31], v[72:75], v[176:191]
    global_load_dwordx4 v[72:75], v4, s[16:17] offset:0 sc1
    ds_read_b64_tr_b16 v[8:9], v5 offset:26624
    ds_read_b64_tr_b16 v[10:11], v5 offset:26880
    ds_read_b64_tr_b16 v[12:13], v5 offset:30720
    ds_read_b64_tr_b16 v[14:15], v5 offset:30976
    ds_read_b64_tr_b16 v[16:17], v5 offset:34816
    ds_read_b64_tr_b16 v[18:19], v5 offset:35072
    ds_read_b64_tr_b16 v[20:21], v5 offset:38912
    ds_read_b64_tr_b16 v[22:23], v5 offset:39168
    ds_read_b64_tr_b16 v[24:25], v5 offset:43008
    ds_read_b64_tr_b16 v[26:27], v5 offset:43264
    ds_read_b64_tr_b16 v[28:29], v5 offset:47104
    ds_read_b64_tr_b16 v[30:31], v5 offset:47360
    s_waitcnt vmcnt(13)
    s_waitcnt lgkmcnt(12)
    v_mfma_f32_32x32x16_bf16 v[96:111], v[32:35], v[76:79], v[96:111]
    v_mfma_f32_32x32x16_bf16 v[112:127], v[36:39], v[76:79], v[112:127]
    v_mfma_f32_32x32x16_bf16 v[128:143], v[40:43], v[76:79], v[128:143]
    v_mfma_f32_32x32x16_bf16 v[144:159], v[44:47], v[76:79], v[144:159]
    v_mfma_f32_32x32x16_bf16 v[160:175], v[48:51], v[76:79], v[160:175]
    v_mfma_f32_32x32x16_bf16 v[176:191], v[52:55], v[76:79], v[176:191]
    global_load_dwordx4 v[76:79], v4, s[16:17] offset:1024 sc1
    ds_read_b64_tr_b16 v[32:33], v5 offset:27648
    ds_read_b64_tr_b16 v[34:35], v5 offset:27904
    ds_read_b64_tr_b16 v[36:37], v5 offset:31744
    ds_read_b64_tr_b16 v[38:39], v5 offset:32000
    ds_read_b64_tr_b16 v[40:41], v5 offset:35840
    ds_read_b64_tr_b16 v[42:43], v5 offset:36096
    ds_read_b64_tr_b16 v[44:45], v5 offset:39936
    ds_read_b64_tr_b16 v[46:47], v5 offset:40192
    ds_read_b64_tr_b16 v[48:49], v5 offset:44032
    ds_read_b64_tr_b16 v[50:51], v5 offset:44288
    ds_read_b64_tr_b16 v[52:53], v5 offset:48128
    ds_read_b64_tr_b16 v[54:55], v5 offset:48384
    s_waitcnt vmcnt(13)
    s_waitcnt lgkmcnt(12)
    v_mfma_f32_32x32x16_bf16 v[96:111], v[8:11], v[80:83], v[96:111]
    v_mfma_f32_32x32x16_bf16 v[112:127], v[12:15], v[80:83], v[112:127]
    v_mfma_f32_32x32x16_bf16 v[128:143], v[16:19], v[80:83], v[128:143]
    v_mfma_f32_32x32x16_bf16 v[144:159], v[20:23], v[80:83], v[144:159]
    v_mfma_f32_32x32x16_bf16 v[160:175], v[24:27], v[80:83], v[160:175]
    v_mfma_f32_32x32x16_bf16 v[176:191], v[28:31], v[80:83], v[176:191]
    global_load_dwordx4 v[80:83], v4, s[16:17] offset:2048 sc1
    s_waitcnt vmcnt(13)
    s_waitcnt lgkmcnt(0)
    v_mfma_f32_32x32x16_bf16 v[96:111], v[32:35], v[84:87], v[96:111]
    v_mfma_f32_32x32x16_bf16 v[112:127], v[36:39], v[84:87], v[112:127]
    v_mfma_f32_32x32x16_bf16 v[128:143], v[40:43], v[84:87], v[128:143]
    v_mfma_f32_32x32x16_bf16 v[144:159], v[44:47], v[84:87], v[144:159]
    v_mfma_f32_32x32x16_bf16 v[160:175], v[48:51], v[84:87], v[160:175]
    v_mfma_f32_32x32x16_bf16 v[176:191], v[52:55], v[84:87], v[176:191]
    global_load_dwordx4 v[84:87], v4, s[16:17] offset:3072 sc1
    s_add_u32 s16, s16, 4096
    s_addc_u32 s17, s17, 0
    s_barrier
    ds_read_b64_tr_b16 v[8:9], v1 offset:0
    ds_read_b64_tr_b16 v[10:11], v1 offset:256
    ds_read_b64_tr_b16 v[12:13], v1 offset:4096
    ds_read_b64_tr_b16 v[14:15], v1 offset:4352
    ds_read_b64_tr_b16 v[16:17], v1 offset:8192
    ds_read_b64_tr_b16 v[18:19], v1 offset:8448
    ds_read_b64_tr_b16 v[20:21], v1 offset:12288
    ds_read_b64_tr_b16 v[22:23], v1 offset:12544
    ds_read_b64_tr_b16 v[24:25], v1 offset:16384
    ds_read_b64_tr_b16 v[26:27], v1 offset:16640
    ds_read_b64_tr_b16 v[28:29], v1 offset:20480
    ds_read_b64_tr_b16 v[30:31], v1 offset:20736
    ds_read_b64_tr_b16 v[32:33], v1 offset:1024
    ds_read_b64_tr_b16 v[34:35], v1 offset:1280
    ds_read_b64_tr_b16 v[36:37], v1 offset:5120
    ds_read_b64_tr_b16 v[38:39], v1 offset:5376
    ds_read_b64_tr_b16 v[40:41], v1 offset:9216
    ds_read_b64_tr_b16 v[42:43], v1 offset:9472
    ds_read_b64_tr_b16 v[44:45], v1 offset:13312
    ds_read_b64_tr_b16 v[46:47], v1 offset:13568
    ds_read_b64_tr_b16 v[48:49], v1 offset:17408
    ds_read_b64_tr_b16 v[50:51], v1 offset:17664
    ds_read_b64_tr_b16 v[52:53], v1 offset:21504
    ds_read_b64_tr_b16 v[54:55], v1 offset:21760
    s_waitcnt vmcnt(7)
    s_waitcnt lgkmcnt(12)
    v_mfma_f32_32x32x16_bf16 v[96:111], v[8:11], v[56:59], v[96:111]
    v_mfma_f32_32x32x16_bf16 v[112:127], v[12:15], v[56:59], v[112:127]
    v_mfma_f32_32x32x16_bf16 v[128:143], v[16:19], v[56:59], v[128:143]
    v_mfma_f32_32x32x16_bf16 v[144:159], v[20:23], v[56:59], v[144:159]
    v_mfma_f32_32x32x16_bf16 v[160:175], v[24:27], v[56:59], v[160:175]
    v_mfma_f32_32x32x16_bf16 v[176:191], v[28:31], v[56:59], v[176:191]
    ds_read_b64_tr_b16 v[8:9], v1 offset:2048
    ds_read_b64_tr_b16 v[10:11], v1 offset:2304
    ds_read_b64_tr_b16 v[12:13], v1 offset:6144
    ds_read_b64_tr_b16 v[14:15], v1 offset:6400
    ds_read_b64_tr_b16 v[16:17], v1 offset:10240
    ds_read_b64_tr_b16 v[18:19], v1 offset:10496
    ds_read_b64_tr_b16 v[20:21], v1 offset:14336
    ds_read_b64_tr_b16 v[22:23], v1 offset:14592
    ds_read_b64_tr_b16 v[24:25], v1 offset:18432
    ds_read_b64_tr_b16 v[26:27], v1 offset:18688
    ds_read_b64_tr_b16 v[28:29], v1 offset:22528
    ds_read_b64_tr_b16 v[30:31], v1 offset:22784
    s_waitcnt vmcnt(6)
    s_waitcnt lgkmcnt(12)
    v_mfma_f32_32x32x16_bf16 v[96:111], v[32:35], v[60:63], v[96:111]
    v_mfma_f32_32x32x16_bf16 v[112:127], v[36:39], v[60:63], v[112:127]
    v_mfma_f32_32x32x16_bf16 v[128:143], v[40:43], v[60:63], v[128:143]
    v_mfma_f32_32x32x16_bf16 v[144:159], v[44:47], v[60:63], v[144:159]
    v_mfma_f32_32x32x16_bf16 v[160:175], v[48:51], v[60:63], v[160:175]
    v_mfma_f32_32x32x16_bf16 v[176:191], v[52:55], v[60:63], v[176:191]
    ds_read_b64_tr_b16 v[32:33], v1 offset:3072
    ds_read_b64_tr_b16 v[34:35], v1 offset:3328
    ds_read_b64_tr_b16 v[36:37], v1 offset:7168
    ds_read_b64_tr_b16 v[38:39], v1 offset:7424
    ds_read_b64_tr_b16 v[40:41], v1 offset:11264
    ds_read_b64_tr_b16 v[42:43], v1 offset:11520
    ds_read_b64_tr_b16 v[44:45], v1 offset:15360
    ds_read_b64_tr_b16 v[46:47], v1 offset:15616
    ds_read_b64_tr_b16 v[48:49], v1 offset:19456
    ds_read_b64_tr_b16 v[50:51], v1 offset:19712
    ds_read_b64_tr_b16 v[52:53], v1 offset:23552
    ds_read_b64_tr_b16 v[54:55], v1 offset:23808
    s_waitcnt vmcnt(5)
    s_waitcnt lgkmcnt(12)
    v_mfma_f32_32x32x16_bf16 v[96:111], v[8:11], v[64:67], v[96:111]
    v_mfma_f32_32x32x16_bf16 v[112:127], v[12:15], v[64:67], v[112:127]
    v_mfma_f32_32x32x16_bf16 v[128:143], v[16:19], v[64:67], v[128:143]
    v_mfma_f32_32x32x16_bf16 v[144:159], v[20:23], v[64:67], v[144:159]
    v_mfma_f32_32x32x16_bf16 v[160:175], v[24:27], v[64:67], v[160:175]
    v_mfma_f32_32x32x16_bf16 v[176:191], v[28:31], v[64:67], v[176:191]
    s_waitcnt vmcnt(4)
    s_waitcnt lgkmcnt(0)
    v_mfma_f32_32x32x16_bf16 v[96:111], v[32:35], v[68:71], v[96:111]
    v_mfma_f32_32x32x16_bf16 v[112:127], v[36:39], v[68:71], v[112:127]
    v_mfma_f32_32x32x16_bf16 v[128:143], v[40:43], v[68:71], v[128:143]
    v_mfma_f32_32x32x16_bf16 v[144:159], v[44:47], v[68:71], v[144:159]
    v_mfma_f32_32x32x16_bf16 v[160:175], v[48:51], v[68:71], v[160:175]
    v_mfma_f32_32x32x16_bf16 v[176:191], v[52:55], v[68:71], v[176:191]
    s_barrier
    ds_read_b64_tr_b16 v[8:9], v1 offset:24576
    ds_read_b64_tr_b16 v[10:11], v1 offset:24832
    ds_read_b64_tr_b16 v[12:13], v1 offset:28672
    ds_read_b64_tr_b16 v[14:15], v1 offset:28928
    ds_read_b64_tr_b16 v[16:17], v1 offset:32768
    ds_read_b64_tr_b16 v[18:19], v1 offset:33024
    ds_read_b64_tr_b16 v[20:21], v1 offset:36864
    ds_read_b64_tr_b16 v[22:23], v1 offset:37120
    ds_read_b64_tr_b16 v[24:25], v1 offset:40960
    ds_read_b64_tr_b16 v[26:27], v1 offset:41216
    ds_read_b64_tr_b16 v[28:29], v1 offset:45056
    ds_read_b64_tr_b16 v[30:31], v1 offset:45312
    ds_read_b64_tr_b16 v[32:33], v1 offset:25600
    ds_read_b64_tr_b16 v[34:35], v1 offset:25856
    ds_read_b64_tr_b16 v[36:37], v1 offset:29696
    ds_read_b64_tr_b16 v[38:39], v1 offset:29952
    ds_read_b64_tr_b16 v[40:41], v1 offset:33792
    ds_read_b64_tr_b16 v[42:43], v1 offset:34048
    ds_read_b64_tr_b16 v[44:45], v1 offset:37888
    ds_read_b64_tr_b16 v[46:47], v1 offset:38144
    ds_read_b64_tr_b16 v[48:49], v1 offset:41984
    ds_read_b64_tr_b16 v[50:51], v1 offset:42240
    ds_read_b64_tr_b16 v[52:53], v1 offset:46080
    ds_read_b64_tr_b16 v[54:55], v1 offset:46336
    s_waitcnt vmcnt(3)
    s_waitcnt lgkmcnt(12)
    v_mfma_f32_32x32x16_bf16 v[96:111], v[8:11], v[72:75], v[96:111]
    v_mfma_f32_32x32x16_bf16 v[112:127], v[12:15], v[72:75], v[112:127]
    v_mfma_f32_32x32x16_bf16 v[128:143], v[16:19], v[72:75], v[128:143]
    v_mfma_f32_32x32x16_bf16 v[144:159], v[20:23], v[72:75], v[144:159]
    v_mfma_f32_32x32x16_bf16 v[160:175], v[24:27], v[72:75], v[160:175]
    v_mfma_f32_32x32x16_bf16 v[176:191], v[28:31], v[72:75], v[176:191]
    ds_read_b64_tr_b16 v[8:9], v1 offset:26624
    ds_read_b64_tr_b16 v[10:11], v1 offset:26880
    ds_read_b64_tr_b16 v[12:13], v1 offset:30720
    ds_read_b64_tr_b16 v[14:15], v1 offset:30976
    ds_read_b64_tr_b16 v[16:17], v1 offset:34816
    ds_read_b64_tr_b16 v[18:19], v1 offset:35072
    ds_read_b64_tr_b16 v[20:21], v1 offset:38912
    ds_read_b64_tr_b16 v[22:23], v1 offset:39168
    ds_read_b64_tr_b16 v[24:25], v1 offset:43008
    ds_read_b64_tr_b16 v[26:27], v1 offset:43264
    ds_read_b64_tr_b16 v[28:29], v1 offset:47104
    ds_read_b64_tr_b16 v[30:31], v1 offset:47360
    s_waitcnt vmcnt(2)
    s_waitcnt lgkmcnt(12)
    v_mfma_f32_32x32x16_bf16 v[96:111], v[32:35], v[76:79], v[96:111]
    v_mfma_f32_32x32x16_bf16 v[112:127], v[36:39], v[76:79], v[112:127]
    v_mfma_f32_32x32x16_bf16 v[128:143], v[40:43], v[76:79], v[128:143]
    v_mfma_f32_32x32x16_bf16 v[144:159], v[44:47], v[76:79], v[144:159]
    v_mfma_f32_32x32x16_bf16 v[160:175], v[48:51], v[76:79], v[160:175]
    v_mfma_f32_32x32x16_bf16 v[176:191], v[52:55], v[76:79], v[176:191]
    ds_read_b64_tr_b16 v[32:33], v1 offset:27648
    ds_read_b64_tr_b16 v[34:35], v1 offset:27904
    ds_read_b64_tr_b16 v[36:37], v1 offset:31744
    ds_read_b64_tr_b16 v[38:39], v1 offset:32000
    ds_read_b64_tr_b16 v[40:41], v1 offset:35840
    ds_read_b64_tr_b16 v[42:43], v1 offset:36096
    ds_read_b64_tr_b16 v[44:45], v1 offset:39936
    ds_read_b64_tr_b16 v[46:47], v1 offset:40192
    ds_read_b64_tr_b16 v[48:49], v1 offset:44032
    ds_read_b64_tr_b16 v[50:51], v1 offset:44288
    ds_read_b64_tr_b16 v[52:53], v1 offset:48128
    ds_read_b64_tr_b16 v[54:55], v1 offset:48384
    s_waitcnt vmcnt(1)
    s_waitcnt lgkmcnt(12)
    v_mfma_f32_32x32x16_bf16 v[96:111], v[8:11], v[80:83], v[96:111]
    v_mfma_f32_32x32x16_bf16 v[112:127], v[12:15], v[80:83], v[112:127]
    v_mfma_f32_32x32x16_bf16 v[128:143], v[16:19], v[80:83], v[128:143]
    v_mfma_f32_32x32x16_bf16 v[144:159], v[20:23], v[80:83], v[144:159]
    v_mfma_f32_32x32x16_bf16 v[160:175], v[24:27], v[80:83], v[160:175]
    v_mfma_f32_32x32x16_bf16 v[176:191], v[28:31], v[80:83], v[176:191]
    s_waitcnt vmcnt(0)
    s_waitcnt lgkmcnt(0)
    v_mfma_f32_32x32x16_bf16 v[96:111], v[32:35], v[84:87], v[96:111]
    v_mfma_f32_32x32x16_bf16 v[112:127], v[36:39], v[84:87], v[112:127]
    v_mfma_f32_32x32x16_bf16 v[128:143], v[40:43], v[84:87], v[128:143]
    v_mfma_f32_32x32x16_bf16 v[144:159], v[44:47], v[84:87], v[144:159]
    v_mfma_f32_32x32x16_bf16 v[160:175], v[48:51], v[84:87], v[160:175]
    v_mfma_f32_32x32x16_bf16 v[176:191], v[52:55], v[84:87], v[176:191]
    s_lshl_b32 s22, s12, 11
    s_lshl_b32 s23, s10, 7
    s_add_u32 s22, s22, s23
    s_lshl_b32 s23, s8, 5
    s_add_u32 s22, s22, s23
    s_mul_i32 s22, s22, 2304
    s_mul_i32 s23, s11, 768
    s_add_u32 s22, s22, s23
    s_add_u32 s22, s22, 88080384
    s_add_u32 s18, s4, s22
    s_addc_u32 s19, s5, 0
    v_and_b32 v7, 31, v6
    v_mul_u32_u24 v5, 2304, v7
    v_lshrrev_b32 v7, 5, v6
    v_lshl_add_u32 v5, v7, 4, v5
    global_store_dwordx4 v5, v[96:99], s[18:19] offset:0 sc1
    global_store_dwordx4 v5, v[100:103], s[18:19] offset:32 sc1
    global_store_dwordx4 v5, v[104:107], s[18:19] offset:64 sc1
    global_store_dwordx4 v5, v[108:111], s[18:19] offset:96 sc1
    global_store_dwordx4 v5, v[112:115], s[18:19] offset:128 sc1
    global_store_dwordx4 v5, v[116:119], s[18:19] offset:160 sc1
    global_store_dwordx4 v5, v[120:123], s[18:19] offset:192 sc1
    global_store_dwordx4 v5, v[124:127], s[18:19] offset:224 sc1
    global_store_dwordx4 v5, v[128:131], s[18:19] offset:256 sc1
    global_store_dwordx4 v5, v[132:135], s[18:19] offset:288 sc1
    global_store_dwordx4 v5, v[136:139], s[18:19] offset:320 sc1
    global_store_dwordx4 v5, v[140:143], s[18:19] offset:352 sc1
    global_store_dwordx4 v5, v[144:147], s[18:19] offset:384 sc1
    global_store_dwordx4 v5, v[148:151], s[18:19] offset:416 sc1
    global_store_dwordx4 v5, v[152:155], s[18:19] offset:448 sc1
    global_store_dwordx4 v5, v[156:159], s[18:19] offset:480 sc1
    global_store_dwordx4 v5, v[160:163], s[18:19] offset:512 sc1
    global_store_dwordx4 v5, v[164:167], s[18:19] offset:544 sc1
    global_store_dwordx4 v5, v[168:171], s[18:19] offset:576 sc1
    global_store_dwordx4 v5, v[172:175], s[18:19] offset:608 sc1
    global_store_dwordx4 v5, v[176:179], s[18:19] offset:640 sc1
    global_store_dwordx4 v5, v[180:183], s[18:19] offset:672 sc1
    global_store_dwordx4 v5, v[184:187], s[18:19] offset:704 sc1
    global_store_dwordx4 v5, v[188:191], s[18:19] offset:736 sc1
    s_waitcnt vmcnt(0)
    s_barrier
    s_cmp_lg_u32 s8, 0
    s_cbranch_scc1 L_p2sig_48
    v_mov_b32 v7, 124
    v_mov_b32 v2, 1
    s_mov_b64 exec, 1
    global_atomic_add v7, v2, s[6:7]
    s_mov_b64 exec, -1
L_p2sig_48:
L_p2skip_44:
    s_load_dwordx2 s[44:45], s[0:1], 40
    s_load_dwordx2 s[50:51], s[0:1], 96
    s_lshr_b32 s10, s9, 5
    s_bfe_u32 s11, s9, 0x30002
    s_and_b32 s12, s9, 3
    v_and_b32 v0, 63, v0
    v_lshlrev_b32 v1, 4, v0
    v_and_b32 v3, 15, v0
    s_waitcnt lgkmcnt(0)
    s_barrier
    s_mul_i32 s26, s10, 1179648
    s_add_u32 s26, s26, 109051904
    s_add_u32 s68, s4, s26
    s_addc_u32 s69, s5, 0
    s_and_b32 s26, s9, 31
    s_mul_i32 s26, s26, 18432
    s_add_u32 s46, s68, s26
    s_addc_u32 s47, s69, 0
    v_mov_b32 v16, -1
    v_mov_b32 v17, -1
    v_mov_b32 v18, -1
    v_mov_b32 v19, -1
    s_lshl_b32 s26, s8, 10
    v_add_u32 v2, s26, v1
    v_add_u32 v12, 0, v2
    global_store_dwordx4 v12, v[16:19], s[46:47]
    v_add_u32 v12, 4096, v2
    global_store_dwordx4 v12, v[16:19], s[46:47]
    v_add_u32 v12, 8192, v2
    global_store_dwordx4 v12, v[16:19], s[46:47]
    v_add_u32 v12, 12288, v2
    global_store_dwordx4 v12, v[16:19], s[46:47]
    s_cmp_ge_u32 s8, 2
    s_cbranch_scc1 L_inv_49
    v_add_u32 v12, 16384, v2
    global_store_dwordx4 v12, v[16:19], s[46:47]
L_inv_49:
    v_add_u32 v12, 589824, v2
    global_store_dwordx4 v12, v[16:19], s[46:47]
    v_add_u32 v12, 593920, v2
    global_store_dwordx4 v12, v[16:19], s[46:47]
    v_add_u32 v12, 598016, v2
    global_store_dwordx4 v12, v[16:19], s[46:47]
    v_add_u32 v12, 602112, v2
    global_store_dwordx4 v12, v[16:19], s[46:47]
    s_cmp_ge_u32 s8, 2
    s_cbranch_scc1 L_inv_50
    v_add_u32 v12, 606208, v2
    global_store_dwordx4 v12, v[16:19], s[46:47]
L_inv_50:
    s_lshl_b32 s26, s11, 2
    s_add_u32 s26, s26, s8
    s_mul_i32 s27, s26, 147456
    s_mul_i32 s28, s12, 288
    s_add_u32 s27, s27, s28
    s_add_u32 s44, s44, s27
    s_addc_u32 s45, s45, 0
    s_mov_b32 s27, 3641
    v_mul_lo_u32 v2, v0, s27
    v_lshrrev_b32 v2, 16, v2
    v_mul_u32_u24 v12, 18, v2
    v_sub_u32 v12, v0, v12
    v_mul_u32_u24 v13, 1152, v2
    v_lshl_add_u32 v13, v12, 4, v13
    s_mul_i32 s27, s8, 36864
    s_add_u32 m0, s27, 0
    s_nop 0
    global_load_lds_dwordx4 v13, s[44:45]
    v_add_u32 v12, 10, v12
    v_add_u32 v13, 3616, v13
    v_cmp_le_u32 vcc, 18, v12
    v_subrev_u32 v2, 18, v12
    s_nop 0
    v_cndmask_b32 v12, v12, v2, vcc
    v_add_u32 v2, 864, v13
    v_cndmask_b32 v13, v13, v2, vcc
    s_add_u32 m0, s27, 1024
    s_nop 0
    global_load_lds_dwordx4 v13, s[44:45]
    v_add_u32 v12, 10, v12
    v_add_u32 v13, 3616, v13
    v_cmp_le_u32 vcc, 18, v12
    v_subrev_u32 v2, 18, v12
    s_nop 0
    v_cndmask_b32 v12, v12, v2, vcc
    v_add_u32 v2, 864, v13
    v_cndmask_b32 v13, v13, v2, vcc
    s_add_u32 m0, s27, 2048
    s_nop 0
    global_load_lds_dwordx4 v13, s[44:45]
    v_add_u32 v12, 10, v12
    v_add_u32 v13, 3616, v13
    v_cmp_le_u32 vcc, 18, v12
    v_subrev_u32 v2, 18, v12
    s_nop 0
    v_cndmask_b32 v12, v12, v2, vcc
    v_add_u32 v2, 864, v13
    v_cndmask_b32 v13, v13, v2, vcc
    s_add_u32 m0, s27, 3072
    s_nop 0
    global_load_lds_dwordx4 v13, s[44:45]
    v_add_u32 v12, 10, v12
    v_add_u32 v13, 3616, v13
    v_cmp_le_u32 vcc, 18, v12
    v_subrev_u32 v2, 18, v12
    s_nop 0
    v_cndmask_b32 v12, v12, v2, vcc
    v_add_u32 v2, 864, v13
    v_cndmask_b32 v13, v13, v2, vcc
    s_add_u32 m0, s27, 4096
    s_nop 0
    global_load_lds_dwordx4 v13, s[44:45]
    v_add_u32 v12, 10, v12
    v_add_u32 v13, 3616, v13
    v_cmp_le_u32 vcc, 18, v12
    v_subrev_u32 v2, 18, v12
    s_nop 0
    v_cndmask_b32 v12, v12, v2, vcc
    v_add_u32 v2, 864, v13
    v_cndmask_b32 v13, v13, v2, vcc
    s_add_u32 m0, s27, 5120
    s_nop 0
    global_load_lds_dwordx4 v13, s[44:45]
    v_add_u32 v12, 10, v12
    v_add_u32 v13, 3616, v13
    v_cmp_le_u32 vcc, 18, v12
    v_subrev_u32 v2, 18, v12
    s_nop 0
    v_cndmask_b32 v12, v12, v2, vcc
    v_add_u32 v2, 864, v13
    v_cndmask_b32 v13, v13, v2, vcc
    s_add_u32 m0, s27, 6144
    s_nop 0
    global_load_lds_dwordx4 v13, s[44:45]
    v_add_u32 v12, 10, v12
    v_add_u32 v13, 3616, v13
    v_cmp_le_u32 vcc, 18, v12
    v_subrev_u32 v2, 18, v12
    s_nop 0
    v_cndmask_b32 v12, v12, v2, vcc
    v_add_u32 v2, 864, v13
    v_cndmask_b32 v13, v13, v2, vcc
    s_add_u32 m0, s27, 7168
    s_nop 0
    global_load_lds_dwordx4 v13, s[44:45]
    v_add_u32 v12, 10, v12
    v_add_u32 v13, 3616, v13
    v_cmp_le_u32 vcc, 18, v12
    v_subrev_u32 v2, 18, v12
    s_nop 0
    v_cndmask_b32 v12, v12, v2, vcc
    v_add_u32 v2, 864, v13
    v_cndmask_b32 v13, v13, v2, vcc
    s_add_u32 m0, s27, 8192
    s_nop 0
    global_load_lds_dwordx4 v13, s[44:45]
    v_add_u32 v12, 10, v12
    v_add_u32 v13, 3616, v13
    v_cmp_le_u32 vcc, 18, v12
    v_subrev_u32 v2, 18, v12
    s_nop 0
    v_cndmask_b32 v12, v12, v2, vcc
    v_add_u32 v2, 864, v13
    v_cndmask_b32 v13, v13, v2, vcc
    s_add_u32 m0, s27, 9216
    s_nop 0
    global_load_lds_dwordx4 v13, s[44:45]
    v_add_u32 v12, 10, v12
    v_add_u32 v13, 3616, v13
    v_cmp_le_u32 vcc, 18, v12
    v_subrev_u32 v2, 18, v12
    s_nop 0
    v_cndmask_b32 v12, v12, v2, vcc
    v_add_u32 v2, 864, v13
    v_cndmask_b32 v13, v13, v2, vcc
    s_add_u32 m0, s27, 10240
    s_nop 0
    global_load_lds_dwordx4 v13, s[44:45]
    v_add_u32 v12, 10, v12
    v_add_u32 v13, 3616, v13
    v_cmp_le_u32 vcc, 18, v12
    v_subrev_u32 v2, 18, v12
    s_nop 0
    v_cndmask_b32 v12, v12, v2, vcc
    v_add_u32 v2, 864, v13
    v_cndmask_b32 v13, v13, v2, vcc
    s_add_u32 m0, s27, 11264
    s_nop 0
    global_load_lds_dwordx4 v13, s[44:45]
    v_add_u32 v12, 10, v12
    v_add_u32 v13, 3616, v13
    v_cmp_le_u32 vcc, 18, v12
    v_subrev_u32 v2, 18, v12
    s_nop 0
    v_cndmask_b32 v12, v12, v2, vcc
    v_add_u32 v2, 864, v13
    v_cndmask_b32 v13, v13, v2, vcc
    s_add_u32 m0, s27, 12288
    s_nop 0
    global_load_lds_dwordx4 v13, s[44:45]
    v_add_u32 v12, 10, v12
    v_add_u32 v13, 3616, v13
    v_cmp_le_u32 vcc, 18, v12
    v_subrev_u32 v2, 18, v12
    s_nop 0
    v_cndmask_b32 v12, v12, v2, vcc
    v_add_u32 v2, 864, v13
    v_cndmask_b32 v13, v13, v2, vcc
    s_add_u32 m0, s27, 13312
    s_nop 0
    global_load_lds_dwordx4 v13, s[44:45]
    v_add_u32 v12, 10, v12
    v_add_u32 v13, 3616, v13
    v_cmp_le_u32 vcc, 18, v12
    v_subrev_u32 v2, 18, v12
    s_nop 0
    v_cndmask_b32 v12, v12, v2, vcc
    v_add_u32 v2, 864, v13
    v_cndmask_b32 v13, v13, v2, vcc
    s_add_u32 m0, s27, 14336
    s_nop 0
    global_load_lds_dwordx4 v13, s[44:45]
    v_add_u32 v12, 10, v12
    v_add_u32 v13, 3616, v13
    v_cmp_le_u32 vcc, 18, v12
    v_subrev_u32 v2, 18, v12
    s_nop 0
    v_cndmask_b32 v12, v12, v2, vcc
    v_add_u32 v2, 864, v13
    v_cndmask_b32 v13, v13, v2, vcc
    s_add_u32 m0, s27, 15360
    s_nop 0
    global_load_lds_dwordx4 v13, s[44:45]
    v_add_u32 v12, 10, v12
    v_add_u32 v13, 3616, v13
    v_cmp_le_u32 vcc, 18, v12
    v_subrev_u32 v2, 18, v12
    s_nop 0
    v_cndmask_b32 v12, v12, v2, vcc
    v_add_u32 v2, 864, v13
    v_cndmask_b32 v13, v13, v2, vcc
    s_add_u32 m0, s27, 16384
    s_nop 0
    global_load_lds_dwordx4 v13, s[44:45]
    v_add_u32 v12, 10, v12
    v_add_u32 v13, 3616, v13
    v_cmp_le_u32 vcc, 18, v12
    v_subrev_u32 v2, 18, v12
    s_nop 0
    v_cndmask_b32 v12, v12, v2, vcc
    v_add_u32 v2, 864, v13
    v_cndmask_b32 v13, v13, v2, vcc
    s_add_u32 m0, s27, 17408
    s_nop 0
    global_load_lds_dwordx4 v13, s[44:45]
    v_add_u32 v12, 10, v12
    v_add_u32 v13, 3616, v13
    v_cmp_le_u32 vcc, 18, v12
    v_subrev_u32 v2, 18, v12
    s_nop 0
    v_cndmask_b32 v12, v12, v2, vcc
    v_add_u32 v2, 864, v13
    v_cndmask_b32 v13, v13, v2, vcc
    s_add_u32 m0, s27, 18432
    s_nop 0
    global_load_lds_dwordx4 v13, s[44:45]
    v_add_u32 v12, 10, v12
    v_add_u32 v13, 3616, v13
    v_cmp_le_u32 vcc, 18, v12
    v_subrev_u32 v2, 18, v12
    s_nop 0
    v_cndmask_b32 v12, v12, v2, vcc
    v_add_u32 v2, 864, v13
    v_cndmask_b32 v13, v13, v2, vcc
    s_add_u32 m0, s27, 19456
    s_nop 0
    global_load_lds_dwordx4 v13, s[44:45]
    v_add_u32 v12, 10, v12
    v_add_u32 v13, 3616, v13
    v_cmp_le_u32 vcc, 18, v12
    v_subrev_u32 v2, 18, v12
    s_nop 0
    v_cndmask_b32 v12, v12, v2, vcc
    v_add_u32 v2, 864, v13
    v_cndmask_b32 v13, v13, v2, vcc
    s_add_u32 m0, s27, 20480
    s_nop 0
    global_load_lds_dwordx4 v13, s[44:45]
    v_add_u32 v12, 10, v12
    v_add_u32 v13, 3616, v13
    v_cmp_le_u32 vcc, 18, v12
    v_subrev_u32 v2, 18, v12
    s_nop 0
    v_cndmask_b32 v12, v12, v2, vcc
    v_add_u32 v2, 864, v13
    v_cndmask_b32 v13, v13, v2, vcc
    s_add_u32 m0, s27, 21504
    s_nop 0
    global_load_lds_dwordx4 v13, s[44:45]
    v_add_u32 v12, 10, v12
    v_add_u32 v13, 3616, v13
    v_cmp_le_u32 vcc, 18, v12
    v_subrev_u32 v2, 18, v12
    s_nop 0
    v_cndmask_b32 v12, v12, v2, vcc
    v_add_u32 v2, 864, v13
    v_cndmask_b32 v13, v13, v2, vcc
    s_add_u32 m0, s27, 22528
    s_nop 0
    global_load_lds_dwordx4 v13, s[44:45]
    v_add_u32 v12, 10, v12
    v_add_u32 v13, 3616, v13
    v_cmp_le_u32 vcc, 18, v12
    v_subrev_u32 v2, 18, v12
    s_nop 0
    v_cndmask_b32 v12, v12, v2, vcc
    v_add_u32 v2, 864, v13
    v_cndmask_b32 v13, v13, v2, vcc
    s_add_u32 m0, s27, 23552
    s_nop 0
    global_load_lds_dwordx4 v13, s[44:45]
    v_add_u32 v12, 10, v12
    v_add_u32 v13, 3616, v13
    v_cmp_le_u32 vcc, 18, v12
    v_subrev_u32 v2, 18, v12
    s_nop 0
    v_cndmask_b32 v12, v12, v2, vcc
    v_add_u32 v2, 864, v13
    v_cndmask_b32 v13, v13, v2, vcc
    s_add_u32 m0, s27, 24576
    s_nop 0
    global_load_lds_dwordx4 v13, s[44:45]
    v_add_u32 v12, 10, v12
    v_add_u32 v13, 3616, v13
    v_cmp_le_u32 vcc, 18, v12
    v_subrev_u32 v2, 18, v12
    s_nop 0
    v_cndmask_b32 v12, v12, v2, vcc
    v_add_u32 v2, 864, v13
    v_cndmask_b32 v13, v13, v2, vcc
    s_add_u32 m0, s27, 25600
    s_nop 0
    global_load_lds_dwordx4 v13, s[44:45]
    v_add_u32 v12, 10, v12
    v_add_u32 v13, 3616, v13
    v_cmp_le_u32 vcc, 18, v12
    v_subrev_u32 v2, 18, v12
    s_nop 0
    v_cndmask_b32 v12, v12, v2, vcc
    v_add_u32 v2, 864, v13
    v_cndmask_b32 v13, v13, v2, vcc
    s_add_u32 m0, s27, 26624
    s_nop 0
    global_load_lds_dwordx4 v13, s[44:45]
    v_add_u32 v12, 10, v12
    v_add_u32 v13, 3616, v13
    v_cmp_le_u32 vcc, 18, v12
    v_subrev_u32 v2, 18, v12
    s_nop 0
    v_cndmask_b32 v12, v12, v2, vcc
    v_add_u32 v2, 864, v13
    v_cndmask_b32 v13, v13, v2, vcc
    s_add_u32 m0, s27, 27648
    s_nop 0
    global_load_lds_dwordx4 v13, s[44:45]
    v_add_u32 v12, 10, v12
    v_add_u32 v13, 3616, v13
    v_cmp_le_u32 vcc, 18, v12
    v_subrev_u32 v2, 18, v12
    s_nop 0
    v_cndmask_b32 v12, v12, v2, vcc
    v_add_u32 v2, 864, v13
    v_cndmask_b32 v13, v13, v2, vcc
    s_add_u32 m0, s27, 28672
    s_nop 0
    global_load_lds_dwordx4 v13, s[44:45]
    v_add_u32 v12, 10, v12
    v_add_u32 v13, 3616, v13
    v_cmp_le_u32 vcc, 18, v12
    v_subrev_u32 v2, 18, v12
    s_nop 0
    v_cndmask_b32 v12, v12, v2, vcc
    v_add_u32 v2, 864, v13
    v_cndmask_b32 v13, v13, v2, vcc
    s_add_u32 m0, s27, 29696
    s_nop 0
    global_load_lds_dwordx4 v13, s[44:45]
    v_add_u32 v12, 10, v12
    v_add_u32 v13, 3616, v13
    v_cmp_le_u32 vcc, 18, v12
    v_subrev_u32 v2, 18, v12
    s_nop 0
    v_cndmask_b32 v12, v12, v2, vcc
    v_add_u32 v2, 864, v13
    v_cndmask_b32 v13, v13, v2, vcc
    s_add_u32 m0, s27, 30720
    s_nop 0
    global_load_lds_dwordx4 v13, s[44:45]
    v_add_u32 v12, 10, v12
    v_add_u32 v13, 3616, v13
    v_cmp_le_u32 vcc, 18, v12
    v_subrev_u32 v2, 18, v12
    s_nop 0
    v_cndmask_b32 v12, v12, v2, vcc
    v_add_u32 v2, 864, v13
    v_cndmask_b32 v13, v13, v2, vcc
    s_add_u32 m0, s27, 31744
    s_nop 0
    global_load_lds_dwordx4 v13, s[44:45]
    v_add_u32 v12, 10, v12
    v_add_u32 v13, 3616, v13
    v_cmp_le_u32 vcc, 18, v12
    v_subrev_u32 v2, 18, v12
    s_nop 0
    v_cndmask_b32 v12, v12, v2, vcc
    v_add_u32 v2, 864, v13
    v_cndmask_b32 v13, v13, v2, vcc
    s_add_u32 m0, s27, 32768
    s_nop 0
    global_load_lds_dwordx4 v13, s[44:45]
    v_add_u32 v12, 10, v12
    v_add_u32 v13, 3616, v13
    v_cmp_le_u32 vcc, 18, v12
    v_subrev_u32 v2, 18, v12
    s_nop 0
    v_cndmask_b32 v12, v12, v2, vcc
    v_add_u32 v2, 864, v13
    v_cndmask_b32 v13, v13, v2, vcc
    s_add_u32 m0, s27, 33792
    s_nop 0
    global_load_lds_dwordx4 v13, s[44:45]
    v_add_u32 v12, 10, v12
    v_add_u32 v13, 3616, v13
    v_cmp_le_u32 vcc, 18, v12
    v_subrev_u32 v2, 18, v12
    s_nop 0
    v_cndmask_b32 v12, v12, v2, vcc
    v_add_u32 v2, 864, v13
    v_cndmask_b32 v13, v13, v2, vcc
    s_add_u32 m0, s27, 34816
    s_nop 0
    global_load_lds_dwordx4 v13, s[44:45]
    v_add_u32 v12, 10, v12
    v_add_u32 v13, 3616, v13
    v_cmp_le_u32 vcc, 18, v12
    v_subrev_u32 v2, 18, v12
    s_nop 0
    v_cndmask_b32 v12, v12, v2, vcc
    v_add_u32 v2, 864, v13
    v_cndmask_b32 v13, v13, v2, vcc
    s_add_u32 m0, s27, 35840
    s_nop 0
    global_load_lds_dwordx4 v13, s[44:45]
    s_waitcnt vmcnt(0)
    v_lshrrev_b32 v2, 4, v0
    v_lshlrev_b32 v2, 3, v2
    v_bfe_u32 v12, v0, 2, 2
    v_add_u32 v2, v2, v12
    v_mul_u32_u24 v2, 288, v2
    v_and_b32 v12, 3, v0
    v_lshl_add_u32 v2, v12, 3, v2
    v_add_u32 v2, s27, v2
    ds_read_b64_tr_b16 a[0:1], v2 offset:0
    ds_read_b64_tr_b16 a[2:3], v2 offset:1152
    ds_read_b64_tr_b16 a[4:5], v2 offset:9216
    ds_read_b64_tr_b16 a[6:7], v2 offset:10368
    ds_read_b64_tr_b16 a[8:9], v2 offset:18432
    ds_read_b64_tr_b16 a[10:11], v2 offset:19584
    ds_read_b64_tr_b16 a[12:13], v2 offset:27648
    ds_read_b64_tr_b16 a[14:15], v2 offset:28800
    ds_read_b64_tr_b16 a[16:17], v2 offset:32
    ds_read_b64_tr_b16 a[18:19], v2 offset:1184
    ds_read_b64_tr_b16 a[20:21], v2 offset:9248
    ds_read_b64_tr_b16 a[22:23], v2 offset:10400
    s_waitcnt lgkmcnt(0)
    ds_read_b64_tr_b16 a[24:25], v2 offset:18464
    ds_read_b64_tr_b16 a[26:27], v2 offset:19616
    ds_read_b64_tr_b16 a[28:29], v2 offset:27680
    ds_read_b64_tr_b16 a[30:31], v2 offset:28832
    ds_read_b64_tr_b16 a[32:33], v2 offset:64
    ds_read_b64_tr_b16 a[34:35], v2 offset:1216
    ds_read_b64_tr_b16 a[36:37], v2 offset:9280
    ds_read_b64_tr_b16 a[38:39], v2 offset:10432
    ds_read_b64_tr_b16 a[40:41], v2 offset:18496
    ds_read_b64_tr_b16 a[42:43], v2 offset:19648
    ds_read_b64_tr_b16 a[44:45], v2 offset:27712
    ds_read_b64_tr_b16 a[46:47], v2 offset:28864
    s_waitcnt lgkmcnt(0)
    ds_read_b64_tr_b16 a[48:49], v2 offset:96
    ds_read_b64_tr_b16 a[50:51], v2 offset:1248
    ds_read_b64_tr_b16 a[52:53], v2 offset:9312
    ds_read_b64_tr_b16 a[54:55], v2 offset:10464
    ds_read_b64_tr_b16 a[56:57], v2 offset:18528
    ds_read_b64_tr_b16 a[58:59], v2 offset:19680
    ds_read_b64_tr_b16 a[60:61], v2 offset:27744
    ds_read_b64_tr_b16 a[62:63], v2 offset:28896
    ds_read_b64_tr_b16 a[64:65], v2 offset:128
    ds_read_b64_tr_b16 a[66:67], v2 offset:1280
    ds_read_b64_tr_b16 a[68:69], v2 offset:9344
    ds_read_b64_tr_b16 a[70:71], v2 offset:10496
    s_waitcnt lgkmcnt(0)
    ds_read_b64_tr_b16 a[72:73], v2 offset:18560
    ds_read_b64_tr_b16 a[74:75], v2 offset:19712
    ds_read_b64_tr_b16 a[76:77], v2 offset:27776
    ds_read_b64_tr_b16 a[78:79], v2 offset:28928
    ds_read_b64_tr_b16 a[80:81], v2 offset:160
    ds_read_b64_tr_b16 a[82:83], v2 offset:1312
    ds_read_b64_tr_b16 a[84:85], v2 offset:9376
    ds_read_b64_tr_b16 a[86:87], v2 offset:10528
    ds_read_b64_tr_b16 a[88:89], v2 offset:18592
    ds_read_b64_tr_b16 a[90:91], v2 offset:19744
    ds_read_b64_tr_b16 a[92:93], v2 offset:27808
    ds_read_b64_tr_b16 a[94:95], v2 offset:28960
    s_waitcnt lgkmcnt(0)
    ds_read_b64_tr_b16 a[96:97], v2 offset:192
    ds_read_b64_tr_b16 a[98:99], v2 offset:1344
    ds_read_b64_tr_b16 a[100:101], v2 offset:9408
    ds_read_b64_tr_b16 a[102:103], v2 offset:10560
    ds_read_b64_tr_b16 a[104:105], v2 offset:18624
    ds_read_b64_tr_b16 a[106:107], v2 offset:19776
    ds_read_b64_tr_b16 a[108:109], v2 offset:27840
    ds_read_b64_tr_b16 a[110:111], v2 offset:28992
    ds_read_b64_tr_b16 a[112:113], v2 offset:224
    ds_read_b64_tr_b16 a[114:115], v2 offset:1376
    ds_read_b64_tr_b16 a[116:117], v2 offset:9440
    ds_read_b64_tr_b16 a[118:119], v2 offset:10592
    s_waitcnt lgkmcnt(0)
    ds_read_b64_tr_b16 a[120:121], v2 offset:18656
    ds_read_b64_tr_b16 a[122:123], v2 offset:19808
    ds_read_b64_tr_b16 a[124:125], v2 offset:27872
    ds_read_b64_tr_b16 a[126:127], v2 offset:29024
    ds_read_b64_tr_b16 a[128:129], v2 offset:256
    ds_read_b64_tr_b16 a[130:131], v2 offset:1408
    ds_read_b64_tr_b16 a[132:133], v2 offset:9472
    ds_read_b64_tr_b16 a[134:135], v2 offset:10624
    ds_read_b64_tr_b16 a[136:137], v2 offset:18688
    ds_read_b64_tr_b16 a[138:139], v2 offset:19840
    ds_read_b64_tr_b16 a[140:141], v2 offset:27904
    ds_read_b64_tr_b16 a[142:143], v2 offset:29056
    s_waitcnt lgkmcnt(0)
    s_waitcnt lgkmcnt(0)
    s_mov_b32 s30, 0x3e0293ee
    s_mov_b32 s31, 0x3e0293ee
    v_mov_b32 v10, 0xff800000
    v_lshrrev_b32 v2, 4, v0
    v_lshlrev_b32 v2, 2, v2
    v_add_u32 v12, 0, v2
    v_cmp_le_u32 s[32:33], v12, v3
    v_add_u32 v12, 1, v2
    v_cmp_le_u32 s[34:35], v12, v3
    v_add_u32 v12, 2, v2
    v_cmp_le_u32 s[36:37], v12, v3
    v_add_u32 v12, 3, v2
    v_cmp_le_u32 s[38:39], v12, v3
    s_mov_b32 s40, -1
    s_mov_b32 s41, 0
    v_bfe_u32 v12, v0, 1, 2
    v_lshlrev_b32 v4, 9, v12
    v_and_b32 v12, 1, v0
    v_lshl_add_u32 v4, v12, 3, v4
    v_lshrrev_b32 v12, 4, v0
    v_lshl_add_u32 v4, v12, 5, v4
    v_lshlrev_b32 v5, 5, v3
    v_and_b32 v12, 1, v12
    v_lshl_add_u32 v5, v12, 4, v5
    s_mul_i32 s26, s8, 18432
    v_add_u32 v6, s26, v1
    v_mul_u32_u24 v7, 576, v3
    v_lshrrev_b32 v12, 4, v0
    v_lshl_add_u32 v7, v12, 4, v7
    s_and_b32 s26, s8, 1
    s_mul_i32 s26, s26, 9216
    s_lshr_b32 s27, s8, 1
    s_lshl_b32 s27, s27, 6
    s_add_u32 s26, s26, s27
    v_add_u32 v7, s26, v7
    s_lshl_b32 s26, s8, 6
    v_add_u32 v2, s26, v0
    v_min_u32 v2, 143, v2
    s_mov_b32 s27, 1821
    v_mul_lo_u32 v12, v2, s27
    v_lshrrev_b32 v12, 16, v12
    v_mul_u32_u24 v13, 36, v12
    v_sub_u32 v13, v2, v13
    s_lshl_b32 s26, s11, 2
    v_add_u32 v12, s26, v12
    v_mul_u32_u24 v8, 576, v12
    v_lshl_add_u32 v8, v13, 4, v8
    v_mul_u32_u24 v9, 2304, v12
    v_lshl_add_u32 v9, v13, 4, v9
    s_mul_i32 s26, s12, 576
    v_add_u32 v9, s26, v9
    v_lshrrev_b32 v14, 1, v9
    v_lshlrev_b32 v15, 2, v12
    s_waitcnt vmcnt(0)
    s_barrier
    s_cmp_lg_u32 s8, 0
    s_cbranch_scc1 L_gb_51
    s_add_u32 s26, s10, 32
    s_lshl_b32 s26, s26, 2
    v_mov_b32 v2, s26
    v_mov_b32 v12, 1
    s_mov_b64 exec, 1
    global_atomic_add v2, v12, s[6:7]
    s_mov_b64 exec, -1
L_gb_51:
    s_cmp_lg_u32 s8, 0
    s_cbranch_scc1 L_w3all_52
    s_add_u32 s27, s10, 32
    s_lshl_b32 s27, s27, 2
    v_mov_b32 v2, s27
L_gbw_53:
    global_load_dword v12, v2, s[6:7] sc1
    s_waitcnt vmcnt(0)
    v_readfirstlane_b32 s26, v12
    s_cmp_ge_u32 s26, 32
    s_cbranch_scc1 L_gbo_54
    s_sub_u32 s43, s43, 1
    s_cbranch_scc1 L_bail
    s_sleep 64
    s_branch L_gbw_53
L_gbo_54:
    v_mov_b32 v2, 160
L_w3sp_55:
    global_load_dword v12, v2, s[6:7] sc1
    s_waitcnt vmcnt(0)
    v_readfirstlane_b32 s26, v12
    s_cmp_ge_u32 s26, 224
    s_cbranch_scc1 L_w3ok_56
    s_sub_u32 s43, s43, 1
    s_cbranch_scc1 L_bail
    s_sleep 64
    s_branch L_w3sp_55
L_w3ok_56:
    v_mov_b32 v2, 120
L_w3sp_57:
    global_load_dword v12, v2, s[6:7] sc1
    s_waitcnt vmcnt(0)
    v_readfirstlane_b32 s26, v12
    s_cmp_ge_u32 s26, 72
    s_cbranch_scc1 L_w3ok_58
    s_sub_u32 s43, s43, 1
    s_cbranch_scc1 L_bail
    s_sleep 64
    s_branch L_w3sp_57
L_w3ok_58:
    v_mov_b32 v2, 80
L_w3sp_59:
    global_load_dword v12, v2, s[6:7] sc1
    s_waitcnt vmcnt(0)
    v_readfirstlane_b32 s26, v12
    s_cmp_ge_u32 s26, 196
    s_cbranch_scc1 L_w3ok_60
    s_sub_u32 s43, s43, 1
    s_cbranch_scc1 L_bail
    s_sleep 64
    s_branch L_w3sp_59
L_w3ok_60:
    v_mov_b32 v2, 60
L_w3sp_61:
    global_load_dword v12, v2, s[6:7] sc1
    s_waitcnt vmcnt(0)
    v_readfirstlane_b32 s26, v12
    s_cmp_ge_u32 s26, 128
    s_cbranch_scc1 L_w3ok_62
    s_sub_u32 s43, s43, 1
    s_cbranch_scc1 L_bail
    s_sleep 64
    s_branch L_w3sp_61
L_w3ok_62:
    v_mov_b32 v2, 124
L_w3sp_63:
    global_load_dword v12, v2, s[6:7] sc1
    s_waitcnt vmcnt(0)
    v_readfirstlane_b32 s26, v12
    s_cmp_ge_u32 s26, 192
    s_cbranch_scc1 L_w3ok_64
    s_sub_u32 s43, s43, 1
    s_cbranch_scc1 L_bail
    s_sleep 64
    s_branch L_w3sp_63
L_w3ok_64:
L_w3all_52:
    s_barrier
    s_mov_b32 s13, s10
    s_mov_b32 s14, 0
L_w3loop_65:
    s_lshl_b32 s26, s11, 2
    s_add_u32 s26, s26, s8
    s_lshl_b32 s27, s13, 5
    s_add_u32 s26, s26, s27
    s_lshl_b32 s27, s26, 13
    s_add_u32 s18, s4, s27
    s_addc_u32 s19, s5, 0
    s_add_u32 s20, s18, 16777216
    s_addc_u32 s21, s19, 0
    s_add_u32 s16, s18, 50331648
    s_addc_u32 s17, s19, 0
    s_lshl_b32 s27, s26, 11
    s_add_u32 s22, s4, s27
    s_addc_u32 s23, s5, 0
    s_add_u32 s24, s22, 37748736
    s_addc_u32 s25, s23, 0
    s_add_u32 s22, s22, 33554432
    s_addc_u32 s23, s23, 0
    v_add_u32 v2, 4096, v1
    global_load_dwordx4 v[16:19], v1, s[16:17] offset:0 sc1
    global_load_dwordx4 v[20:23], v1, s[16:17] offset:1024 sc1
    global_load_dwordx4 v[24:27], v1, s[16:17] offset:2048 sc1
    global_load_dwordx4 v[28:31], v1, s[16:17] offset:3072 sc1
    global_load_dwordx4 v[32:35], v2, s[16:17] offset:0 sc1
    global_load_dwordx4 v[36:39], v2, s[16:17] offset:1024 sc1
    global_load_dwordx4 v[40:43], v2, s[16:17] offset:2048 sc1
    global_load_dwordx4 v[44:47], v2, s[16:17] offset:3072 sc1
    v_add_u32 v2, 4096, v1
    global_load_dwordx4 v[48:51], v1, s[18:19] offset:0 sc1
    global_load_dwordx4 v[52:55], v1, s[18:19] offset:1024 sc1
    global_load_dwordx4 v[56:59], v1, s[18:19] offset:2048 sc1
    global_load_dwordx4 v[60:63], v1, s[18:19] offset:3072 sc1
    global_load_dwordx4 v[64:67], v2, s[18:19] offset:0 sc1
    global_load_dwordx4 v[68:71], v2, s[18:19] offset:1024 sc1
    global_load_dwordx4 v[72:75], v2, s[18:19] offset:2048 sc1
    global_load_dwordx4 v[76:79], v2, s[18:19] offset:3072 sc1
    v_add_u32 v2, 4096, v1
    global_load_dwordx4 v[80:83], v1, s[20:21] offset:0 sc1
    global_load_dwordx4 v[84:87], v1, s[20:21] offset:1024 sc1
    global_load_dwordx4 v[88:91], v1, s[20:21] offset:2048 sc1
    global_load_dwordx4 v[92:95], v1, s[20:21] offset:3072 sc1
    global_load_dwordx4 v[96:99], v2, s[20:21] offset:0 sc1
    global_load_dwordx4 v[100:103], v2, s[20:21] offset:1024 sc1
    global_load_dwordx4 v[104:107], v2, s[20:21] offset:2048 sc1
    global_load_dwordx4 v[108:111], v2, s[20:21] offset:3072 sc1
    s_lshl_b32 s27, s13, 7
    s_add_u32 s27, s27, 87031808
    s_add_u32 s54, s4, s27
    s_addc_u32 s55, s5, 0
    v_lshlrev_b32 v2, 2, v3
    global_load_dword v240, v2, s[54:55] sc1
    global_load_dword v242, v2, s[54:55] offset:64 sc1
    s_cmp_lg_u32 s8, 0
    s_cbranch_scc1 L_w3ps_71
    s_mov_b64 exec, 1
L_w3p1_69:
    global_load_dword v12, v5, s[24:25] offset:1536 sc1
    s_waitcnt vmcnt(0)
    v_cmp_eq_u32 vcc, -1, v12
    s_cbranch_vccz L_w3k1_70
    s_sub_u32 s43, s43, 1
    s_cbranch_scc1 L_bail
    s_sleep 5
    s_branch L_w3p1_69
L_w3k1_70:
    s_mov_b64 exec, -1
L_w3ps_71:
    s_barrier
L_w3pp_67:
    global_load_dwordx2 v[112:113], v4, s[22:23] offset:0 sc1
    global_load_dwordx2 v[114:115], v4, s[22:23] offset:16 sc1
    global_load_dwordx2 v[116:117], v4, s[22:23] offset:128 sc1
    global_load_dwordx2 v[118:119], v4, s[22:23] offset:144 sc1
    global_load_dwordx2 v[120:121], v4, s[22:23] offset:256 sc1
    global_load_dwordx2 v[122:123], v4, s[22:23] offset:272 sc1
    global_load_dwordx2 v[124:125], v4, s[22:23] offset:384 sc1
    global_load_dwordx2 v[126:127], v4, s[22:23] offset:400 sc1
    global_load_dwordx4 v[128:131], v5, s[24:25] offset:0 sc1
    global_load_dwordx4 v[132:135], v5, s[24:25] offset:512 sc1
    global_load_dwordx4 v[136:139], v5, s[24:25] offset:1024 sc1
    global_load_dwordx4 v[140:143], v5, s[24:25] offset:1536 sc1
    s_waitcnt vmcnt(0)
    v_max3_u32 v12, v112, v113, v114
    v_max3_u32 v12, v12, v115, v116
    v_max3_u32 v12, v12, v117, v118
    v_max3_u32 v12, v12, v119, v120
    v_max3_u32 v12, v12, v121, v122
    v_max3_u32 v12, v12, v123, v124
    v_max3_u32 v12, v12, v125, v126
    v_max3_u32 v12, v12, v127, v128
    v_max3_u32 v12, v12, v129, v130
    v_max3_u32 v12, v12, v131, v132
    v_max3_u32 v12, v12, v133, v134
    v_max3_u32 v12, v12, v135, v136
    v_max3_u32 v12, v12, v137, v138
    v_max3_u32 v12, v12, v139, v140
    v_max3_u32 v12, v12, v141, v142
    v_max_u32 v12, v12, v143
    v_cmp_eq_u32 vcc, -1, v12
    s_cbranch_vccz L_w3pk_68
    s_sub_u32 s43, s43, 1
    s_cbranch_scc1 L_bail
    s_sleep 2
    s_branch L_w3pp_67
L_w3pk_68:
    v_swap_b32 v129, v130
    v_swap_b32 v133, v134
    v_swap_b32 v137, v138
    v_swap_b32 v141, v142
    v_mfma_f32_16x16x32_bf16 v[144:147], v[112:115], v[16:19], 0
    v_mfma_f32_16x16x32_bf16 v[152:155], v[48:51], v[16:19], 0
    v_mfma_f32_16x16x32_bf16 v[148:151], v[112:115], v[32:35], 0
    v_mfma_f32_16x16x32_bf16 v[156:159], v[48:51], v[32:35], 0
    v_mfma_f32_16x16x32_bf16 v[160:163], v[64:67], v[32:35], 0
    v_mfma_f32_16x16x32_bf16 v[144:147], v[116:119], v[20:23], v[144:147]
    v_mfma_f32_16x16x32_bf16 v[152:155], v[52:55], v[20:23], v[152:155]
    v_mfma_f32_16x16x32_bf16 v[148:151], v[116:119], v[36:39], v[148:151]
    v_mfma_f32_16x16x32_bf16 v[156:159], v[52:55], v[36:39], v[156:159]
    v_mfma_f32_16x16x32_bf16 v[160:163], v[68:71], v[36:39], v[160:163]
    v_mfma_f32_16x16x32_bf16 v[144:147], v[120:123], v[24:27], v[144:147]
    v_mfma_f32_16x16x32_bf16 v[152:155], v[56:59], v[24:27], v[152:155]
    v_mfma_f32_16x16x32_bf16 v[148:151], v[120:123], v[40:43], v[148:151]
    v_mfma_f32_16x16x32_bf16 v[156:159], v[56:59], v[40:43], v[156:159]
    v_mfma_f32_16x16x32_bf16 v[160:163], v[72:75], v[40:43], v[160:163]
    v_mfma_f32_16x16x32_bf16 v[144:147], v[124:127], v[28:31], v[144:147]
    v_mfma_f32_16x16x32_bf16 v[152:155], v[60:63], v[28:31], v[152:155]
    v_mfma_f32_16x16x32_bf16 v[148:151], v[124:127], v[44:47], v[148:151]
    v_mfma_f32_16x16x32_bf16 v[156:159], v[60:63], v[44:47], v[156:159]
    v_mfma_f32_16x16x32_bf16 v[160:163], v[76:79], v[44:47], v[160:163]
    s_nop 3
    v_cndmask_b32 v144, v10, v144, s[40:41]
    v_cndmask_b32 v145, v10, v145, s[40:41]
    v_cndmask_b32 v146, v10, v146, s[40:41]
    v_cndmask_b32 v147, v10, v147, s[40:41]
    v_cndmask_b32 v152, v10, v152, s[32:33]
    v_cndmask_b32 v153, v10, v153, s[34:35]
    v_cndmask_b32 v154, v10, v154, s[36:37]
    v_cndmask_b32 v155, v10, v155, s[38:39]
    v_max3_f32 v12, v144, v145, v146
    v_max3_f32 v12, v12, v147, v152
    v_max3_f32 v12, v12, v153, v154
    v_max_f32 v12, v12, v155
    v_mov_b32 v13, v12
    s_nop 1
    v_permlane32_swap_b32 v12, v13
    v_max_f32 v12, v12, v13
    v_mov_b32 v13, v12
    s_nop 1
    v_permlane16_swap_b32 v12, v13
    v_max_f32 v12, v12, v13
    v_mul_f32 v12, s30, v12
    v_fma_f32 v144, v144, s30, -v12
    v_fma_f32 v145, v145, s30, -v12
    v_fma_f32 v146, v146, s30, -v12
    v_fma_f32 v147, v147, s30, -v12
    v_fma_f32 v152, v152, s30, -v12
    v_fma_f32 v153, v153, s30, -v12
    v_fma_f32 v154, v154, s30, -v12
    v_fma_f32 v155, v155, s30, -v12
    v_exp_f32 v144, v144
    v_exp_f32 v145, v145
    v_exp_f32 v146, v146
    v_exp_f32 v147, v147
    v_exp_f32 v152, v152
    v_exp_f32 v153, v153
    v_exp_f32 v154, v154
    v_exp_f32 v155, v155
    v_cvt_pk_bf16_f32 v232, v152, v153
    v_cvt_pk_bf16_f32 v233, v154, v155
    v_mov_b32 v234, 0
    v_mov_b32 v235, 0
    v_cvt_pk_bf16_f32 v164, v144, v145
    v_cvt_pk_bf16_f32 v165, v146, v147
    v_add_f32 v12, v144, v145
    v_add_f32 v12, v12, v146
    v_add_f32 v12, v12, v147
    v_add_f32 v12, v12, v152
    v_add_f32 v12, v12, v153
    v_add_f32 v12, v12, v154
    v_add_f32 v12, v12, v155
    v_mov_b32 v13, v12
    s_nop 1
    v_permlane32_swap_b32 v12, v13
    v_add_f32 v12, v12, v13
    v_mov_b32 v13, v12
    s_nop 1
    v_permlane16_swap_b32 v12, v13
    v_add_f32 v12, v12, v13
    v_rcp_f32 v12, v12
    s_nop 0
    v_mul_f32 v240, v240, v12
    v_cndmask_b32 v148, v10, v148, s[40:41]
    v_cndmask_b32 v149, v10, v149, s[40:41]
    v_cndmask_b32 v150, v10, v150, s[40:41]
    v_cndmask_b32 v151, v10, v151, s[40:41]
    v_cndmask_b32 v160, v10, v160, s[32:33]
    v_cndmask_b32 v161, v10, v161, s[34:35]
    v_cndmask_b32 v162, v10, v162, s[36:37]
    v_cndmask_b32 v163, v10, v163, s[38:39]
    v_max3_f32 v12, v148, v149, v150
    v_max3_f32 v12, v12, v151, v156
    v_max3_f32 v12, v12, v157, v158
    v_max3_f32 v12, v12, v159, v160
    v_max3_f32 v12, v12, v161, v162
    v_max_f32 v12, v12, v163
    v_mov_b32 v13, v12
    s_nop 1
    v_permlane32_swap_b32 v12, v13
    v_max_f32 v12, v12, v13
    v_mov_b32 v13, v12
    s_nop 1
    v_permlane16_swap_b32 v12, v13
    v_max_f32 v12, v12, v13
    v_mul_f32 v12, s30, v12
    v_fma_f32 v148, v148, s30, -v12
    v_fma_f32 v149, v149, s30, -v12
    v_fma_f32 v150, v150, s30, -v12
    v_fma_f32 v151, v151, s30, -v12
    v_fma_f32 v156, v156, s30, -v12
    v_fma_f32 v157, v157, s30, -v12
    v_fma_f32 v158, v158, s30, -v12
    v_fma_f32 v159, v159, s30, -v12
    v_fma_f32 v160, v160, s30, -v12
    v_fma_f32 v161, v161, s30, -v12
    v_fma_f32 v162, v162, s30, -v12
    v_fma_f32 v163, v163, s30, -v12
    v_exp_f32 v148, v148
    v_exp_f32 v149, v149
    v_exp_f32 v150, v150
    v_exp_f32 v151, v151
    v_exp_f32 v156, v156
    v_exp_f32 v157, v157
    v_exp_f32 v158, v158
    v_exp_f32 v159, v159
    v_exp_f32 v160, v160
    v_exp_f32 v161, v161
    v_exp_f32 v162, v162
    v_exp_f32 v163, v163
    v_cvt_pk_bf16_f32 v236, v156, v157
    v_cvt_pk_bf16_f32 v237, v158, v159
    v_cvt_pk_bf16_f32 v238, v160, v161
    v_cvt_pk_bf16_f32 v239, v162, v163
    v_cvt_pk_bf16_f32 v166, v148, v149
    v_cvt_pk_bf16_f32 v167, v150, v151
    v_add_f32 v12, v148, v149
    v_add_f32 v12, v12, v150
    v_add_f32 v12, v12, v151
    v_add_f32 v12, v12, v156
    v_add_f32 v12, v12, v157
    v_add_f32 v12, v12, v158
    v_add_f32 v12, v12, v159
    v_add_f32 v12, v12, v160
    v_add_f32 v12, v12, v161
    v_add_f32 v12, v12, v162
    v_add_f32 v12, v12, v163
    v_mov_b32 v13, v12
    s_nop 1
    v_permlane32_swap_b32 v12, v13
    v_add_f32 v12, v12, v13
    v_mov_b32 v13, v12
    s_nop 1
    v_permlane16_swap_b32 v12, v13
    v_add_f32 v12, v12, v13
    v_rcp_f32 v12, v12
    s_nop 0
    v_mul_f32 v242, v242, v12
    v_mfma_f32_16x16x32_bf16 v[168:171], v[80:83], v[232:235], 0
    v_mfma_f32_16x16x32_bf16 v[172:175], v[80:83], v[236:239], 0
    v_mfma_f32_16x16x32_bf16 v[176:179], v[84:87], v[232:235], 0
    v_mfma_f32_16x16x32_bf16 v[180:183], v[84:87], v[236:239], 0
    v_mfma_f32_16x16x32_bf16 v[184:187], v[88:91], v[232:235], 0
    v_mfma_f32_16x16x32_bf16 v[188:191], v[88:91], v[236:239], 0
    v_mfma_f32_16x16x32_bf16 v[192:195], v[92:95], v[232:235], 0
    v_mfma_f32_16x16x32_bf16 v[196:199], v[92:95], v[236:239], 0
    v_mfma_f32_16x16x32_bf16 v[200:203], v[96:99], v[232:235], 0
    v_mfma_f32_16x16x32_bf16 v[204:207], v[96:99], v[236:239], 0
    v_mfma_f32_16x16x32_bf16 v[208:211], v[100:103], v[232:235], 0
    v_mfma_f32_16x16x32_bf16 v[212:215], v[100:103], v[236:239], 0
    v_mfma_f32_16x16x32_bf16 v[216:219], v[104:107], v[232:235], 0
    v_mfma_f32_16x16x32_bf16 v[220:223], v[104:107], v[236:239], 0
    v_mfma_f32_16x16x32_bf16 v[224:227], v[108:111], v[232:235], 0
    v_mfma_f32_16x16x32_bf16 v[228:231], v[108:111], v[236:239], 0
    v_mfma_f32_16x16x16_bf16 v[168:171], v[128:129], v[164:165], v[168:171]
    v_mfma_f32_16x16x16_bf16 v[172:175], v[128:129], v[166:167], v[172:175]
    v_mfma_f32_16x16x16_bf16 v[176:179], v[130:131], v[164:165], v[176:179]
    v_mfma_f32_16x16x16_bf16 v[180:183], v[130:131], v[166:167], v[180:183]
    v_mfma_f32_16x16x16_bf16 v[184:187], v[132:133], v[164:165], v[184:187]
    v_mfma_f32_16x16x16_bf16 v[188:191], v[132:133], v[166:167], v[188:191]
    v_mfma_f32_16x16x16_bf16 v[192:195], v[134:135], v[164:165], v[192:195]
    v_mfma_f32_16x16x16_bf16 v[196:199], v[134:135], v[166:167], v[196:199]
    v_mfma_f32_16x16x16_bf16 v[200:203], v[136:137], v[164:165], v[200:203]
    v_mfma_f32_16x16x16_bf16 v[204:207], v[136:137], v[166:167], v[204:207]
    v_mfma_f32_16x16x16_bf16 v[208:211], v[138:139], v[164:165], v[208:211]
    v_mfma_f32_16x16x16_bf16 v[212:215], v[138:139], v[166:167], v[212:215]
    v_mfma_f32_16x16x16_bf16 v[216:219], v[140:141], v[164:165], v[216:219]
    v_mfma_f32_16x16x16_bf16 v[220:223], v[140:141], v[166:167], v[220:223]
    v_mfma_f32_16x16x16_bf16 v[224:227], v[142:143], v[164:165], v[224:227]
    v_mfma_f32_16x16x16_bf16 v[228:231], v[142:143], v[166:167], v[228:231]
    v_pk_mul_f32 v[168:169], v[168:169], v[240:241] op_sel_hi:[1,0]
    v_pk_mul_f32 v[176:177], v[176:177], v[240:241] op_sel_hi:[1,0]
    v_pk_mul_f32 v[170:171], v[170:171], v[240:241] op_sel_hi:[1,0]
    v_pk_mul_f32 v[178:179], v[178:179], v[240:241] op_sel_hi:[1,0]
    v_cvt_pk_bf16_f32 v16, v168, v176
    v_cvt_pk_bf16_f32 v17, v169, v177
    v_cvt_pk_bf16_f32 v18, v170, v178
    v_cvt_pk_bf16_f32 v19, v171, v179
    v_pk_mul_f32 v[172:173], v[172:173], v[242:243] op_sel_hi:[1,0]
    v_pk_mul_f32 v[180:181], v[180:181], v[242:243] op_sel_hi:[1,0]
    v_pk_mul_f32 v[174:175], v[174:175], v[242:243] op_sel_hi:[1,0]
    v_pk_mul_f32 v[182:183], v[182:183], v[242:243] op_sel_hi:[1,0]
    v_cvt_pk_bf16_f32 v20, v172, v180
    v_cvt_pk_bf16_f32 v21, v173, v181
    v_cvt_pk_bf16_f32 v22, v174, v182
    v_cvt_pk_bf16_f32 v23, v175, v183
    v_pk_mul_f32 v[184:185], v[184:185], v[240:241] op_sel_hi:[1,0]
    v_pk_mul_f32 v[192:193], v[192:193], v[240:241] op_sel_hi:[1,0]
    v_pk_mul_f32 v[186:187], v[186:187], v[240:241] op_sel_hi:[1,0]
    v_pk_mul_f32 v[194:195], v[194:195], v[240:241] op_sel_hi:[1,0]
    v_cvt_pk_bf16_f32 v24, v184, v192
    v_cvt_pk_bf16_f32 v25, v185, v193
    v_cvt_pk_bf16_f32 v26, v186, v194
    v_cvt_pk_bf16_f32 v27, v187, v195
    v_pk_mul_f32 v[188:189], v[188:189], v[242:243] op_sel_hi:[1,0]
    v_pk_mul_f32 v[196:197], v[196:197], v[242:243] op_sel_hi:[1,0]
    v_pk_mul_f32 v[190:191], v[190:191], v[242:243] op_sel_hi:[1,0]
    v_pk_mul_f32 v[198:199], v[198:199], v[242:243] op_sel_hi:[1,0]
    v_cvt_pk_bf16_f32 v28, v188, v196
    v_cvt_pk_bf16_f32 v29, v189, v197
    v_cvt_pk_bf16_f32 v30, v190, v198
    v_cvt_pk_bf16_f32 v31, v191, v199
    v_pk_mul_f32 v[200:201], v[200:201], v[240:241] op_sel_hi:[1,0]
    v_pk_mul_f32 v[208:209], v[208:209], v[240:241] op_sel_hi:[1,0]
    v_pk_mul_f32 v[202:203], v[202:203], v[240:241] op_sel_hi:[1,0]
    v_pk_mul_f32 v[210:211], v[210:211], v[240:241] op_sel_hi:[1,0]
    v_cvt_pk_bf16_f32 v32, v200, v208
    v_cvt_pk_bf16_f32 v33, v201, v209
    v_cvt_pk_bf16_f32 v34, v202, v210
    v_cvt_pk_bf16_f32 v35, v203, v211
    v_pk_mul_f32 v[204:205], v[204:205], v[242:243] op_sel_hi:[1,0]
    v_pk_mul_f32 v[212:213], v[212:213], v[242:243] op_sel_hi:[1,0]
    v_pk_mul_f32 v[206:207], v[206:207], v[242:243] op_sel_hi:[1,0]
    v_pk_mul_f32 v[214:215], v[214:215], v[242:243] op_sel_hi:[1,0]
    v_cvt_pk_bf16_f32 v36, v204, v212
    v_cvt_pk_bf16_f32 v37, v205, v213
    v_cvt_pk_bf16_f32 v38, v206, v214
    v_cvt_pk_bf16_f32 v39, v207, v215
    v_pk_mul_f32 v[216:217], v[216:217], v[240:241] op_sel_hi:[1,0]
    v_pk_mul_f32 v[224:225], v[224:225], v[240:241] op_sel_hi:[1,0]
    v_pk_mul_f32 v[218:219], v[218:219], v[240:241] op_sel_hi:[1,0]
    v_pk_mul_f32 v[226:227], v[226:227], v[240:241] op_sel_hi:[1,0]
    v_cvt_pk_bf16_f32 v40, v216, v224
    v_cvt_pk_bf16_f32 v41, v217, v225
    v_cvt_pk_bf16_f32 v42, v218, v226
    v_cvt_pk_bf16_f32 v43, v219, v227
    v_pk_mul_f32 v[220:221], v[220:221], v[242:243] op_sel_hi:[1,0]
    v_pk_mul_f32 v[228:229], v[228:229], v[242:243] op_sel_hi:[1,0]
    v_pk_mul_f32 v[222:223], v[222:223], v[242:243] op_sel_hi:[1,0]
    v_pk_mul_f32 v[230:231], v[230:231], v[242:243] op_sel_hi:[1,0]
    v_cvt_pk_bf16_f32 v44, v220, v228
    v_cvt_pk_bf16_f32 v45, v221, v229
    v_cvt_pk_bf16_f32 v46, v222, v230
    v_cvt_pk_bf16_f32 v47, v223, v231
    v_mfma_f32_16x16x32_bf16 v[48:51], a[0:3], v[16:19], 0
    v_mfma_f32_16x16x32_bf16 v[52:55], a[0:3], v[20:23], 0
    v_mfma_f32_16x16x32_bf16 v[56:59], a[16:19], v[16:19], 0
    v_mfma_f32_16x16x32_bf16 v[60:63], a[16:19], v[20:23], 0
    v_mfma_f32_16x16x32_bf16 v[64:67], a[32:35], v[16:19], 0
    v_mfma_f32_16x16x32_bf16 v[68:71], a[32:35], v[20:23], 0
    v_mfma_f32_16x16x32_bf16 v[72:75], a[48:51], v[16:19], 0
    v_mfma_f32_16x16x32_bf16 v[76:79], a[48:51], v[20:23], 0
    v_mfma_f32_16x16x32_bf16 v[80:83], a[64:67], v[16:19], 0
    v_mfma_f32_16x16x32_bf16 v[84:87], a[64:67], v[20:23], 0
    v_mfma_f32_16x16x32_bf16 v[88:91], a[80:83], v[16:19], 0
    v_mfma_f32_16x16x32_bf16 v[92:95], a[80:83], v[20:23], 0
    v_mfma_f32_16x16x32_bf16 v[96:99], a[96:99], v[16:19], 0
    v_mfma_f32_16x16x32_bf16 v[100:103], a[96:99], v[20:23], 0
    v_mfma_f32_16x16x32_bf16 v[104:107], a[112:115], v[16:19], 0
    v_mfma_f32_16x16x32_bf16 v[108:111], a[112:115], v[20:23], 0
    v_mfma_f32_16x16x32_bf16 v[112:115], a[128:131], v[16:19], 0
    v_mfma_f32_16x16x32_bf16 v[116:119], a[128:131], v[20:23], 0
    v_mfma_f32_16x16x32_bf16 v[48:51], a[4:7], v[24:27], v[48:51]
    v_mfma_f32_16x16x32_bf16 v[52:55], a[4:7], v[28:31], v[52:55]
    v_mfma_f32_16x16x32_bf16 v[56:59], a[20:23], v[24:27], v[56:59]
    v_mfma_f32_16x16x32_bf16 v[60:63], a[20:23], v[28:31], v[60:63]
    v_mfma_f32_16x16x32_bf16 v[64:67], a[36:39], v[24:27], v[64:67]
    v_mfma_f32_16x16x32_bf16 v[68:71], a[36:39], v[28:31], v[68:71]
    v_mfma_f32_16x16x32_bf16 v[72:75], a[52:55], v[24:27], v[72:75]
    v_mfma_f32_16x16x32_bf16 v[76:79], a[52:55], v[28:31], v[76:79]
    v_mfma_f32_16x16x32_bf16 v[80:83], a[68:71], v[24:27], v[80:83]
    v_mfma_f32_16x16x32_bf16 v[84:87], a[68:71], v[28:31], v[84:87]
    v_mfma_f32_16x16x32_bf16 v[88:91], a[84:87], v[24:27], v[88:91]
    v_mfma_f32_16x16x32_bf16 v[92:95], a[84:87], v[28:31], v[92:95]
    v_mfma_f32_16x16x32_bf16 v[96:99], a[100:103], v[24:27], v[96:99]
    v_mfma_f32_16x16x32_bf16 v[100:103], a[100:103], v[28:31], v[100:103]
    v_mfma_f32_16x16x32_bf16 v[104:107], a[116:119], v[24:27], v[104:107]
    v_mfma_f32_16x16x32_bf16 v[108:111], a[116:119], v[28:31], v[108:111]
    v_mfma_f32_16x16x32_bf16 v[112:115], a[132:135], v[24:27], v[112:115]
    v_mfma_f32_16x16x32_bf16 v[116:119], a[132:135], v[28:31], v[116:119]
    v_mfma_f32_16x16x32_bf16 v[48:51], a[8:11], v[32:35], v[48:51]
    v_mfma_f32_16x16x32_bf16 v[52:55], a[8:11], v[36:39], v[52:55]
    v_mfma_f32_16x16x32_bf16 v[56:59], a[24:27], v[32:35], v[56:59]
    v_mfma_f32_16x16x32_bf16 v[60:63], a[24:27], v[36:39], v[60:63]
    v_mfma_f32_16x16x32_bf16 v[64:67], a[40:43], v[32:35], v[64:67]
    v_mfma_f32_16x16x32_bf16 v[68:71], a[40:43], v[36:39], v[68:71]
    v_mfma_f32_16x16x32_bf16 v[72:75], a[56:59], v[32:35], v[72:75]
    v_mfma_f32_16x16x32_bf16 v[76:79], a[56:59], v[36:39], v[76:79]
    v_mfma_f32_16x16x32_bf16 v[80:83], a[72:75], v[32:35], v[80:83]
    v_mfma_f32_16x16x32_bf16 v[84:87], a[72:75], v[36:39], v[84:87]
    v_mfma_f32_16x16x32_bf16 v[88:91], a[88:91], v[32:35], v[88:91]
    v_mfma_f32_16x16x32_bf16 v[92:95], a[88:91], v[36:39], v[92:95]
    v_mfma_f32_16x16x32_bf16 v[96:99], a[104:107], v[32:35], v[96:99]
    v_mfma_f32_16x16x32_bf16 v[100:103], a[104:107], v[36:39], v[100:103]
    v_mfma_f32_16x16x32_bf16 v[104:107], a[120:123], v[32:35], v[104:107]
    v_mfma_f32_16x16x32_bf16 v[108:111], a[120:123], v[36:39], v[108:111]
    v_mfma_f32_16x16x32_bf16 v[112:115], a[136:139], v[32:35], v[112:115]
    v_mfma_f32_16x16x32_bf16 v[116:119], a[136:139], v[36:39], v[116:119]
    v_mfma_f32_16x16x32_bf16 v[48:51], a[12:15], v[40:43], v[48:51]
    v_mfma_f32_16x16x32_bf16 v[52:55], a[12:15], v[44:47], v[52:55]
    v_mfma_f32_16x16x32_bf16 v[56:59], a[28:31], v[40:43], v[56:59]
    v_mfma_f32_16x16x32_bf16 v[60:63], a[28:31], v[44:47], v[60:63]
    v_mfma_f32_16x16x32_bf16 v[64:67], a[44:47], v[40:43], v[64:67]
    v_mfma_f32_16x16x32_bf16 v[68:71], a[44:47], v[44:47], v[68:71]
    v_mfma_f32_16x16x32_bf16 v[72:75], a[60:63], v[40:43], v[72:75]
    v_mfma_f32_16x16x32_bf16 v[76:79], a[60:63], v[44:47], v[76:79]
    v_mfma_f32_16x16x32_bf16 v[80:83], a[76:79], v[40:43], v[80:83]
    v_mfma_f32_16x16x32_bf16 v[84:87], a[76:79], v[44:47], v[84:87]
    v_mfma_f32_16x16x32_bf16 v[88:91], a[92:95], v[40:43], v[88:91]
    v_mfma_f32_16x16x32_bf16 v[92:95], a[92:95], v[44:47], v[92:95]
    v_mfma_f32_16x16x32_bf16 v[96:99], a[108:111], v[40:43], v[96:99]
    v_mfma_f32_16x16x32_bf16 v[100:103], a[108:111], v[44:47], v[100:103]
    v_mfma_f32_16x16x32_bf16 v[104:107], a[124:127], v[40:43], v[104:107]
    v_mfma_f32_16x16x32_bf16 v[108:111], a[124:127], v[44:47], v[108:111]
    v_mfma_f32_16x16x32_bf16 v[112:115], a[140:143], v[40:43], v[112:115]
    v_mfma_f32_16x16x32_bf16 v[116:119], a[140:143], v[44:47], v[116:119]
    s_barrier
    ds_write_b128 v6, v[48:51] offset:0
    ds_write_b128 v6, v[52:55] offset:1024
    ds_write_b128 v6, v[56:59] offset:2048
    ds_write_b128 v6, v[60:63] offset:3072
    ds_write_b128 v6, v[64:67] offset:4096
    ds_write_b128 v6, v[68:71] offset:5120
    ds_write_b128 v6, v[72:75] offset:6144
    ds_write_b128 v6, v[76:79] offset:7168
    ds_write_b128 v6, v[80:83] offset:8192
    ds_write_b128 v6, v[84:87] offset:9216
    ds_write_b128 v6, v[88:91] offset:10240
    ds_write_b128 v6, v[92:95] offset:11264
    ds_write_b128 v6, v[96:99] offset:12288
    ds_write_b128 v6, v[100:103] offset:13312
    ds_write_b128 v6, v[104:107] offset:14336
    ds_write_b128 v6, v[108:111] offset:15360
    ds_write_b128 v6, v[112:115] offset:16384
    ds_write_b128 v6, v[116:119] offset:17408
    s_waitcnt lgkmcnt(0)
    s_barrier
    s_and_b32 s26, s14, 1
    s_mul_i32 s26, s26, 589824
    s_add_u32 s48, s68, s26
    s_addc_u32 s49, s69, 0
    s_and_b32 s27, s9, 31
    s_mul_i32 s27, s27, 18432
    s_add_u32 s46, s48, s27
    s_addc_u32 s47, s49, 0
    s_bfe_u32 s15, s14, 0x10001
    s_lshl_b32 s26, s8, 10
    v_add_u32 v2, s26, v1
    v_add_u32 v12, 36864, v2
    ds_read_b128 v[168:171], v2 offset:0
    ds_read_b128 v[172:175], v2 offset:18432
    ds_read_b128 v[176:179], v12 offset:0
    ds_read_b128 v[180:183], v12 offset:18432
    ds_read_b128 v[184:187], v2 offset:4096
    ds_read_b128 v[188:191], v2 offset:22528
    ds_read_b128 v[192:195], v12 offset:4096
    ds_read_b128 v[196:199], v12 offset:22528
    ds_read_b128 v[200:203], v2 offset:8192
    ds_read_b128 v[204:207], v2 offset:26624
    ds_read_b128 v[208:211], v12 offset:8192
    ds_read_b128 v[212:215], v12 offset:26624
    s_waitcnt lgkmcnt(8)
    v_pk_add_f32 v[168:169], v[168:169], v[172:173]
    v_pk_add_f32 v[176:177], v[176:177], v[180:181]
    v_pk_add_f32 v[170:171], v[170:171], v[174:175]
    v_pk_add_f32 v[178:179], v[178:179], v[182:183]
    v_pk_add_f32 v[168:169], v[168:169], v[176:177]
    v_pk_add_f32 v[170:171], v[170:171], v[178:179]
    v_and_or_b32 v168, v168, -2, s15
    global_store_dwordx4 v7, v[168:171], s[46:47] offset:0
    ds_read_b128 v[216:219], v2 offset:12288
    ds_read_b128 v[220:223], v2 offset:30720
    ds_read_b128 v[224:227], v12 offset:12288
    ds_read_b128 v[228:231], v12 offset:30720
    s_waitcnt lgkmcnt(8)
    v_pk_add_f32 v[184:185], v[184:185], v[188:189]
    v_pk_add_f32 v[192:193], v[192:193], v[196:197]
    v_pk_add_f32 v[186:187], v[186:187], v[190:191]
    v_pk_add_f32 v[194:195], v[194:195], v[198:199]
    v_pk_add_f32 v[184:185], v[184:185], v[192:193]
    v_pk_add_f32 v[186:187], v[186:187], v[194:195]
    v_and_or_b32 v184, v184, -2, s15
    global_store_dwordx4 v7, v[184:187], s[46:47] offset:128
    s_waitcnt lgkmcnt(4)
    v_pk_add_f32 v[200:201], v[200:201], v[204:205]
    v_pk_add_f32 v[208:209], v[208:209], v[212:213]
    v_pk_add_f32 v[202:203], v[202:203], v[206:207]
    v_pk_add_f32 v[210:211], v[210:211], v[214:215]
    v_pk_add_f32 v[200:201], v[200:201], v[208:209]
    v_pk_add_f32 v[202:203], v[202:203], v[210:211]
    v_and_or_b32 v200, v200, -2, s15
    global_store_dwordx4 v7, v[200:203], s[46:47] offset:256
    s_waitcnt lgkmcnt(0)
    v_pk_add_f32 v[216:217], v[216:217], v[220:221]
    v_pk_add_f32 v[224:225], v[224:225], v[228:229]
    v_pk_add_f32 v[218:219], v[218:219], v[222:223]
    v_pk_add_f32 v[226:227], v[226:227], v[230:231]
    v_pk_add_f32 v[216:217], v[216:217], v[224:225]
    v_pk_add_f32 v[218:219], v[218:219], v[226:227]
    v_and_or_b32 v216, v216, -2, s15
    global_store_dwordx4 v7, v[216:219], s[46:47] offset:384
    s_cmp_ge_u32 s8, 2
    s_cbranch_scc1 L_r4_72
    ds_read_b128 v[232:235], v2 offset:16384
    ds_read_b128 v[236:239], v2 offset:34816
    ds_read_b128 v[240:243], v12 offset:16384
    ds_read_b128 v[244:247], v12 offset:34816
    s_waitcnt lgkmcnt(0)
    v_pk_add_f32 v[232:233], v[232:233], v[236:237]
    v_pk_add_f32 v[240:241], v[240:241], v[244:245]
    v_pk_add_f32 v[234:235], v[234:235], v[238:239]
    v_pk_add_f32 v[242:243], v[242:243], v[246:247]
    v_pk_add_f32 v[232:233], v[232:233], v[240:241]
    v_pk_add_f32 v[234:235], v[234:235], v[242:243]
    v_and_or_b32 v232, v232, -2, s15
    global_store_dwordx4 v7, v[232:235], s[46:47] offset:512
L_r4_72:
    s_cmp_eq_u32 s8, 3
    s_cbranch_scc1 L_fin_end_73
    s_lshl_b32 s26, s13, 5
    s_mul_i32 s27, s26, 2304
    s_add_u32 s27, s27, 88080384
    s_add_u32 s52, s4, s27
    s_addc_u32 s53, s5, 0
    global_load_dwordx4 v[200:203], v9, s[52:53] sc1
    s_add_u32 s52, s52, 4718592
    s_addc_u32 s53, s53, 0
    global_load_dwordx4 v[204:207], v9, s[52:53] sc1
    s_add_u32 s52, s52, 4718592
    s_addc_u32 s53, s53, 0
    global_load_dwordx4 v[208:211], v9, s[52:53] sc1
    s_add_u32 s52, s52, 4718592
    s_addc_u32 s53, s53, 0
    global_load_dwordx4 v[212:215], v9, s[52:53] sc1
    global_load_dword v216, v15, s[54:55] sc1
    s_mul_i32 s26, s12, 18432
    s_add_u32 s44, s48, s26
    s_addc_u32 s45, s49, 0
L_fp_74:
    v_mov_b32 v2, v8
    global_load_dwordx4 v[16:19], v2, s[44:45] sc1
    v_add_u32 v2, 73728, v2
    global_load_dwordx4 v[20:23], v2, s[44:45] sc1
    v_add_u32 v2, 73728, v2
    global_load_dwordx4 v[24:27], v2, s[44:45] sc1
    v_add_u32 v2, 73728, v2
    global_load_dwordx4 v[28:31], v2, s[44:45] sc1
    v_add_u32 v2, 73728, v2
    global_load_dwordx4 v[32:35], v2, s[44:45] sc1
    v_add_u32 v2, 73728, v2
    global_load_dwordx4 v[36:39], v2, s[44:45] sc1
    v_add_u32 v2, 73728, v2
    global_load_dwordx4 v[40:43], v2, s[44:45] sc1
    v_add_u32 v2, 73728, v2
    global_load_dwordx4 v[44:47], v2, s[44:45] sc1
    s_waitcnt vmcnt(0)
    v_xor_b32 v12, s15, v16
    v_bitop3_b32 v12, v20, s15, v12 bitop3:0xbe
    v_bitop3_b32 v12, v24, s15, v12 bitop3:0xbe
    v_bitop3_b32 v12, v28, s15, v12 bitop3:0xbe
    v_bitop3_b32 v12, v32, s15, v12 bitop3:0xbe
    v_bitop3_b32 v12, v36, s15, v12 bitop3:0xbe
    v_bitop3_b32 v12, v40, s15, v12 bitop3:0xbe
    v_bitop3_b32 v12, v44, s15, v12 bitop3:0xbe
    v_and_b32 v12, 1, v12
    v_cmp_ne_u32 vcc, 0, v12
    s_cbranch_vccz L_fpok_76
    s_sub_u32 s43, s43, 1
    s_cbranch_scc1 L_bail
    s_sleep 2
    s_branch L_fp_74
L_fpok_76:
    v_pk_add_f32 v[16:17], v[16:17], v[20:21]
    v_pk_add_f32 v[18:19], v[18:19], v[22:23]
    v_pk_add_f32 v[24:25], v[24:25], v[28:29]
    v_pk_add_f32 v[26:27], v[26:27], v[30:31]
    v_pk_add_f32 v[32:33], v[32:33], v[36:37]
    v_pk_add_f32 v[34:35], v[34:35], v[38:39]
    v_pk_add_f32 v[40:41], v[40:41], v[44:45]
    v_pk_add_f32 v[42:43], v[42:43], v[46:47]
    v_pk_add_f32 v[16:17], v[16:17], v[24:25]
    v_pk_add_f32 v[18:19], v[18:19], v[26:27]
    v_pk_add_f32 v[32:33], v[32:33], v[40:41]
    v_pk_add_f32 v[34:35], v[34:35], v[42:43]
    v_pk_add_f32 v[16:17], v[16:17], v[32:33]
    v_pk_add_f32 v[18:19], v[18:19], v[34:35]
    v_pk_add_f32 v[200:201], v[200:201], v[204:205]
    v_pk_add_f32 v[208:209], v[208:209], v[212:213]
    v_pk_add_f32 v[202:203], v[202:203], v[206:207]
    v_pk_add_f32 v[210:211], v[210:211], v[214:215]
    v_pk_add_f32 v[200:201], v[200:201], v[208:209]
    v_pk_add_f32 v[202:203], v[202:203], v[210:211]
    v_sub_f32 v216, 1.0, v216
    v_fma_f32 v16, v200, v216, v16
    v_fma_f32 v17, v201, v216, v17
    v_fma_f32 v18, v202, v216, v18
    v_fma_f32 v19, v203, v216, v19
    v_cvt_pk_bf16_f32 v16, v16, v17
    v_cvt_pk_bf16_f32 v17, v18, v19
    s_mul_i32 s26, s13, 36864
    s_add_u32 s44, s50, s26
    s_addc_u32 s45, s51, 0
    s_cmp_lg_u32 s8, 2
    s_cbranch_scc1 L_fo_77
    s_mov_b32 exec_lo, 0x0000ffff
    s_mov_b32 exec_hi, 0
L_fo_77:
    global_store_dwordx2 v14, v[16:17], s[44:45]
    s_mov_b64 exec, -1
L_fin_end_73:
    s_add_u32 s14, s14, 1
    s_add_u32 s13, s13, 7
    s_cmp_lt_u32 s13, 64
    s_cbranch_scc1 L_w3loop_65
    s_waitcnt vmcnt(0)
    s_branch L_end
L_team:
    s_load_dwordx2 s[60:61], s[0:1], 16
    s_load_dwordx2 s[62:63], s[0:1], 24
    s_load_dwordx2 s[64:65], s[0:1], 32
    s_load_dwordx2 s[66:67], s[0:1], 40
    s_load_dwordx2 s[68:69], s[0:1], 8
    s_waitcnt lgkmcnt(0)
    v_lshlrev_b32 v10, 4, v0
    s_mul_i32 s38, s9, 9504
    v_add_u32 v10, s38, v10
    v_mov_b32 v12, -1
    v_mov_b32 v13, -1
    v_mov_b32 v14, -1
    v_mov_b32 v15, -1
    s_add_u32 s20, s4, 41943040
    s_addc_u32 s21, s5, 0
    s_add_u32 s22, s4, 42247168
    s_addc_u32 s23, s5, 0
    global_store_dwordx4 v10, v[12:15], s[20:21]
    v_add_u32 v11, 4096, v10
    global_store_dwordx4 v11, v[12:15], s[20:21]
    global_store_dwordx4 v10, v[12:15], s[22:23]
    v_add_u32 v11, 4096, v10
    global_store_dwordx4 v11, v[12:15], s[22:23]
    v_cmp_gt_u32 vcc, 82, v0
    s_and_saveexec_b64 s[50:51], vcc
    s_cbranch_execz L_ci_78
    v_add_u32 v11, 8192, v10
    global_store_dwordx4 v11, v[12:15], s[20:21]
    global_store_dwordx4 v11, v[12:15], s[22:23]
L_ci_78:
    s_mov_b64 exec, s[50:51]
    s_add_u32 s34, s4, 44040192
    s_addc_u32 s35, s5, 0
    s_add_u32 s32, s4, 44056576
    s_addc_u32 s33, s5, 0
    v_mov_b32 v50, 0
    v_cmp_gt_u32 vcc, 18, v0
    s_and_saveexec_b64 s[50:51], vcc
    s_cbranch_execz L_mi_79
    s_mul_i32 s38, s9, 18
    v_add_u32 v16, s38, v0
    v_lshlrev_b32 v50, 4, v16
    global_store_dwordx4 v50, v[12:15], s[32:33]
    v_and_b32 v18, 15, v16
    v_lshrrev_b32 v19, 2, v18
    v_lshlrev_b32 v19, 1, v19
    v_and_b32 v20, 1, v18
    v_add_u32 v19, v19, v20
    v_mul_u32_u24 v19, 1152, v19
    v_lshrrev_b32 v20, 6, v16
    v_bfe_u32 v21, v16, 4, 2
    v_and_b32 v22, 3, v20
    v_mul_u32_u24 v22, 144, v22
    v_bfe_u32 v23, v20, 2, 1
    v_lshl_add_u32 v22, v23, 6, v22
    v_lshl_add_u32 v22, v21, 4, v22
    v_mul_u32_u24 v23, 144, v21
    v_add_u32 v23, 128, v23
    v_cmp_eq_u32 vcc, 8, v20
    s_nop 1
    v_cndmask_b32 v22, v22, v23, vcc
    v_lshl_add_u32 v19, v22, 1, v19
    v_bfe_u32 v20, v18, 1, 1
    v_lshl_add_u32 v19, v20, 4, v19
    global_load_dwordx4 v[46:49], v19, s[68:69]
L_mi_79:
    s_mov_b64 exec, s[50:51]
    v_and_b32 v74, 63, v0
    v_and_b32 v75, 15, v74
    v_lshrrev_b32 v76, 4, v74
    s_mul_i32 s38, s8, 36864
    v_lshlrev_b32 v0, 4, v74
    v_add_u32 v0, s38, v0
    v_bfe_u32 v77, v74, 1, 1
    v_mov_b32 v1, 0x4444
    v_mov_b32 v78, 0xEEEE
    v_cmp_eq_u32 vcc, 1, v77
    s_nop 1
    v_cndmask_b32 v1, v1, v78, vcc
    s_cmp_lt_u32 s8, 2
    s_cselect_b32 s38, 0, 2304
    s_add_u32 s38, s38, 155648
    s_and_b32 s39, s8, 1
    s_lshl_b32 s39, s39, 7
    s_add_u32 s38, s38, s39
    v_mul_u32_u24 v2, 576, v76
    v_lshl_add_u32 v2, v75, 3, v2
    v_add_u32 v2, s38, v2
    v_and_b32 v77, 7, v74
    v_mul_u32_u24 v3, 288, v77
    v_lshl_add_u32 v3, v76, 4, v3
    v_add_u32 v3, 155648, v3
    v_lshrrev_b32 v77, 2, v75
    v_lshlrev_b32 v77, 1, v77
    v_and_b32 v78, 1, v75
    v_add_u32 v77, v77, v78
    v_mul_u32_u24 v4, 288, v77
    v_lshl_add_u32 v4, v76, 4, v4
    v_bfe_u32 v78, v74, 1, 1
    v_lshl_add_u32 v4, v78, 6, v4
    v_add_u32 v4, 157952, v4
    v_lshrrev_b32 v77, 1, v76
    v_lshlrev_b32 v77, 2, v77
    v_lshrrev_b32 v78, 2, v75
    v_add_u32 v77, v77, v78
    v_lshlrev_b32 v77, 1, v77
    s_lshl_b32 s38, s8, 4
    v_add_u32 v77, s38, v77
    v_mul_u32_u24 v5, 4224, v77
    v_and_b32 v77, 1, v76
    v_lshlrev_b32 v77, 2, v77
    v_and_b32 v78, 3, v75
    v_add_u32 v77, v77, v78
    v_lshl_add_u32 v5, v77, 4, v5
    s_lshl_b32 s38, s9, 7
    s_add_u32 s38, s38, 2112
    v_add_u32 v5, s38, v5
    v_and_b32 v78, 7, v74
    s_cmp_ge_u32 s8, 2
    s_cbranch_scc1 L_c_w2_80
    v_bfe_u32 v77, v74, 3, 1
    v_lshlrev_b32 v77, 2, v77
    v_add_u32 v77, v77, v76
    v_lshlrev_b32 v6, 9, v77
    v_lshl_add_u32 v6, v78, 4, v6
    s_lshl_b32 s38, s9, 1
    s_add_u32 s38, s38, s8
    s_mul_i32 s38, s38, 4224
    v_add_u32 v6, s38, v6
    s_lshr_b32 s38, s9, 3
    s_lshl_b32 s38, s38, 6
    s_and_b32 s39, s9, 3
    s_lshl_b32 s39, s39, 4
    s_add_u32 s38, s38, s39
    s_lshl_b32 s39, s8, 8
    s_add_u32 s38, s38, s39
    v_and_b32 v77, 3, v74
    v_lshlrev_b32 v77, 2, v77
    v_add_u32 v77, s38, v77
    v_and_b32 v73, 1, v76
    s_bfe_u32 s38, s9, 0x10002
    s_lshl_b32 s38, s38, 1
    v_bfe_u32 v72, v74, 2, 1
    v_add_u32 v72, s38, v72
    s_branch L_c_done_81
L_c_w2_80:
    v_bfe_u32 v77, v74, 3, 1
    v_lshlrev_b32 v77, 2, v77
    v_add_u32 v77, v77, v76
    v_lshlrev_b32 v6, 9, v77
    v_lshl_add_u32 v6, v78, 4, v6
    s_and_b32 s39, s9, 7
    s_add_u32 s38, s39, 64
    s_mul_i32 s38, s38, 4224
    v_add_u32 v6, s38, v6
    s_lshr_b32 s38, s39, 1
    s_lshl_b32 s38, s38, 4
    s_add_u32 s38, s38, 512
    v_lshlrev_b32 v77, 2, v78
    v_and_b32 v72, 1, v76
    v_lshl_add_u32 v77, v72, 1, v77
    v_lshrrev_b32 v72, 4, v77
    v_and_b32 v77, 15, v77
    v_add_u32 v77, s38, v77
    v_mov_b32 v73, 0
    s_and_b32 s38, s9, 1
    s_lshl_b32 s38, s38, 1
    v_add_u32 v72, s38, v72
L_c_done_81:
    v_lshrrev_b32 v78, 6, v77
    v_lshlrev_b32 v7, 10, v78
    v_bfe_u32 v78, v77, 4, 2
    v_lshl_add_u32 v7, v78, 8, v7
    v_bfe_u32 v78, v77, 3, 1
    v_lshl_add_u32 v7, v78, 5, v7
    v_and_b32 v78, 7, v77
    v_lshl_add_u32 v7, v78, 1, v7
    v_lshl_add_u32 v7, v73, 4, v7
    v_lshl_add_u32 v7, v72, 6, v7
    v_and_b32 v77, 1, v75
    v_lshlrev_b32 v77, 4, v77
    v_mov_b32 v78, 0x3f80
    v_lshlrev_b32 v78, v77, v78
    v_lshrrev_b32 v77, 1, v75
    v_cmp_eq_u32 vcc, 0, v77
    s_nop 1
    v_cndmask_b32 v60, 0, v78, vcc
    v_cmp_eq_u32 vcc, 1, v77
    s_nop 1
    v_cndmask_b32 v61, 0, v78, vcc
    v_cmp_eq_u32 vcc, 2, v77
    s_nop 1
    v_cndmask_b32 v62, 0, v78, vcc
    v_cmp_eq_u32 vcc, 3, v77
    s_nop 1
    v_cndmask_b32 v63, 0, v78, vcc
    v_lshlrev_b32 v77, 4, v74
    v_add_u32 v77, 162560, v77
    ds_write_b128 v77, v[60:63]
    s_waitcnt lgkmcnt(0)
    s_lshl_b32 s52, s8, 6
    s_add_u32 s52, s52, 4608
    s_mul_i32 s38, s8, 36864
    s_sub_u32 s53, 147456, s38
    s_mov_b32 s37, 0x3e0293ee
    s_mov_b32 s44, 0x05040100
    s_mov_b32 s45, 0x07060302
    s_mul_i32 s38, s8, 36864
    v_subrev_u32 v74, s38, v0
    v_lshrrev_b32 v74, 4, v74
    v_and_b32 v75, 15, v74
    v_lshrrev_b32 v76, 4, v74
    v_lshrrev_b32 v77, 1, v76
    v_lshlrev_b32 v77, 4, v77
    v_and_b32 v78, 1, v76
    v_lshl_add_u32 v77, v78, 2, v77
    v_lshlrev_b32 v79, 13, v77
    v_lshl_add_u32 v79, v75, 3, v79
    s_lshl_b32 s38, s9, 8
    v_add_u32 v79, s38, v79
    s_lshr_b32 s38, s8, 1
    s_lshl_b32 s38, s38, 7
    v_add_u32 v73, s38, v79
    s_mov_b32 s40, s64
    s_and_b32 s41, s65, 0xffff
    s_mov_b32 s42, 4718592
    s_mov_b32 s43, 0x20000
    v_lshrrev_b32 v66, 1, v76
    v_mul_u32_u24 v66, 4096, v66
    v_lshlrev_b32 v66, 8, v66
    s_lshr_b32 s38, s8, 1
    s_lshl_b32 s38, s38, 1
    v_lshrrev_b32 v78, 3, v75
    v_add_u32 v78, s38, v78
    v_mul_u32_u24 v72, 36864, v78
    v_lshl_add_u32 v72, v76, 8, v72
    v_and_b32 v78, 7, v75
    v_lshl_add_u32 v72, v78, 5, v72
    s_and_b32 s38, s8, 1
    s_lshl_b32 s38, s38, 12
    v_add_u32 v72, s38, v72
    s_cmp_lt_u32 s8, 2
    s_cselect_b32 s50, s60, s62
    s_cselect_b32 s51, s61, s63
    s_mov_b32 s84, s50
    s_and_b32 s85, s51, 0xffff
    s_mov_b32 s86, 4718592
    s_mov_b32 s87, 0x20000
    s_and_b32 s38, s8, 1
    s_lshl_b32 s38, s38, 7
    v_add_u32 v71, s38, v79
    s_mov_b32 s88, s66
    s_and_b32 s89, s67, 0xffff
    s_mov_b32 s90, 4718592
    s_mov_b32 s91, 0x20000
    v_lshrrev_b32 v77, 1, v76
    v_lshlrev_b32 v77, 3, v77
    v_and_b32 v78, 1, v76
    v_lshl_add_u32 v77, v78, 2, v77
    s_lshl_b32 s38, s9, 7
    v_add_u32 v77, s38, v77
    v_mul_u32_u24 v77, 1152, v77
    s_mul_i32 s38, s8, 288
    v_add_u32 v77, s38, v77
    v_lshl_add_u32 v70, v75, 3, v77
    v_and_b32 v78, 14, v75
    v_lshl_add_u32 v69, v78, 1, v77
    v_and_b32 v78, 1, v75
    v_mov_b32 v68, 0x05040100
    v_mov_b32 v67, 0x07060302
    v_cmp_eq_u32 vcc, 1, v78
    s_nop 1
    v_cndmask_b32 v68, v68, v67, vcc
    s_mov_b32 s38, 0
    s_bitcmp1_b32 s8, 0
    s_cselect_b32 s38, 1179648, s38
    buffer_load_dwordx2 v[80:81], v73, s[40:43], s38 offen
    s_mov_b32 s38, 8192
    s_bitcmp1_b32 s8, 0
    s_cselect_b32 s38, 1187840, s38
    buffer_load_dwordx2 v[82:83], v73, s[40:43], s38 offen
    s_mov_b32 s38, 65536
    s_bitcmp1_b32 s8, 0
    s_cselect_b32 s38, 1245184, s38
    buffer_load_dwordx2 v[84:85], v73, s[40:43], s38 offen
    s_mov_b32 s38, 73728
    s_bitcmp1_b32 s8, 0
    s_cselect_b32 s38, 1253376, s38
    buffer_load_dwordx2 v[86:87], v73, s[40:43], s38 offen
    s_mov_b32 s38, 16384
    s_bitcmp1_b32 s8, 0
    s_cselect_b32 s38, 1196032, s38
    buffer_load_dwordx2 v[88:89], v73, s[40:43], s38 offen
    s_mov_b32 s38, 24576
    s_bitcmp1_b32 s8, 0
    s_cselect_b32 s38, 1204224, s38
    buffer_load_dwordx2 v[90:91], v73, s[40:43], s38 offen
    s_mov_b32 s38, 81920
    s_bitcmp1_b32 s8, 0
    s_cselect_b32 s38, 1261568, s38
    buffer_load_dwordx2 v[92:93], v73, s[40:43], s38 offen
    s_mov_b32 s38, 90112
    s_bitcmp1_b32 s8, 0
    s_cselect_b32 s38, 1269760, s38
    buffer_load_dwordx2 v[94:95], v73, s[40:43], s38 offen
    s_mov_b32 s38, 262144
    s_bitcmp1_b32 s8, 0
    s_cselect_b32 s38, 1441792, s38
    buffer_load_dwordx2 v[96:97], v73, s[40:43], s38 offen
    s_mov_b32 s38, 270336
    s_bitcmp1_b32 s8, 0
    s_cselect_b32 s38, 1449984, s38
    buffer_load_dwordx2 v[98:99], v73, s[40:43], s38 offen
    s_mov_b32 s38, 327680
    s_bitcmp1_b32 s8, 0
    s_cselect_b32 s38, 1507328, s38
    buffer_load_dwordx2 v[100:101], v73, s[40:43], s38 offen
    s_mov_b32 s38, 335872
    s_bitcmp1_b32 s8, 0
    s_cselect_b32 s38, 1515520, s38
    buffer_load_dwordx2 v[102:103], v73, s[40:43], s38 offen
    s_mov_b32 s38, 278528
    s_bitcmp1_b32 s8, 0
    s_cselect_b32 s38, 1458176, s38
    buffer_load_dwordx2 v[104:105], v73, s[40:43], s38 offen
    s_mov_b32 s38, 286720
    s_bitcmp1_b32 s8, 0
    s_cselect_b32 s38, 1466368, s38
    buffer_load_dwordx2 v[106:107], v73, s[40:43], s38 offen
    s_mov_b32 s38, 344064
    s_bitcmp1_b32 s8, 0
    s_cselect_b32 s38, 1523712, s38
    buffer_load_dwordx2 v[108:109], v73, s[40:43], s38 offen
    s_mov_b32 s38, 352256
    s_bitcmp1_b32 s8, 0
    s_cselect_b32 s38, 1531904, s38
    buffer_load_dwordx2 v[110:111], v73, s[40:43], s38 offen
    s_mov_b32 s38, 2359296
    s_bitcmp1_b32 s8, 0
    s_cselect_b32 s38, 3538944, s38
    buffer_load_dwordx2 v[112:113], v73, s[40:43], s38 offen
    s_mov_b32 s38, 2367488
    s_bitcmp1_b32 s8, 0
    s_cselect_b32 s38, 3547136, s38
    buffer_load_dwordx2 v[114:115], v73, s[40:43], s38 offen
    s_mov_b32 s38, 2424832
    s_bitcmp1_b32 s8, 0
    s_cselect_b32 s38, 3604480, s38
    buffer_load_dwordx2 v[116:117], v73, s[40:43], s38 offen
    s_mov_b32 s38, 2433024
    s_bitcmp1_b32 s8, 0
    s_cselect_b32 s38, 3612672, s38
    buffer_load_dwordx2 v[118:119], v73, s[40:43], s38 offen
    s_mov_b32 s38, 2375680
    s_bitcmp1_b32 s8, 0
    s_cselect_b32 s38, 3555328, s38
    buffer_load_dwordx2 v[120:121], v73, s[40:43], s38 offen
    s_mov_b32 s38, 2383872
    s_bitcmp1_b32 s8, 0
    s_cselect_b32 s38, 3563520, s38
    buffer_load_dwordx2 v[122:123], v73, s[40:43], s38 offen
    s_mov_b32 s38, 2441216
    s_bitcmp1_b32 s8, 0
    s_cselect_b32 s38, 3620864, s38
    buffer_load_dwordx2 v[124:125], v73, s[40:43], s38 offen
    s_mov_b32 s38, 2449408
    s_bitcmp1_b32 s8, 0
    s_cselect_b32 s38, 3629056, s38
    buffer_load_dwordx2 v[126:127], v73, s[40:43], s38 offen
    s_mov_b32 s38, 2621440
    s_bitcmp1_b32 s8, 0
    s_cselect_b32 s38, 3801088, s38
    buffer_load_dwordx2 v[128:129], v73, s[40:43], s38 offen
    s_mov_b32 s38, 2629632
    s_bitcmp1_b32 s8, 0
    s_cselect_b32 s38, 3809280, s38
    buffer_load_dwordx2 v[130:131], v73, s[40:43], s38 offen
    s_mov_b32 s38, 2686976
    s_bitcmp1_b32 s8, 0
    s_cselect_b32 s38, 3866624, s38
    buffer_load_dwordx2 v[132:133], v73, s[40:43], s38 offen
    s_mov_b32 s38, 2695168
    s_bitcmp1_b32 s8, 0
    s_cselect_b32 s38, 3874816, s38
    buffer_load_dwordx2 v[134:135], v73, s[40:43], s38 offen
    s_mov_b32 s38, 2637824
    s_bitcmp1_b32 s8, 0
    s_cselect_b32 s38, 3817472, s38
    buffer_load_dwordx2 v[136:137], v73, s[40:43], s38 offen
    s_mov_b32 s38, 2646016
    s_bitcmp1_b32 s8, 0
    s_cselect_b32 s38, 3825664, s38
    buffer_load_dwordx2 v[138:139], v73, s[40:43], s38 offen
    s_mov_b32 s38, 2703360
    s_bitcmp1_b32 s8, 0
    s_cselect_b32 s38, 3883008, s38
    buffer_load_dwordx2 v[140:141], v73, s[40:43], s38 offen
    s_mov_b32 s38, 2711552
    s_bitcmp1_b32 s8, 0
    s_cselect_b32 s38, 3891200, s38
    buffer_load_dwordx2 v[142:143], v73, s[40:43], s38 offen
    s_mov_b32 s38, 524288
    s_bitcmp1_b32 s8, 0
    s_cselect_b32 s38, 1703936, s38
    buffer_load_dwordx2 v[144:145], v73, s[40:43], s38 offen
    s_mov_b32 s38, 532480
    s_bitcmp1_b32 s8, 0
    s_cselect_b32 s38, 1712128, s38
    buffer_load_dwordx2 v[146:147], v73, s[40:43], s38 offen
    s_mov_b32 s38, 589824
    s_bitcmp1_b32 s8, 0
    s_cselect_b32 s38, 1769472, s38
    buffer_load_dwordx2 v[148:149], v73, s[40:43], s38 offen
    s_mov_b32 s38, 598016
    s_bitcmp1_b32 s8, 0
    s_cselect_b32 s38, 1777664, s38
    buffer_load_dwordx2 v[150:151], v73, s[40:43], s38 offen
    s_mov_b32 s38, 540672
    s_bitcmp1_b32 s8, 0
    s_cselect_b32 s38, 1720320, s38
    buffer_load_dwordx2 v[152:153], v73, s[40:43], s38 offen
    s_mov_b32 s38, 548864
    s_bitcmp1_b32 s8, 0
    s_cselect_b32 s38, 1728512, s38
    buffer_load_dwordx2 v[154:155], v73, s[40:43], s38 offen
    s_mov_b32 s38, 606208
    s_bitcmp1_b32 s8, 0
    s_cselect_b32 s38, 1785856, s38
    buffer_load_dwordx2 v[156:157], v73, s[40:43], s38 offen
    s_mov_b32 s38, 614400
    s_bitcmp1_b32 s8, 0
    s_cselect_b32 s38, 1794048, s38
    buffer_load_dwordx2 v[158:159], v73, s[40:43], s38 offen
    s_mov_b32 s38, 786432
    s_bitcmp1_b32 s8, 0
    s_cselect_b32 s38, 1966080, s38
    buffer_load_dwordx2 v[160:161], v73, s[40:43], s38 offen
    s_mov_b32 s38, 794624
    s_bitcmp1_b32 s8, 0
    s_cselect_b32 s38, 1974272, s38
    buffer_load_dwordx2 v[162:163], v73, s[40:43], s38 offen
    s_mov_b32 s38, 851968
    s_bitcmp1_b32 s8, 0
    s_cselect_b32 s38, 2031616, s38
    buffer_load_dwordx2 v[164:165], v73, s[40:43], s38 offen
    s_mov_b32 s38, 860160
    s_bitcmp1_b32 s8, 0
    s_cselect_b32 s38, 2039808, s38
    buffer_load_dwordx2 v[166:167], v73, s[40:43], s38 offen
    s_mov_b32 s38, 802816
    s_bitcmp1_b32 s8, 0
    s_cselect_b32 s38, 1982464, s38
    buffer_load_dwordx2 v[168:169], v73, s[40:43], s38 offen
    s_mov_b32 s38, 811008
    s_bitcmp1_b32 s8, 0
    s_cselect_b32 s38, 1990656, s38
    buffer_load_dwordx2 v[170:171], v73, s[40:43], s38 offen
    s_mov_b32 s38, 868352
    s_bitcmp1_b32 s8, 0
    s_cselect_b32 s38, 2048000, s38
    buffer_load_dwordx2 v[172:173], v73, s[40:43], s38 offen
    s_mov_b32 s38, 876544
    s_bitcmp1_b32 s8, 0
    s_cselect_b32 s38, 2056192, s38
    buffer_load_dwordx2 v[174:175], v73, s[40:43], s38 offen
    s_waitcnt vmcnt(32)
    s_mov_b32 s38, 2883584
    s_bitcmp1_b32 s8, 0
    s_cselect_b32 s38, 4063232, s38
    buffer_load_dwordx2 v[176:177], v73, s[40:43], s38 offen
    s_mov_b32 s38, 2891776
    s_bitcmp1_b32 s8, 0
    s_cselect_b32 s38, 4071424, s38
    buffer_load_dwordx2 v[178:179], v73, s[40:43], s38 offen
    s_mov_b32 s38, 2949120
    s_bitcmp1_b32 s8, 0
    s_cselect_b32 s38, 4128768, s38
    buffer_load_dwordx2 v[180:181], v73, s[40:43], s38 offen
    s_mov_b32 s38, 2957312
    s_bitcmp1_b32 s8, 0
    s_cselect_b32 s38, 4136960, s38
    buffer_load_dwordx2 v[182:183], v73, s[40:43], s38 offen
    s_mov_b32 s38, 2899968
    s_bitcmp1_b32 s8, 0
    s_cselect_b32 s38, 4079616, s38
    buffer_load_dwordx2 v[184:185], v73, s[40:43], s38 offen
    s_mov_b32 s38, 2908160
    s_bitcmp1_b32 s8, 0
    s_cselect_b32 s38, 4087808, s38
    buffer_load_dwordx2 v[186:187], v73, s[40:43], s38 offen
    s_mov_b32 s38, 2965504
    s_bitcmp1_b32 s8, 0
    s_cselect_b32 s38, 4145152, s38
    buffer_load_dwordx2 v[188:189], v73, s[40:43], s38 offen
    s_mov_b32 s38, 2973696
    s_bitcmp1_b32 s8, 0
    s_cselect_b32 s38, 4153344, s38
    buffer_load_dwordx2 v[190:191], v73, s[40:43], s38 offen
    s_mov_b32 s38, 3145728
    s_bitcmp1_b32 s8, 0
    s_cselect_b32 s38, 4325376, s38
    buffer_load_dwordx2 v[192:193], v73, s[40:43], s38 offen
    s_mov_b32 s38, 3153920
    s_bitcmp1_b32 s8, 0
    s_cselect_b32 s38, 4333568, s38
    buffer_load_dwordx2 v[194:195], v73, s[40:43], s38 offen
    s_mov_b32 s38, 3211264
    s_bitcmp1_b32 s8, 0
    s_cselect_b32 s38, 4390912, s38
    buffer_load_dwordx2 v[196:197], v73, s[40:43], s38 offen
    s_mov_b32 s38, 3219456
    s_bitcmp1_b32 s8, 0
    s_cselect_b32 s38, 4399104, s38
    buffer_load_dwordx2 v[198:199], v73, s[40:43], s38 offen
    s_mov_b32 s38, 3162112
    s_bitcmp1_b32 s8, 0
    s_cselect_b32 s38, 4341760, s38
    buffer_load_dwordx2 v[200:201], v73, s[40:43], s38 offen
    s_mov_b32 s38, 3170304
    s_bitcmp1_b32 s8, 0
    s_cselect_b32 s38, 4349952, s38
    buffer_load_dwordx2 v[202:203], v73, s[40:43], s38 offen
    s_mov_b32 s38, 3227648
    s_bitcmp1_b32 s8, 0
    s_cselect_b32 s38, 4407296, s38
    buffer_load_dwordx2 v[204:205], v73, s[40:43], s38 offen
    s_mov_b32 s38, 3235840
    s_bitcmp1_b32 s8, 0
    s_cselect_b32 s38, 4415488, s38
    buffer_load_dwordx2 v[206:207], v73, s[40:43], s38 offen
    s_cmp_lg_u32 s8, 0
    s_cbranch_scc1 L_mi2_82
    s_mov_b32 exec_lo, 0x3ffff
    s_mov_b32 exec_hi, 0
    v_min_u32 v46, -2, v46
    v_min_u32 v47, -2, v47
    v_min_u32 v48, -2, v48
    v_min_u32 v49, -2, v49
    global_store_dwordx4 v50, v[46:49], s[34:35]
    s_mov_b64 exec, -1
L_mi2_82:
    v_perm_b32 v10, v82, v80, s44
    v_perm_b32 v18, v82, v80, s45
    v_perm_b32 v26, v83, v81, s44
    v_perm_b32 v34, v83, v81, s45
    v_perm_b32 v11, v86, v84, s44
    v_perm_b32 v19, v86, v84, s45
    v_perm_b32 v27, v87, v85, s44
    v_perm_b32 v35, v87, v85, s45
    v_perm_b32 v12, v90, v88, s44
    v_perm_b32 v20, v90, v88, s45
    v_perm_b32 v28, v91, v89, s44
    v_perm_b32 v36, v91, v89, s45
    v_perm_b32 v13, v94, v92, s44
    v_perm_b32 v21, v94, v92, s45
    v_perm_b32 v29, v95, v93, s44
    v_perm_b32 v37, v95, v93, s45
    v_perm_b32 v14, v98, v96, s44
    v_perm_b32 v22, v98, v96, s45
    v_perm_b32 v30, v99, v97, s44
    v_perm_b32 v38, v99, v97, s45
    v_perm_b32 v15, v102, v100, s44
    v_perm_b32 v23, v102, v100, s45
    v_perm_b32 v31, v103, v101, s44
    v_perm_b32 v39, v103, v101, s45
    v_perm_b32 v16, v106, v104, s44
    v_perm_b32 v24, v106, v104, s45
    v_perm_b32 v32, v107, v105, s44
    v_perm_b32 v40, v107, v105, s45
    v_perm_b32 v17, v110, v108, s44
    v_perm_b32 v25, v110, v108, s45
    v_perm_b32 v33, v111, v109, s44
    v_perm_b32 v41, v111, v109, s45
    ds_write_b128 v72, v[10:13] offset:0
    ds_write_b128 v72, v[14:17] offset:1024
    ds_write_b128 v72, v[18:21] offset:2048
    ds_write_b128 v72, v[22:25] offset:3072
    ds_write_b128 v72, v[26:29] offset:16
    ds_write_b128 v72, v[30:33] offset:1040
    ds_write_b128 v72, v[34:37] offset:2064
    ds_write_b128 v72, v[38:41] offset:3088
    s_waitcnt lgkmcnt(0)
    s_waitcnt vmcnt(32)
    v_add_u32 v65, v73, v66
    s_mov_b32 s38, 1048576
    buffer_load_dwordx2 v[80:81], v65, s[40:43], s38 offen
    s_mov_b32 s38, 1056768
    buffer_load_dwordx2 v[82:83], v65, s[40:43], s38 offen
    s_mov_b32 s38, 1114112
    buffer_load_dwordx2 v[84:85], v65, s[40:43], s38 offen
    s_mov_b32 s38, 1122304
    buffer_load_dwordx2 v[86:87], v65, s[40:43], s38 offen
    s_mov_b32 s38, 1064960
    buffer_load_dwordx2 v[88:89], v65, s[40:43], s38 offen
    s_mov_b32 s38, 1073152
    buffer_load_dwordx2 v[90:91], v65, s[40:43], s38 offen
    s_mov_b32 s38, 1130496
    buffer_load_dwordx2 v[92:93], v65, s[40:43], s38 offen
    s_mov_b32 s38, 1138688
    buffer_load_dwordx2 v[94:95], v65, s[40:43], s38 offen
    s_mov_b32 s38, 3407872
    buffer_load_dwordx2 v[96:97], v65, s[40:43], s38 offen
    s_mov_b32 s38, 3416064
    buffer_load_dwordx2 v[98:99], v65, s[40:43], s38 offen
    s_mov_b32 s38, 3473408
    buffer_load_dwordx2 v[100:101], v65, s[40:43], s38 offen
    s_mov_b32 s38, 3481600
    buffer_load_dwordx2 v[102:103], v65, s[40:43], s38 offen
    s_mov_b32 s38, 3424256
    buffer_load_dwordx2 v[104:105], v65, s[40:43], s38 offen
    s_mov_b32 s38, 3432448
    buffer_load_dwordx2 v[106:107], v65, s[40:43], s38 offen
    s_mov_b32 s38, 3489792
    buffer_load_dwordx2 v[108:109], v65, s[40:43], s38 offen
    s_mov_b32 s38, 3497984
    buffer_load_dwordx2 v[110:111], v65, s[40:43], s38 offen
    v_perm_b32 v10, v114, v112, s44
    v_perm_b32 v18, v114, v112, s45
    v_perm_b32 v26, v115, v113, s44
    v_perm_b32 v34, v115, v113, s45
    v_perm_b32 v11, v118, v116, s44
    v_perm_b32 v19, v118, v116, s45
    v_perm_b32 v27, v119, v117, s44
    v_perm_b32 v35, v119, v117, s45
    v_perm_b32 v12, v122, v120, s44
    v_perm_b32 v20, v122, v120, s45
    v_perm_b32 v28, v123, v121, s44
    v_perm_b32 v36, v123, v121, s45
    v_perm_b32 v13, v126, v124, s44
    v_perm_b32 v21, v126, v124, s45
    v_perm_b32 v29, v127, v125, s44
    v_perm_b32 v37, v127, v125, s45
    v_perm_b32 v14, v130, v128, s44
    v_perm_b32 v22, v130, v128, s45
    v_perm_b32 v30, v131, v129, s44
    v_perm_b32 v38, v131, v129, s45
    v_perm_b32 v15, v134, v132, s44
    v_perm_b32 v23, v134, v132, s45
    v_perm_b32 v31, v135, v133, s44
    v_perm_b32 v39, v135, v133, s45
    v_perm_b32 v16, v138, v136, s44
    v_perm_b32 v24, v138, v136, s45
    v_perm_b32 v32, v139, v137, s44
    v_perm_b32 v40, v139, v137, s45
    v_perm_b32 v17, v142, v140, s44
    v_perm_b32 v25, v142, v140, s45
    v_perm_b32 v33, v143, v141, s44
    v_perm_b32 v41, v143, v141, s45
    ds_write_b128 v72, v[10:13] offset:8192
    ds_write_b128 v72, v[14:17] offset:9216
    ds_write_b128 v72, v[18:21] offset:10240
    ds_write_b128 v72, v[22:25] offset:11264
    ds_write_b128 v72, v[26:29] offset:8208
    ds_write_b128 v72, v[30:33] offset:9232
    ds_write_b128 v72, v[34:37] offset:10256
    ds_write_b128 v72, v[38:41] offset:11280
    s_waitcnt lgkmcnt(0)
    s_waitcnt vmcnt(32)
    s_mov_b32 s38, 0
    buffer_load_dwordx2 a[0:1], v71, s[84:87], s38 offen
    s_mov_b32 s38, 8192
    buffer_load_dwordx2 a[2:3], v71, s[84:87], s38 offen
    s_mov_b32 s38, 65536
    buffer_load_dwordx2 a[4:5], v71, s[84:87], s38 offen
    s_mov_b32 s38, 73728
    buffer_load_dwordx2 a[6:7], v71, s[84:87], s38 offen
    s_mov_b32 s38, 16384
    buffer_load_dwordx2 a[8:9], v71, s[84:87], s38 offen
    s_mov_b32 s38, 24576
    buffer_load_dwordx2 a[10:11], v71, s[84:87], s38 offen
    s_mov_b32 s38, 81920
    buffer_load_dwordx2 a[12:13], v71, s[84:87], s38 offen
    s_mov_b32 s38, 90112
    buffer_load_dwordx2 a[14:15], v71, s[84:87], s38 offen
    s_mov_b32 s38, 262144
    buffer_load_dwordx2 a[16:17], v71, s[84:87], s38 offen
    s_mov_b32 s38, 270336
    buffer_load_dwordx2 a[18:19], v71, s[84:87], s38 offen
    s_mov_b32 s38, 327680
    buffer_load_dwordx2 a[20:21], v71, s[84:87], s38 offen
    s_mov_b32 s38, 335872
    buffer_load_dwordx2 a[22:23], v71, s[84:87], s38 offen
    s_mov_b32 s38, 278528
    buffer_load_dwordx2 a[24:25], v71, s[84:87], s38 offen
    s_mov_b32 s38, 286720
    buffer_load_dwordx2 a[26:27], v71, s[84:87], s38 offen
    s_mov_b32 s38, 344064
    buffer_load_dwordx2 a[28:29], v71, s[84:87], s38 offen
    s_mov_b32 s38, 352256
    buffer_load_dwordx2 a[30:31], v71, s[84:87], s38 offen
    v_perm_b32 v10, v146, v144, s44
    v_perm_b32 v18, v146, v144, s45
    v_perm_b32 v26, v147, v145, s44
    v_perm_b32 v34, v147, v145, s45
    v_perm_b32 v11, v150, v148, s44
    v_perm_b32 v19, v150, v148, s45
    v_perm_b32 v27, v151, v149, s44
    v_perm_b32 v35, v151, v149, s45
    v_perm_b32 v12, v154, v152, s44
    v_perm_b32 v20, v154, v152, s45
    v_perm_b32 v28, v155, v153, s44
    v_perm_b32 v36, v155, v153, s45
    v_perm_b32 v13, v158, v156, s44
    v_perm_b32 v21, v158, v156, s45
    v_perm_b32 v29, v159, v157, s44
    v_perm_b32 v37, v159, v157, s45
    v_perm_b32 v14, v162, v160, s44
    v_perm_b32 v22, v162, v160, s45
    v_perm_b32 v30, v163, v161, s44
    v_perm_b32 v38, v163, v161, s45
    v_perm_b32 v15, v166, v164, s44
    v_perm_b32 v23, v166, v164, s45
    v_perm_b32 v31, v167, v165, s44
    v_perm_b32 v39, v167, v165, s45
    v_perm_b32 v16, v170, v168, s44
    v_perm_b32 v24, v170, v168, s45
    v_perm_b32 v32, v171, v169, s44
    v_perm_b32 v40, v171, v169, s45
    v_perm_b32 v17, v174, v172, s44
    v_perm_b32 v25, v174, v172, s45
    v_perm_b32 v33, v175, v173, s44
    v_perm_b32 v41, v175, v173, s45
    ds_write_b128 v72, v[10:13] offset:16384
    ds_write_b128 v72, v[14:17] offset:17408
    ds_write_b128 v72, v[18:21] offset:18432
    ds_write_b128 v72, v[22:25] offset:19456
    ds_write_b128 v72, v[26:29] offset:16400
    ds_write_b128 v72, v[30:33] offset:17424
    ds_write_b128 v72, v[34:37] offset:18448
    ds_write_b128 v72, v[38:41] offset:19472
    s_waitcnt lgkmcnt(0)
    s_waitcnt vmcnt(32)
    s_mov_b32 s38, 1179648
    buffer_load_dwordx2 a[32:33], v71, s[84:87], s38 offen
    s_mov_b32 s38, 1187840
    buffer_load_dwordx2 a[34:35], v71, s[84:87], s38 offen
    s_mov_b32 s38, 1245184
    buffer_load_dwordx2 a[36:37], v71, s[84:87], s38 offen
    s_mov_b32 s38, 1253376
    buffer_load_dwordx2 a[38:39], v71, s[84:87], s38 offen
    s_mov_b32 s38, 1196032
    buffer_load_dwordx2 a[40:41], v71, s[84:87], s38 offen
    s_mov_b32 s38, 1204224
    buffer_load_dwordx2 a[42:43], v71, s[84:87], s38 offen
    s_mov_b32 s38, 1261568
    buffer_load_dwordx2 a[44:45], v71, s[84:87], s38 offen
    s_mov_b32 s38, 1269760
    buffer_load_dwordx2 a[46:47], v71, s[84:87], s38 offen
    s_mov_b32 s38, 1441792
    buffer_load_dwordx2 a[48:49], v71, s[84:87], s38 offen
    s_mov_b32 s38, 1449984
    buffer_load_dwordx2 a[50:51], v71, s[84:87], s38 offen
    s_mov_b32 s38, 1507328
    buffer_load_dwordx2 a[52:53], v71, s[84:87], s38 offen
    s_mov_b32 s38, 1515520
    buffer_load_dwordx2 a[54:55], v71, s[84:87], s38 offen
    s_mov_b32 s38, 1458176
    buffer_load_dwordx2 a[56:57], v71, s[84:87], s38 offen
    s_mov_b32 s38, 1466368
    buffer_load_dwordx2 a[58:59], v71, s[84:87], s38 offen
    s_mov_b32 s38, 1523712
    buffer_load_dwordx2 a[60:61], v71, s[84:87], s38 offen
    s_mov_b32 s38, 1531904
    buffer_load_dwordx2 a[62:63], v71, s[84:87], s38 offen
    v_perm_b32 v10, v178, v176, s44
    v_perm_b32 v18, v178, v176, s45
    v_perm_b32 v26, v179, v177, s44
    v_perm_b32 v34, v179, v177, s45
    v_perm_b32 v11, v182, v180, s44
    v_perm_b32 v19, v182, v180, s45
    v_perm_b32 v27, v183, v181, s44
    v_perm_b32 v35, v183, v181, s45
    v_perm_b32 v12, v186, v184, s44
    v_perm_b32 v20, v186, v184, s45
    v_perm_b32 v28, v187, v185, s44
    v_perm_b32 v36, v187, v185, s45
    v_perm_b32 v13, v190, v188, s44
    v_perm_b32 v21, v190, v188, s45
    v_perm_b32 v29, v191, v189, s44
    v_perm_b32 v37, v191, v189, s45
    v_perm_b32 v14, v194, v192, s44
    v_perm_b32 v22, v194, v192, s45
    v_perm_b32 v30, v195, v193, s44
    v_perm_b32 v38, v195, v193, s45
    v_perm_b32 v15, v198, v196, s44
    v_perm_b32 v23, v198, v196, s45
    v_perm_b32 v31, v199, v197, s44
    v_perm_b32 v39, v199, v197, s45
    v_perm_b32 v16, v202, v200, s44
    v_perm_b32 v24, v202, v200, s45
    v_perm_b32 v32, v203, v201, s44
    v_perm_b32 v40, v203, v201, s45
    v_perm_b32 v17, v206, v204, s44
    v_perm_b32 v25, v206, v204, s45
    v_perm_b32 v33, v207, v205, s44
    v_perm_b32 v41, v207, v205, s45
    ds_write_b128 v72, v[10:13] offset:24576
    ds_write_b128 v72, v[14:17] offset:25600
    ds_write_b128 v72, v[18:21] offset:26624
    ds_write_b128 v72, v[22:25] offset:27648
    ds_write_b128 v72, v[26:29] offset:24592
    ds_write_b128 v72, v[30:33] offset:25616
    ds_write_b128 v72, v[34:37] offset:26640
    ds_write_b128 v72, v[38:41] offset:27664
    s_waitcnt lgkmcnt(0)
    s_waitcnt vmcnt(32)
    s_mov_b32 s38, 2359296
    buffer_load_dwordx2 a[64:65], v71, s[84:87], s38 offen
    s_mov_b32 s38, 2367488
    buffer_load_dwordx2 a[66:67], v71, s[84:87], s38 offen
    s_mov_b32 s38, 2424832
    buffer_load_dwordx2 a[68:69], v71, s[84:87], s38 offen
    s_mov_b32 s38, 2433024
    buffer_load_dwordx2 a[70:71], v71, s[84:87], s38 offen
    s_mov_b32 s38, 2375680
    buffer_load_dwordx2 a[72:73], v71, s[84:87], s38 offen
    s_mov_b32 s38, 2383872
    buffer_load_dwordx2 a[74:75], v71, s[84:87], s38 offen
    s_mov_b32 s38, 2441216
    buffer_load_dwordx2 a[76:77], v71, s[84:87], s38 offen
    s_mov_b32 s38, 2449408
    buffer_load_dwordx2 a[78:79], v71, s[84:87], s38 offen
    s_mov_b32 s38, 2621440
    buffer_load_dwordx2 a[80:81], v71, s[84:87], s38 offen
    s_mov_b32 s38, 2629632
    buffer_load_dwordx2 a[82:83], v71, s[84:87], s38 offen
    s_mov_b32 s38, 2686976
    buffer_load_dwordx2 a[84:85], v71, s[84:87], s38 offen
    s_mov_b32 s38, 2695168
    buffer_load_dwordx2 a[86:87], v71, s[84:87], s38 offen
    s_mov_b32 s38, 2637824
    buffer_load_dwordx2 a[88:89], v71, s[84:87], s38 offen
    s_mov_b32 s38, 2646016
    buffer_load_dwordx2 a[90:91], v71, s[84:87], s38 offen
    s_mov_b32 s38, 2703360
    buffer_load_dwordx2 a[92:93], v71, s[84:87], s38 offen
    s_mov_b32 s38, 2711552
    buffer_load_dwordx2 a[94:95], v71, s[84:87], s38 offen
    s_barrier
    s_cmp_lg_u32 s8, 0
    s_cbranch_scc1 L_tb_84
    v_mov_b32 v58, 72
    v_mov_b32 v59, 1
    s_mov_b64 exec, 1
    global_atomic_add v58, v59, s[6:7]
    s_mov_b64 exec, -1
L_tb_84:
    s_and_b32 s39, s8, 1
    s_lshl_b32 s39, s39, 12
    v_subrev_u32 v72, s39, v72
    v_perm_b32 v10, v82, v80, s44
    v_perm_b32 v18, v82, v80, s45
    v_perm_b32 v26, v83, v81, s44
    v_perm_b32 v34, v83, v81, s45
    v_perm_b32 v11, v86, v84, s44
    v_perm_b32 v19, v86, v84, s45
    v_perm_b32 v27, v87, v85, s44
    v_perm_b32 v35, v87, v85, s45
    v_perm_b32 v12, v90, v88, s44
    v_perm_b32 v20, v90, v88, s45
    v_perm_b32 v28, v91, v89, s44
    v_perm_b32 v36, v91, v89, s45
    v_perm_b32 v13, v94, v92, s44
    v_perm_b32 v21, v94, v92, s45
    v_perm_b32 v29, v95, v93, s44
    v_perm_b32 v37, v95, v93, s45
    v_perm_b32 v14, v98, v96, s44
    v_perm_b32 v22, v98, v96, s45
    v_perm_b32 v30, v99, v97, s44
    v_perm_b32 v38, v99, v97, s45
    v_perm_b32 v15, v102, v100, s44
    v_perm_b32 v23, v102, v100, s45
    v_perm_b32 v31, v103, v101, s44
    v_perm_b32 v39, v103, v101, s45
    v_perm_b32 v16, v106, v104, s44
    v_perm_b32 v24, v106, v104, s45
    v_perm_b32 v32, v107, v105, s44
    v_perm_b32 v40, v107, v105, s45
    v_perm_b32 v17, v110, v108, s44
    v_perm_b32 v25, v110, v108, s45
    v_perm_b32 v33, v111, v109, s44
    v_perm_b32 v41, v111, v109, s45
    ds_write_b128 v72, v[10:13] offset:32768
    ds_write_b128 v72, v[14:17] offset:33792
    ds_write_b128 v72, v[18:21] offset:34816
    ds_write_b128 v72, v[22:25] offset:35840
    ds_write_b128 v72, v[26:29] offset:32784
    ds_write_b128 v72, v[30:33] offset:33808
    ds_write_b128 v72, v[34:37] offset:34832
    ds_write_b128 v72, v[38:41] offset:35856
    s_waitcnt lgkmcnt(0)
    s_waitcnt vmcnt(32)
    s_mov_b32 s38, 3538944
    buffer_load_dwordx2 a[96:97], v71, s[84:87], s38 offen
    s_mov_b32 s38, 3547136
    buffer_load_dwordx2 a[98:99], v71, s[84:87], s38 offen
    s_mov_b32 s38, 3604480
    buffer_load_dwordx2 a[100:101], v71, s[84:87], s38 offen
    s_mov_b32 s38, 3612672
    buffer_load_dwordx2 a[102:103], v71, s[84:87], s38 offen
    s_mov_b32 s38, 3555328
    buffer_load_dwordx2 a[104:105], v71, s[84:87], s38 offen
    s_mov_b32 s38, 3563520
    buffer_load_dwordx2 a[106:107], v71, s[84:87], s38 offen
    s_mov_b32 s38, 3620864
    buffer_load_dwordx2 a[108:109], v71, s[84:87], s38 offen
    s_mov_b32 s38, 3629056
    buffer_load_dwordx2 a[110:111], v71, s[84:87], s38 offen
    s_mov_b32 s38, 3801088
    buffer_load_dwordx2 a[112:113], v71, s[84:87], s38 offen
    s_mov_b32 s38, 3809280
    buffer_load_dwordx2 a[114:115], v71, s[84:87], s38 offen
    s_mov_b32 s38, 3866624
    buffer_load_dwordx2 a[116:117], v71, s[84:87], s38 offen
    s_mov_b32 s38, 3874816
    buffer_load_dwordx2 a[118:119], v71, s[84:87], s38 offen
    s_mov_b32 s38, 3817472
    buffer_load_dwordx2 a[120:121], v71, s[84:87], s38 offen
    s_mov_b32 s38, 3825664
    buffer_load_dwordx2 a[122:123], v71, s[84:87], s38 offen
    s_mov_b32 s38, 3883008
    buffer_load_dwordx2 a[124:125], v71, s[84:87], s38 offen
    s_mov_b32 s38, 3891200
    buffer_load_dwordx2 a[126:127], v71, s[84:87], s38 offen
    v_accvgpr_read_b32 v10, a0
    v_accvgpr_read_b32 v11, a1
    v_accvgpr_read_b32 v12, a2
    v_accvgpr_read_b32 v13, a3
    v_accvgpr_read_b32 v14, a4
    v_accvgpr_read_b32 v15, a5
    v_accvgpr_read_b32 v16, a6
    v_accvgpr_read_b32 v17, a7
    v_accvgpr_read_b32 v18, a8
    v_accvgpr_read_b32 v19, a9
    v_accvgpr_read_b32 v20, a10
    v_accvgpr_read_b32 v21, a11
    v_accvgpr_read_b32 v22, a12
    v_accvgpr_read_b32 v23, a13
    v_accvgpr_read_b32 v24, a14
    v_accvgpr_read_b32 v25, a15
    v_accvgpr_read_b32 v26, a16
    v_accvgpr_read_b32 v27, a17
    v_accvgpr_read_b32 v28, a18
    v_accvgpr_read_b32 v29, a19
    v_accvgpr_read_b32 v30, a20
    v_accvgpr_read_b32 v31, a21
    v_accvgpr_read_b32 v32, a22
    v_accvgpr_read_b32 v33, a23
    v_accvgpr_read_b32 v34, a24
    v_accvgpr_read_b32 v35, a25
    v_accvgpr_read_b32 v36, a26
    v_accvgpr_read_b32 v37, a27
    v_accvgpr_read_b32 v38, a28
    v_accvgpr_read_b32 v39, a29
    v_accvgpr_read_b32 v40, a30
    v_accvgpr_read_b32 v41, a31
    v_perm_b32 v42, v12, v10, s44
    v_accvgpr_write_b32 a0, v42
    v_perm_b32 v43, v12, v10, s45
    v_accvgpr_write_b32 a8, v43
    v_perm_b32 v44, v13, v11, s44
    v_accvgpr_write_b32 a16, v44
    v_perm_b32 v45, v13, v11, s45
    v_accvgpr_write_b32 a24, v45
    v_perm_b32 v42, v16, v14, s44
    v_accvgpr_write_b32 a1, v42
    v_perm_b32 v43, v16, v14, s45
    v_accvgpr_write_b32 a9, v43
    v_perm_b32 v44, v17, v15, s44
    v_accvgpr_write_b32 a17, v44
    v_perm_b32 v45, v17, v15, s45
    v_accvgpr_write_b32 a25, v45
    v_perm_b32 v42, v20, v18, s44
    v_accvgpr_write_b32 a2, v42
    v_perm_b32 v43, v20, v18, s45
    v_accvgpr_write_b32 a10, v43
    v_perm_b32 v44, v21, v19, s44
    v_accvgpr_write_b32 a18, v44
    v_perm_b32 v45, v21, v19, s45
    v_accvgpr_write_b32 a26, v45
    v_perm_b32 v42, v24, v22, s44
    v_accvgpr_write_b32 a3, v42
    v_perm_b32 v43, v24, v22, s45
    v_accvgpr_write_b32 a11, v43
    v_perm_b32 v44, v25, v23, s44
    v_accvgpr_write_b32 a19, v44
    v_perm_b32 v45, v25, v23, s45
    v_accvgpr_write_b32 a27, v45
    v_perm_b32 v42, v28, v26, s44
    v_accvgpr_write_b32 a4, v42
    v_perm_b32 v43, v28, v26, s45
    v_accvgpr_write_b32 a12, v43
    v_perm_b32 v44, v29, v27, s44
    v_accvgpr_write_b32 a20, v44
    v_perm_b32 v45, v29, v27, s45
    v_accvgpr_write_b32 a28, v45
    v_perm_b32 v42, v32, v30, s44
    v_accvgpr_write_b32 a5, v42
    v_perm_b32 v43, v32, v30, s45
    v_accvgpr_write_b32 a13, v43
    v_perm_b32 v44, v33, v31, s44
    v_accvgpr_write_b32 a21, v44
    v_perm_b32 v45, v33, v31, s45
    v_accvgpr_write_b32 a29, v45
    v_perm_b32 v42, v36, v34, s44
    v_accvgpr_write_b32 a6, v42
    v_perm_b32 v43, v36, v34, s45
    v_accvgpr_write_b32 a14, v43
    v_perm_b32 v44, v37, v35, s44
    v_accvgpr_write_b32 a22, v44
    v_perm_b32 v45, v37, v35, s45
    v_accvgpr_write_b32 a30, v45
    v_perm_b32 v42, v40, v38, s44
    v_accvgpr_write_b32 a7, v42
    v_perm_b32 v43, v40, v38, s45
    v_accvgpr_write_b32 a15, v43
    v_perm_b32 v44, v41, v39, s44
    v_accvgpr_write_b32 a23, v44
    v_perm_b32 v45, v41, v39, s45
    v_accvgpr_write_b32 a31, v45
    s_waitcnt vmcnt(32)
    s_mov_b32 s38, 524288
    buffer_load_dwordx2 a[128:129], v71, s[84:87], s38 offen
    s_mov_b32 s38, 532480
    buffer_load_dwordx2 a[130:131], v71, s[84:87], s38 offen
    s_mov_b32 s38, 589824
    buffer_load_dwordx2 a[132:133], v71, s[84:87], s38 offen
    s_mov_b32 s38, 598016
    buffer_load_dwordx2 a[134:135], v71, s[84:87], s38 offen
    s_mov_b32 s38, 540672
    buffer_load_dwordx2 a[136:137], v71, s[84:87], s38 offen
    s_mov_b32 s38, 548864
    buffer_load_dwordx2 a[138:139], v71, s[84:87], s38 offen
    s_mov_b32 s38, 606208
    buffer_load_dwordx2 a[140:141], v71, s[84:87], s38 offen
    s_mov_b32 s38, 614400
    buffer_load_dwordx2 a[142:143], v71, s[84:87], s38 offen
    s_mov_b32 s38, 786432
    buffer_load_dwordx2 a[144:145], v71, s[84:87], s38 offen
    s_mov_b32 s38, 794624
    buffer_load_dwordx2 a[146:147], v71, s[84:87], s38 offen
    s_mov_b32 s38, 851968
    buffer_load_dwordx2 a[148:149], v71, s[84:87], s38 offen
    s_mov_b32 s38, 860160
    buffer_load_dwordx2 a[150:151], v71, s[84:87], s38 offen
    s_mov_b32 s38, 802816
    buffer_load_dwordx2 a[152:153], v71, s[84:87], s38 offen
    s_mov_b32 s38, 811008
    buffer_load_dwordx2 a[154:155], v71, s[84:87], s38 offen
    s_mov_b32 s38, 868352
    buffer_load_dwordx2 a[156:157], v71, s[84:87], s38 offen
    s_mov_b32 s38, 876544
    buffer_load_dwordx2 a[158:159], v71, s[84:87], s38 offen
    v_accvgpr_read_b32 v10, a32
    v_accvgpr_read_b32 v11, a33
    v_accvgpr_read_b32 v12, a34
    v_accvgpr_read_b32 v13, a35
    v_accvgpr_read_b32 v14, a36
    v_accvgpr_read_b32 v15, a37
    v_accvgpr_read_b32 v16, a38
    v_accvgpr_read_b32 v17, a39
    v_accvgpr_read_b32 v18, a40
    v_accvgpr_read_b32 v19, a41
    v_accvgpr_read_b32 v20, a42
    v_accvgpr_read_b32 v21, a43
    v_accvgpr_read_b32 v22, a44
    v_accvgpr_read_b32 v23, a45
    v_accvgpr_read_b32 v24, a46
    v_accvgpr_read_b32 v25, a47
    v_accvgpr_read_b32 v26, a48
    v_accvgpr_read_b32 v27, a49
    v_accvgpr_read_b32 v28, a50
    v_accvgpr_read_b32 v29, a51
    v_accvgpr_read_b32 v30, a52
    v_accvgpr_read_b32 v31, a53
    v_accvgpr_read_b32 v32, a54
    v_accvgpr_read_b32 v33, a55
    v_accvgpr_read_b32 v34, a56
    v_accvgpr_read_b32 v35, a57
    v_accvgpr_read_b32 v36, a58
    v_accvgpr_read_b32 v37, a59
    v_accvgpr_read_b32 v38, a60
    v_accvgpr_read_b32 v39, a61
    v_accvgpr_read_b32 v40, a62
    v_accvgpr_read_b32 v41, a63
    v_perm_b32 v42, v12, v10, s44
    v_accvgpr_write_b32 a32, v42
    v_perm_b32 v43, v12, v10, s45
    v_accvgpr_write_b32 a40, v43
    v_perm_b32 v44, v13, v11, s44
    v_accvgpr_write_b32 a48, v44
    v_perm_b32 v45, v13, v11, s45
    v_accvgpr_write_b32 a56, v45
    v_perm_b32 v42, v16, v14, s44
    v_accvgpr_write_b32 a33, v42
    v_perm_b32 v43, v16, v14, s45
    v_accvgpr_write_b32 a41, v43
    v_perm_b32 v44, v17, v15, s44
    v_accvgpr_write_b32 a49, v44
    v_perm_b32 v45, v17, v15, s45
    v_accvgpr_write_b32 a57, v45
    v_perm_b32 v42, v20, v18, s44
    v_accvgpr_write_b32 a34, v42
    v_perm_b32 v43, v20, v18, s45
    v_accvgpr_write_b32 a42, v43
    v_perm_b32 v44, v21, v19, s44
    v_accvgpr_write_b32 a50, v44
    v_perm_b32 v45, v21, v19, s45
    v_accvgpr_write_b32 a58, v45
    v_perm_b32 v42, v24, v22, s44
    v_accvgpr_write_b32 a35, v42
    v_perm_b32 v43, v24, v22, s45
    v_accvgpr_write_b32 a43, v43
    v_perm_b32 v44, v25, v23, s44
    v_accvgpr_write_b32 a51, v44
    v_perm_b32 v45, v25, v23, s45
    v_accvgpr_write_b32 a59, v45
    v_perm_b32 v42, v28, v26, s44
    v_accvgpr_write_b32 a36, v42
    v_perm_b32 v43, v28, v26, s45
    v_accvgpr_write_b32 a44, v43
    v_perm_b32 v44, v29, v27, s44
    v_accvgpr_write_b32 a52, v44
    v_perm_b32 v45, v29, v27, s45
    v_accvgpr_write_b32 a60, v45
    v_perm_b32 v42, v32, v30, s44
    v_accvgpr_write_b32 a37, v42
    v_perm_b32 v43, v32, v30, s45
    v_accvgpr_write_b32 a45, v43
    v_perm_b32 v44, v33, v31, s44
    v_accvgpr_write_b32 a53, v44
    v_perm_b32 v45, v33, v31, s45
    v_accvgpr_write_b32 a61, v45
    v_perm_b32 v42, v36, v34, s44
    v_accvgpr_write_b32 a38, v42
    v_perm_b32 v43, v36, v34, s45
    v_accvgpr_write_b32 a46, v43
    v_perm_b32 v44, v37, v35, s44
    v_accvgpr_write_b32 a54, v44
    v_perm_b32 v45, v37, v35, s45
    v_accvgpr_write_b32 a62, v45
    v_perm_b32 v42, v40, v38, s44
    v_accvgpr_write_b32 a39, v42
    v_perm_b32 v43, v40, v38, s45
    v_accvgpr_write_b32 a47, v43
    v_perm_b32 v44, v41, v39, s44
    v_accvgpr_write_b32 a55, v44
    v_perm_b32 v45, v41, v39, s45
    v_accvgpr_write_b32 a63, v45
    s_waitcnt vmcnt(32)
    s_mov_b32 s38, 1703936
    buffer_load_dwordx2 a[160:161], v71, s[84:87], s38 offen
    s_mov_b32 s38, 1712128
    buffer_load_dwordx2 a[162:163], v71, s[84:87], s38 offen
    s_mov_b32 s38, 1769472
    buffer_load_dwordx2 a[164:165], v71, s[84:87], s38 offen
    s_mov_b32 s38, 1777664
    buffer_load_dwordx2 a[166:167], v71, s[84:87], s38 offen
    s_mov_b32 s38, 1720320
    buffer_load_dwordx2 a[168:169], v71, s[84:87], s38 offen
    s_mov_b32 s38, 1728512
    buffer_load_dwordx2 a[170:171], v71, s[84:87], s38 offen
    s_mov_b32 s38, 1785856
    buffer_load_dwordx2 a[172:173], v71, s[84:87], s38 offen
    s_mov_b32 s38, 1794048
    buffer_load_dwordx2 a[174:175], v71, s[84:87], s38 offen
    s_mov_b32 s38, 1966080
    buffer_load_dwordx2 a[176:177], v71, s[84:87], s38 offen
    s_mov_b32 s38, 1974272
    buffer_load_dwordx2 a[178:179], v71, s[84:87], s38 offen
    s_mov_b32 s38, 2031616
    buffer_load_dwordx2 a[180:181], v71, s[84:87], s38 offen
    s_mov_b32 s38, 2039808
    buffer_load_dwordx2 a[182:183], v71, s[84:87], s38 offen
    s_mov_b32 s38, 1982464
    buffer_load_dwordx2 a[184:185], v71, s[84:87], s38 offen
    s_mov_b32 s38, 1990656
    buffer_load_dwordx2 a[186:187], v71, s[84:87], s38 offen
    s_mov_b32 s38, 2048000
    buffer_load_dwordx2 a[188:189], v71, s[84:87], s38 offen
    s_mov_b32 s38, 2056192
    buffer_load_dwordx2 a[190:191], v71, s[84:87], s38 offen
    v_accvgpr_read_b32 v10, a64
    v_accvgpr_read_b32 v11, a65
    v_accvgpr_read_b32 v12, a66
    v_accvgpr_read_b32 v13, a67
    v_accvgpr_read_b32 v14, a68
    v_accvgpr_read_b32 v15, a69
    v_accvgpr_read_b32 v16, a70
    v_accvgpr_read_b32 v17, a71
    v_accvgpr_read_b32 v18, a72
    v_accvgpr_read_b32 v19, a73
    v_accvgpr_read_b32 v20, a74
    v_accvgpr_read_b32 v21, a75
    v_accvgpr_read_b32 v22, a76
    v_accvgpr_read_b32 v23, a77
    v_accvgpr_read_b32 v24, a78
    v_accvgpr_read_b32 v25, a79
    v_accvgpr_read_b32 v26, a80
    v_accvgpr_read_b32 v27, a81
    v_accvgpr_read_b32 v28, a82
    v_accvgpr_read_b32 v29, a83
    v_accvgpr_read_b32 v30, a84
    v_accvgpr_read_b32 v31, a85
    v_accvgpr_read_b32 v32, a86
    v_accvgpr_read_b32 v33, a87
    v_accvgpr_read_b32 v34, a88
    v_accvgpr_read_b32 v35, a89
    v_accvgpr_read_b32 v36, a90
    v_accvgpr_read_b32 v37, a91
    v_accvgpr_read_b32 v38, a92
    v_accvgpr_read_b32 v39, a93
    v_accvgpr_read_b32 v40, a94
    v_accvgpr_read_b32 v41, a95
    v_perm_b32 v42, v12, v10, s44
    v_accvgpr_write_b32 a64, v42
    v_perm_b32 v43, v12, v10, s45
    v_accvgpr_write_b32 a72, v43
    v_perm_b32 v44, v13, v11, s44
    v_accvgpr_write_b32 a80, v44
    v_perm_b32 v45, v13, v11, s45
    v_accvgpr_write_b32 a88, v45
    v_perm_b32 v42, v16, v14, s44
    v_accvgpr_write_b32 a65, v42
    v_perm_b32 v43, v16, v14, s45
    v_accvgpr_write_b32 a73, v43
    v_perm_b32 v44, v17, v15, s44
    v_accvgpr_write_b32 a81, v44
    v_perm_b32 v45, v17, v15, s45
    v_accvgpr_write_b32 a89, v45
    v_perm_b32 v42, v20, v18, s44
    v_accvgpr_write_b32 a66, v42
    v_perm_b32 v43, v20, v18, s45
    v_accvgpr_write_b32 a74, v43
    v_perm_b32 v44, v21, v19, s44
    v_accvgpr_write_b32 a82, v44
    v_perm_b32 v45, v21, v19, s45
    v_accvgpr_write_b32 a90, v45
    v_perm_b32 v42, v24, v22, s44
    v_accvgpr_write_b32 a67, v42
    v_perm_b32 v43, v24, v22, s45
    v_accvgpr_write_b32 a75, v43
    v_perm_b32 v44, v25, v23, s44
    v_accvgpr_write_b32 a83, v44
    v_perm_b32 v45, v25, v23, s45
    v_accvgpr_write_b32 a91, v45
    v_perm_b32 v42, v28, v26, s44
    v_accvgpr_write_b32 a68, v42
    v_perm_b32 v43, v28, v26, s45
    v_accvgpr_write_b32 a76, v43
    v_perm_b32 v44, v29, v27, s44
    v_accvgpr_write_b32 a84, v44
    v_perm_b32 v45, v29, v27, s45
    v_accvgpr_write_b32 a92, v45
    v_perm_b32 v42, v32, v30, s44
    v_accvgpr_write_b32 a69, v42
    v_perm_b32 v43, v32, v30, s45
    v_accvgpr_write_b32 a77, v43
    v_perm_b32 v44, v33, v31, s44
    v_accvgpr_write_b32 a85, v44
    v_perm_b32 v45, v33, v31, s45
    v_accvgpr_write_b32 a93, v45
    v_perm_b32 v42, v36, v34, s44
    v_accvgpr_write_b32 a70, v42
    v_perm_b32 v43, v36, v34, s45
    v_accvgpr_write_b32 a78, v43
    v_perm_b32 v44, v37, v35, s44
    v_accvgpr_write_b32 a86, v44
    v_perm_b32 v45, v37, v35, s45
    v_accvgpr_write_b32 a94, v45
    v_perm_b32 v42, v40, v38, s44
    v_accvgpr_write_b32 a71, v42
    v_perm_b32 v43, v40, v38, s45
    v_accvgpr_write_b32 a79, v43
    v_perm_b32 v44, v41, v39, s44
    v_accvgpr_write_b32 a87, v44
    v_perm_b32 v45, v41, v39, s45
    v_accvgpr_write_b32 a95, v45
    s_waitcnt vmcnt(32)
    s_mov_b32 s38, 2883584
    buffer_load_dwordx2 a[192:193], v71, s[84:87], s38 offen
    s_mov_b32 s38, 2891776
    buffer_load_dwordx2 a[194:195], v71, s[84:87], s38 offen
    s_mov_b32 s38, 2949120
    buffer_load_dwordx2 a[196:197], v71, s[84:87], s38 offen
    s_mov_b32 s38, 2957312
    buffer_load_dwordx2 a[198:199], v71, s[84:87], s38 offen
    s_mov_b32 s38, 2899968
    buffer_load_dwordx2 a[200:201], v71, s[84:87], s38 offen
    s_mov_b32 s38, 2908160
    buffer_load_dwordx2 a[202:203], v71, s[84:87], s38 offen
    s_mov_b32 s38, 2965504
    buffer_load_dwordx2 a[204:205], v71, s[84:87], s38 offen
    s_mov_b32 s38, 2973696
    buffer_load_dwordx2 a[206:207], v71, s[84:87], s38 offen
    s_mov_b32 s38, 3145728
    buffer_load_dwordx2 a[208:209], v71, s[84:87], s38 offen
    s_mov_b32 s38, 3153920
    buffer_load_dwordx2 a[210:211], v71, s[84:87], s38 offen
    s_mov_b32 s38, 3211264
    buffer_load_dwordx2 a[212:213], v71, s[84:87], s38 offen
    s_mov_b32 s38, 3219456
    buffer_load_dwordx2 a[214:215], v71, s[84:87], s38 offen
    s_mov_b32 s38, 3162112
    buffer_load_dwordx2 a[216:217], v71, s[84:87], s38 offen
    s_mov_b32 s38, 3170304
    buffer_load_dwordx2 a[218:219], v71, s[84:87], s38 offen
    s_mov_b32 s38, 3227648
    buffer_load_dwordx2 a[220:221], v71, s[84:87], s38 offen
    s_mov_b32 s38, 3235840
    buffer_load_dwordx2 a[222:223], v71, s[84:87], s38 offen
    v_accvgpr_read_b32 v10, a96
    v_accvgpr_read_b32 v11, a97
    v_accvgpr_read_b32 v12, a98
    v_accvgpr_read_b32 v13, a99
    v_accvgpr_read_b32 v14, a100
    v_accvgpr_read_b32 v15, a101
    v_accvgpr_read_b32 v16, a102
    v_accvgpr_read_b32 v17, a103
    v_accvgpr_read_b32 v18, a104
    v_accvgpr_read_b32 v19, a105
    v_accvgpr_read_b32 v20, a106
    v_accvgpr_read_b32 v21, a107
    v_accvgpr_read_b32 v22, a108
    v_accvgpr_read_b32 v23, a109
    v_accvgpr_read_b32 v24, a110
    v_accvgpr_read_b32 v25, a111
    v_accvgpr_read_b32 v26, a112
    v_accvgpr_read_b32 v27, a113
    v_accvgpr_read_b32 v28, a114
    v_accvgpr_read_b32 v29, a115
    v_accvgpr_read_b32 v30, a116
    v_accvgpr_read_b32 v31, a117
    v_accvgpr_read_b32 v32, a118
    v_accvgpr_read_b32 v33, a119
    v_accvgpr_read_b32 v34, a120
    v_accvgpr_read_b32 v35, a121
    v_accvgpr_read_b32 v36, a122
    v_accvgpr_read_b32 v37, a123
    v_accvgpr_read_b32 v38, a124
    v_accvgpr_read_b32 v39, a125
    v_accvgpr_read_b32 v40, a126
    v_accvgpr_read_b32 v41, a127
    v_perm_b32 v42, v12, v10, s44
    v_accvgpr_write_b32 a96, v42
    v_perm_b32 v43, v12, v10, s45
    v_accvgpr_write_b32 a104, v43
    v_perm_b32 v44, v13, v11, s44
    v_accvgpr_write_b32 a112, v44
    v_perm_b32 v45, v13, v11, s45
    v_accvgpr_write_b32 a120, v45
    v_perm_b32 v42, v16, v14, s44
    v_accvgpr_write_b32 a97, v42
    v_perm_b32 v43, v16, v14, s45
    v_accvgpr_write_b32 a105, v43
    v_perm_b32 v44, v17, v15, s44
    v_accvgpr_write_b32 a113, v44
    v_perm_b32 v45, v17, v15, s45
    v_accvgpr_write_b32 a121, v45
    v_perm_b32 v42, v20, v18, s44
    v_accvgpr_write_b32 a98, v42
    v_perm_b32 v43, v20, v18, s45
    v_accvgpr_write_b32 a106, v43
    v_perm_b32 v44, v21, v19, s44
    v_accvgpr_write_b32 a114, v44
    v_perm_b32 v45, v21, v19, s45
    v_accvgpr_write_b32 a122, v45
    v_perm_b32 v42, v24, v22, s44
    v_accvgpr_write_b32 a99, v42
    v_perm_b32 v43, v24, v22, s45
    v_accvgpr_write_b32 a107, v43
    v_perm_b32 v44, v25, v23, s44
    v_accvgpr_write_b32 a115, v44
    v_perm_b32 v45, v25, v23, s45
    v_accvgpr_write_b32 a123, v45
    v_perm_b32 v42, v28, v26, s44
    v_accvgpr_write_b32 a100, v42
    v_perm_b32 v43, v28, v26, s45
    v_accvgpr_write_b32 a108, v43
    v_perm_b32 v44, v29, v27, s44
    v_accvgpr_write_b32 a116, v44
    v_perm_b32 v45, v29, v27, s45
    v_accvgpr_write_b32 a124, v45
    v_perm_b32 v42, v32, v30, s44
    v_accvgpr_write_b32 a101, v42
    v_perm_b32 v43, v32, v30, s45
    v_accvgpr_write_b32 a109, v43
    v_perm_b32 v44, v33, v31, s44
    v_accvgpr_write_b32 a117, v44
    v_perm_b32 v45, v33, v31, s45
    v_accvgpr_write_b32 a125, v45
    v_perm_b32 v42, v36, v34, s44
    v_accvgpr_write_b32 a102, v42
    v_perm_b32 v43, v36, v34, s45
    v_accvgpr_write_b32 a110, v43
    v_perm_b32 v44, v37, v35, s44
    v_accvgpr_write_b32 a118, v44
    v_perm_b32 v45, v37, v35, s45
    v_accvgpr_write_b32 a126, v45
    v_perm_b32 v42, v40, v38, s44
    v_accvgpr_write_b32 a103, v42
    v_perm_b32 v43, v40, v38, s45
    v_accvgpr_write_b32 a111, v43
    v_perm_b32 v44, v41, v39, s44
    v_accvgpr_write_b32 a119, v44
    v_perm_b32 v45, v41, v39, s45
    v_accvgpr_write_b32 a127, v45
    s_waitcnt vmcnt(32)
    s_mov_b32 s38, 4063232
    buffer_load_dwordx2 a[224:225], v71, s[84:87], s38 offen
    s_mov_b32 s38, 4071424
    buffer_load_dwordx2 a[226:227], v71, s[84:87], s38 offen
    s_mov_b32 s38, 4128768
    buffer_load_dwordx2 a[228:229], v71, s[84:87], s38 offen
    s_mov_b32 s38, 4136960
    buffer_load_dwordx2 a[230:231], v71, s[84:87], s38 offen
    s_mov_b32 s38, 4079616
    buffer_load_dwordx2 a[232:233], v71, s[84:87], s38 offen
    s_mov_b32 s38, 4087808
    buffer_load_dwordx2 a[234:235], v71, s[84:87], s38 offen
    s_mov_b32 s38, 4145152
    buffer_load_dwordx2 a[236:237], v71, s[84:87], s38 offen
    s_mov_b32 s38, 4153344
    buffer_load_dwordx2 a[238:239], v71, s[84:87], s38 offen
    s_mov_b32 s38, 4325376
    buffer_load_dwordx2 a[240:241], v71, s[84:87], s38 offen
    s_mov_b32 s38, 4333568
    buffer_load_dwordx2 a[242:243], v71, s[84:87], s38 offen
    s_mov_b32 s38, 4390912
    buffer_load_dwordx2 a[244:245], v71, s[84:87], s38 offen
    s_mov_b32 s38, 4399104
    buffer_load_dwordx2 a[246:247], v71, s[84:87], s38 offen
    s_mov_b32 s38, 4341760
    buffer_load_dwordx2 a[248:249], v71, s[84:87], s38 offen
    s_mov_b32 s38, 4349952
    buffer_load_dwordx2 a[250:251], v71, s[84:87], s38 offen
    s_mov_b32 s38, 4407296
    buffer_load_dwordx2 a[252:253], v71, s[84:87], s38 offen
    s_mov_b32 s38, 4415488
    buffer_load_dwordx2 a[254:255], v71, s[84:87], s38 offen
    v_accvgpr_read_b32 v10, a128
    v_accvgpr_read_b32 v11, a129
    v_accvgpr_read_b32 v12, a130
    v_accvgpr_read_b32 v13, a131
    v_accvgpr_read_b32 v14, a132
    v_accvgpr_read_b32 v15, a133
    v_accvgpr_read_b32 v16, a134
    v_accvgpr_read_b32 v17, a135
    v_accvgpr_read_b32 v18, a136
    v_accvgpr_read_b32 v19, a137
    v_accvgpr_read_b32 v20, a138
    v_accvgpr_read_b32 v21, a139
    v_accvgpr_read_b32 v22, a140
    v_accvgpr_read_b32 v23, a141
    v_accvgpr_read_b32 v24, a142
    v_accvgpr_read_b32 v25, a143
    v_accvgpr_read_b32 v26, a144
    v_accvgpr_read_b32 v27, a145
    v_accvgpr_read_b32 v28, a146
    v_accvgpr_read_b32 v29, a147
    v_accvgpr_read_b32 v30, a148
    v_accvgpr_read_b32 v31, a149
    v_accvgpr_read_b32 v32, a150
    v_accvgpr_read_b32 v33, a151
    v_accvgpr_read_b32 v34, a152
    v_accvgpr_read_b32 v35, a153
    v_accvgpr_read_b32 v36, a154
    v_accvgpr_read_b32 v37, a155
    v_accvgpr_read_b32 v38, a156
    v_accvgpr_read_b32 v39, a157
    v_accvgpr_read_b32 v40, a158
    v_accvgpr_read_b32 v41, a159
    v_perm_b32 v42, v12, v10, s44
    v_accvgpr_write_b32 a128, v42
    v_perm_b32 v43, v12, v10, s45
    v_accvgpr_write_b32 a136, v43
    v_perm_b32 v44, v13, v11, s44
    v_accvgpr_write_b32 a144, v44
    v_perm_b32 v45, v13, v11, s45
    v_accvgpr_write_b32 a152, v45
    v_perm_b32 v42, v16, v14, s44
    v_accvgpr_write_b32 a129, v42
    v_perm_b32 v43, v16, v14, s45
    v_accvgpr_write_b32 a137, v43
    v_perm_b32 v44, v17, v15, s44
    v_accvgpr_write_b32 a145, v44
    v_perm_b32 v45, v17, v15, s45
    v_accvgpr_write_b32 a153, v45
    v_perm_b32 v42, v20, v18, s44
    v_accvgpr_write_b32 a130, v42
    v_perm_b32 v43, v20, v18, s45
    v_accvgpr_write_b32 a138, v43
    v_perm_b32 v44, v21, v19, s44
    v_accvgpr_write_b32 a146, v44
    v_perm_b32 v45, v21, v19, s45
    v_accvgpr_write_b32 a154, v45
    v_perm_b32 v42, v24, v22, s44
    v_accvgpr_write_b32 a131, v42
    v_perm_b32 v43, v24, v22, s45
    v_accvgpr_write_b32 a139, v43
    v_perm_b32 v44, v25, v23, s44
    v_accvgpr_write_b32 a147, v44
    v_perm_b32 v45, v25, v23, s45
    v_accvgpr_write_b32 a155, v45
    v_perm_b32 v42, v28, v26, s44
    v_accvgpr_write_b32 a132, v42
    v_perm_b32 v43, v28, v26, s45
    v_accvgpr_write_b32 a140, v43
    v_perm_b32 v44, v29, v27, s44
    v_accvgpr_write_b32 a148, v44
    v_perm_b32 v45, v29, v27, s45
    v_accvgpr_write_b32 a156, v45
    v_perm_b32 v42, v32, v30, s44
    v_accvgpr_write_b32 a133, v42
    v_perm_b32 v43, v32, v30, s45
    v_accvgpr_write_b32 a141, v43
    v_perm_b32 v44, v33, v31, s44
    v_accvgpr_write_b32 a149, v44
    v_perm_b32 v45, v33, v31, s45
    v_accvgpr_write_b32 a157, v45
    v_perm_b32 v42, v36, v34, s44
    v_accvgpr_write_b32 a134, v42
    v_perm_b32 v43, v36, v34, s45
    v_accvgpr_write_b32 a142, v43
    v_perm_b32 v44, v37, v35, s44
    v_accvgpr_write_b32 a150, v44
    v_perm_b32 v45, v37, v35, s45
    v_accvgpr_write_b32 a158, v45
    v_perm_b32 v42, v40, v38, s44
    v_accvgpr_write_b32 a135, v42
    v_perm_b32 v43, v40, v38, s45
    v_accvgpr_write_b32 a143, v43
    v_perm_b32 v44, v41, v39, s44
    v_accvgpr_write_b32 a151, v44
    v_perm_b32 v45, v41, v39, s45
    v_accvgpr_write_b32 a159, v45
    s_waitcnt vmcnt(32)
    v_add_u32 v64, v71, v66
    s_mov_b32 s38, 1048576
    buffer_load_dwordx2 v[224:225], v64, s[84:87], s38 offen
    s_mov_b32 s38, 1056768
    buffer_load_dwordx2 v[226:227], v64, s[84:87], s38 offen
    s_mov_b32 s38, 1114112
    buffer_load_dwordx2 v[228:229], v64, s[84:87], s38 offen
    s_mov_b32 s38, 1122304
    buffer_load_dwordx2 v[230:231], v64, s[84:87], s38 offen
    s_mov_b32 s38, 1064960
    buffer_load_dwordx2 v[232:233], v64, s[84:87], s38 offen
    s_mov_b32 s38, 1073152
    buffer_load_dwordx2 v[234:235], v64, s[84:87], s38 offen
    s_mov_b32 s38, 1130496
    buffer_load_dwordx2 v[236:237], v64, s[84:87], s38 offen
    s_mov_b32 s38, 1138688
    buffer_load_dwordx2 v[238:239], v64, s[84:87], s38 offen
    s_mov_b32 s38, 3407872
    buffer_load_dwordx2 v[240:241], v64, s[84:87], s38 offen
    s_mov_b32 s38, 3416064
    buffer_load_dwordx2 v[242:243], v64, s[84:87], s38 offen
    s_mov_b32 s38, 3473408
    buffer_load_dwordx2 v[244:245], v64, s[84:87], s38 offen
    s_mov_b32 s38, 3481600
    buffer_load_dwordx2 v[246:247], v64, s[84:87], s38 offen
    s_mov_b32 s38, 3424256
    buffer_load_dwordx2 v[248:249], v64, s[84:87], s38 offen
    s_mov_b32 s38, 3432448
    buffer_load_dwordx2 v[250:251], v64, s[84:87], s38 offen
    s_mov_b32 s38, 3489792
    buffer_load_dwordx2 v[252:253], v64, s[84:87], s38 offen
    s_mov_b32 s38, 3497984
    buffer_load_dwordx2 v[254:255], v64, s[84:87], s38 offen
    v_accvgpr_read_b32 v10, a160
    v_accvgpr_read_b32 v11, a161
    v_accvgpr_read_b32 v12, a162
    v_accvgpr_read_b32 v13, a163
    v_accvgpr_read_b32 v14, a164
    v_accvgpr_read_b32 v15, a165
    v_accvgpr_read_b32 v16, a166
    v_accvgpr_read_b32 v17, a167
    v_accvgpr_read_b32 v18, a168
    v_accvgpr_read_b32 v19, a169
    v_accvgpr_read_b32 v20, a170
    v_accvgpr_read_b32 v21, a171
    v_accvgpr_read_b32 v22, a172
    v_accvgpr_read_b32 v23, a173
    v_accvgpr_read_b32 v24, a174
    v_accvgpr_read_b32 v25, a175
    v_accvgpr_read_b32 v26, a176
    v_accvgpr_read_b32 v27, a177
    v_accvgpr_read_b32 v28, a178
    v_accvgpr_read_b32 v29, a179
    v_accvgpr_read_b32 v30, a180
    v_accvgpr_read_b32 v31, a181
    v_accvgpr_read_b32 v32, a182
    v_accvgpr_read_b32 v33, a183
    v_accvgpr_read_b32 v34, a184
    v_accvgpr_read_b32 v35, a185
    v_accvgpr_read_b32 v36, a186
    v_accvgpr_read_b32 v37, a187
    v_accvgpr_read_b32 v38, a188
    v_accvgpr_read_b32 v39, a189
    v_accvgpr_read_b32 v40, a190
    v_accvgpr_read_b32 v41, a191
    v_perm_b32 v42, v12, v10, s44
    v_accvgpr_write_b32 a160, v42
    v_perm_b32 v43, v12, v10, s45
    v_accvgpr_write_b32 a168, v43
    v_perm_b32 v44, v13, v11, s44
    v_accvgpr_write_b32 a176, v44
    v_perm_b32 v45, v13, v11, s45
    v_accvgpr_write_b32 a184, v45
    v_perm_b32 v42, v16, v14, s44
    v_accvgpr_write_b32 a161, v42
    v_perm_b32 v43, v16, v14, s45
    v_accvgpr_write_b32 a169, v43
    v_perm_b32 v44, v17, v15, s44
    v_accvgpr_write_b32 a177, v44
    v_perm_b32 v45, v17, v15, s45
    v_accvgpr_write_b32 a185, v45
    v_perm_b32 v42, v20, v18, s44
    v_accvgpr_write_b32 a162, v42
    v_perm_b32 v43, v20, v18, s45
    v_accvgpr_write_b32 a170, v43
    v_perm_b32 v44, v21, v19, s44
    v_accvgpr_write_b32 a178, v44
    v_perm_b32 v45, v21, v19, s45
    v_accvgpr_write_b32 a186, v45
    v_perm_b32 v42, v24, v22, s44
    v_accvgpr_write_b32 a163, v42
    v_perm_b32 v43, v24, v22, s45
    v_accvgpr_write_b32 a171, v43
    v_perm_b32 v44, v25, v23, s44
    v_accvgpr_write_b32 a179, v44
    v_perm_b32 v45, v25, v23, s45
    v_accvgpr_write_b32 a187, v45
    v_perm_b32 v42, v28, v26, s44
    v_accvgpr_write_b32 a164, v42
    v_perm_b32 v43, v28, v26, s45
    v_accvgpr_write_b32 a172, v43
    v_perm_b32 v44, v29, v27, s44
    v_accvgpr_write_b32 a180, v44
    v_perm_b32 v45, v29, v27, s45
    v_accvgpr_write_b32 a188, v45
    v_perm_b32 v42, v32, v30, s44
    v_accvgpr_write_b32 a165, v42
    v_perm_b32 v43, v32, v30, s45
    v_accvgpr_write_b32 a173, v43
    v_perm_b32 v44, v33, v31, s44
    v_accvgpr_write_b32 a181, v44
    v_perm_b32 v45, v33, v31, s45
    v_accvgpr_write_b32 a189, v45
    v_perm_b32 v42, v36, v34, s44
    v_accvgpr_write_b32 a166, v42
    v_perm_b32 v43, v36, v34, s45
    v_accvgpr_write_b32 a174, v43
    v_perm_b32 v44, v37, v35, s44
    v_accvgpr_write_b32 a182, v44
    v_perm_b32 v45, v37, v35, s45
    v_accvgpr_write_b32 a190, v45
    v_perm_b32 v42, v40, v38, s44
    v_accvgpr_write_b32 a167, v42
    v_perm_b32 v43, v40, v38, s45
    v_accvgpr_write_b32 a175, v43
    v_perm_b32 v44, v41, v39, s44
    v_accvgpr_write_b32 a183, v44
    v_perm_b32 v45, v41, v39, s45
    v_accvgpr_write_b32 a191, v45
    s_waitcnt vmcnt(32)
    s_mov_b32 s38, 0
    buffer_load_dword v50, v69, s[88:91], s38 offen offset:256
    s_mov_b32 s38, 1152
    buffer_load_dword v51, v69, s[88:91], s38 offen offset:256
    s_mov_b32 s38, 36864
    buffer_load_dword v52, v69, s[88:91], s38 offen offset:256
    s_mov_b32 s38, 38016
    buffer_load_dword v53, v69, s[88:91], s38 offen offset:256
    s_mov_b32 s38, 2304
    buffer_load_dword v54, v69, s[88:91], s38 offen offset:256
    s_mov_b32 s38, 3456
    buffer_load_dword v55, v69, s[88:91], s38 offen offset:256
    s_mov_b32 s38, 39168
    buffer_load_dword v56, v69, s[88:91], s38 offen offset:256
    s_mov_b32 s38, 40320
    buffer_load_dword v57, v69, s[88:91], s38 offen offset:256
    s_mov_b32 s38, 18432
    buffer_load_dword v58, v69, s[88:91], s38 offen offset:256
    s_mov_b32 s38, 19584
    buffer_load_dword v59, v69, s[88:91], s38 offen offset:256
    s_mov_b32 s38, 55296
    buffer_load_dword v60, v69, s[88:91], s38 offen offset:256
    s_mov_b32 s38, 56448
    buffer_load_dword v61, v69, s[88:91], s38 offen offset:256
    s_mov_b32 s38, 20736
    buffer_load_dword v62, v69, s[88:91], s38 offen offset:256
    s_mov_b32 s38, 21888
    buffer_load_dword v63, v69, s[88:91], s38 offen offset:256
    s_mov_b32 s38, 57600
    buffer_load_dword v64, v69, s[88:91], s38 offen offset:256
    s_mov_b32 s38, 58752
    buffer_load_dword v65, v69, s[88:91], s38 offen offset:256
    v_accvgpr_read_b32 v10, a192
    v_accvgpr_read_b32 v11, a193
    v_accvgpr_read_b32 v12, a194
    v_accvgpr_read_b32 v13, a195
    v_accvgpr_read_b32 v14, a196
    v_accvgpr_read_b32 v15, a197
    v_accvgpr_read_b32 v16, a198
    v_accvgpr_read_b32 v17, a199
    v_accvgpr_read_b32 v18, a200
    v_accvgpr_read_b32 v19, a201
    v_accvgpr_read_b32 v20, a202
    v_accvgpr_read_b32 v21, a203
    v_accvgpr_read_b32 v22, a204
    v_accvgpr_read_b32 v23, a205
    v_accvgpr_read_b32 v24, a206
    v_accvgpr_read_b32 v25, a207
    v_accvgpr_read_b32 v26, a208
    v_accvgpr_read_b32 v27, a209
    v_accvgpr_read_b32 v28, a210
    v_accvgpr_read_b32 v29, a211
    v_accvgpr_read_b32 v30, a212
    v_accvgpr_read_b32 v31, a213
    v_accvgpr_read_b32 v32, a214
    v_accvgpr_read_b32 v33, a215
    v_accvgpr_read_b32 v34, a216
    v_accvgpr_read_b32 v35, a217
    v_accvgpr_read_b32 v36, a218
    v_accvgpr_read_b32 v37, a219
    v_accvgpr_read_b32 v38, a220
    v_accvgpr_read_b32 v39, a221
    v_accvgpr_read_b32 v40, a222
    v_accvgpr_read_b32 v41, a223
    v_perm_b32 v42, v12, v10, s44
    v_accvgpr_write_b32 a192, v42
    v_perm_b32 v43, v12, v10, s45
    v_accvgpr_write_b32 a200, v43
    v_perm_b32 v44, v13, v11, s44
    v_accvgpr_write_b32 a208, v44
    v_perm_b32 v45, v13, v11, s45
    v_accvgpr_write_b32 a216, v45
    v_perm_b32 v42, v16, v14, s44
    v_accvgpr_write_b32 a193, v42
    v_perm_b32 v43, v16, v14, s45
    v_accvgpr_write_b32 a201, v43
    v_perm_b32 v44, v17, v15, s44
    v_accvgpr_write_b32 a209, v44
    v_perm_b32 v45, v17, v15, s45
    v_accvgpr_write_b32 a217, v45
    v_perm_b32 v42, v20, v18, s44
    v_accvgpr_write_b32 a194, v42
    v_perm_b32 v43, v20, v18, s45
    v_accvgpr_write_b32 a202, v43
    v_perm_b32 v44, v21, v19, s44
    v_accvgpr_write_b32 a210, v44
    v_perm_b32 v45, v21, v19, s45
    v_accvgpr_write_b32 a218, v45
    v_perm_b32 v42, v24, v22, s44
    v_accvgpr_write_b32 a195, v42
    v_perm_b32 v43, v24, v22, s45
    v_accvgpr_write_b32 a203, v43
    v_perm_b32 v44, v25, v23, s44
    v_accvgpr_write_b32 a211, v44
    v_perm_b32 v45, v25, v23, s45
    v_accvgpr_write_b32 a219, v45
    v_perm_b32 v42, v28, v26, s44
    v_accvgpr_write_b32 a196, v42
    v_perm_b32 v43, v28, v26, s45
    v_accvgpr_write_b32 a204, v43
    v_perm_b32 v44, v29, v27, s44
    v_accvgpr_write_b32 a212, v44
    v_perm_b32 v45, v29, v27, s45
    v_accvgpr_write_b32 a220, v45
    v_perm_b32 v42, v32, v30, s44
    v_accvgpr_write_b32 a197, v42
    v_perm_b32 v43, v32, v30, s45
    v_accvgpr_write_b32 a205, v43
    v_perm_b32 v44, v33, v31, s44
    v_accvgpr_write_b32 a213, v44
    v_perm_b32 v45, v33, v31, s45
    v_accvgpr_write_b32 a221, v45
    v_perm_b32 v42, v36, v34, s44
    v_accvgpr_write_b32 a198, v42
    v_perm_b32 v43, v36, v34, s45
    v_accvgpr_write_b32 a206, v43
    v_perm_b32 v44, v37, v35, s44
    v_accvgpr_write_b32 a214, v44
    v_perm_b32 v45, v37, v35, s45
    v_accvgpr_write_b32 a222, v45
    v_perm_b32 v42, v40, v38, s44
    v_accvgpr_write_b32 a199, v42
    v_perm_b32 v43, v40, v38, s45
    v_accvgpr_write_b32 a207, v43
    v_perm_b32 v44, v41, v39, s44
    v_accvgpr_write_b32 a215, v44
    v_perm_b32 v45, v41, v39, s45
    v_accvgpr_write_b32 a223, v45
    s_waitcnt vmcnt(32)
    s_mov_b32 s38, 0
    buffer_load_dwordx2 v[80:81], v70, s[88:91], s38 offen offset:0
    s_mov_b32 s38, 1152
    buffer_load_dwordx2 v[82:83], v70, s[88:91], s38 offen offset:0
    s_mov_b32 s38, 36864
    buffer_load_dwordx2 v[84:85], v70, s[88:91], s38 offen offset:0
    s_mov_b32 s38, 38016
    buffer_load_dwordx2 v[86:87], v70, s[88:91], s38 offen offset:0
    s_mov_b32 s38, 2304
    buffer_load_dwordx2 v[88:89], v70, s[88:91], s38 offen offset:0
    s_mov_b32 s38, 3456
    buffer_load_dwordx2 v[90:91], v70, s[88:91], s38 offen offset:0
    s_mov_b32 s38, 39168
    buffer_load_dwordx2 v[92:93], v70, s[88:91], s38 offen offset:0
    s_mov_b32 s38, 40320
    buffer_load_dwordx2 v[94:95], v70, s[88:91], s38 offen offset:0
    s_mov_b32 s38, 18432
    buffer_load_dwordx2 v[96:97], v70, s[88:91], s38 offen offset:0
    s_mov_b32 s38, 19584
    buffer_load_dwordx2 v[98:99], v70, s[88:91], s38 offen offset:0
    s_mov_b32 s38, 55296
    buffer_load_dwordx2 v[100:101], v70, s[88:91], s38 offen offset:0
    s_mov_b32 s38, 56448
    buffer_load_dwordx2 v[102:103], v70, s[88:91], s38 offen offset:0
    s_mov_b32 s38, 20736
    buffer_load_dwordx2 v[104:105], v70, s[88:91], s38 offen offset:0
    s_mov_b32 s38, 21888
    buffer_load_dwordx2 v[106:107], v70, s[88:91], s38 offen offset:0
    s_mov_b32 s38, 57600
    buffer_load_dwordx2 v[108:109], v70, s[88:91], s38 offen offset:0
    s_mov_b32 s38, 58752
    buffer_load_dwordx2 v[110:111], v70, s[88:91], s38 offen offset:0
    v_accvgpr_read_b32 v10, a224
    v_accvgpr_read_b32 v11, a225
    v_accvgpr_read_b32 v12, a226
    v_accvgpr_read_b32 v13, a227
    v_accvgpr_read_b32 v14, a228
    v_accvgpr_read_b32 v15, a229
    v_accvgpr_read_b32 v16, a230
    v_accvgpr_read_b32 v17, a231
    v_accvgpr_read_b32 v18, a232
    v_accvgpr_read_b32 v19, a233
    v_accvgpr_read_b32 v20, a234
    v_accvgpr_read_b32 v21, a235
    v_accvgpr_read_b32 v22, a236
    v_accvgpr_read_b32 v23, a237
    v_accvgpr_read_b32 v24, a238
    v_accvgpr_read_b32 v25, a239
    v_accvgpr_read_b32 v26, a240
    v_accvgpr_read_b32 v27, a241
    v_accvgpr_read_b32 v28, a242
    v_accvgpr_read_b32 v29, a243
    v_accvgpr_read_b32 v30, a244
    v_accvgpr_read_b32 v31, a245
    v_accvgpr_read_b32 v32, a246
    v_accvgpr_read_b32 v33, a247
    v_accvgpr_read_b32 v34, a248
    v_accvgpr_read_b32 v35, a249
    v_accvgpr_read_b32 v36, a250
    v_accvgpr_read_b32 v37, a251
    v_accvgpr_read_b32 v38, a252
    v_accvgpr_read_b32 v39, a253
    v_accvgpr_read_b32 v40, a254
    v_accvgpr_read_b32 v41, a255
    v_perm_b32 v42, v12, v10, s44
    v_accvgpr_write_b32 a224, v42
    v_perm_b32 v43, v12, v10, s45
    v_accvgpr_write_b32 a232, v43
    v_perm_b32 v44, v13, v11, s44
    v_accvgpr_write_b32 a240, v44
    v_perm_b32 v45, v13, v11, s45
    v_accvgpr_write_b32 a248, v45
    v_perm_b32 v42, v16, v14, s44
    v_accvgpr_write_b32 a225, v42
    v_perm_b32 v43, v16, v14, s45
    v_accvgpr_write_b32 a233, v43
    v_perm_b32 v44, v17, v15, s44
    v_accvgpr_write_b32 a241, v44
    v_perm_b32 v45, v17, v15, s45
    v_accvgpr_write_b32 a249, v45
    v_perm_b32 v42, v20, v18, s44
    v_accvgpr_write_b32 a226, v42
    v_perm_b32 v43, v20, v18, s45
    v_accvgpr_write_b32 a234, v43
    v_perm_b32 v44, v21, v19, s44
    v_accvgpr_write_b32 a242, v44
    v_perm_b32 v45, v21, v19, s45
    v_accvgpr_write_b32 a250, v45
    v_perm_b32 v42, v24, v22, s44
    v_accvgpr_write_b32 a227, v42
    v_perm_b32 v43, v24, v22, s45
    v_accvgpr_write_b32 a235, v43
    v_perm_b32 v44, v25, v23, s44
    v_accvgpr_write_b32 a243, v44
    v_perm_b32 v45, v25, v23, s45
    v_accvgpr_write_b32 a251, v45
    v_perm_b32 v42, v28, v26, s44
    v_accvgpr_write_b32 a228, v42
    v_perm_b32 v43, v28, v26, s45
    v_accvgpr_write_b32 a236, v43
    v_perm_b32 v44, v29, v27, s44
    v_accvgpr_write_b32 a244, v44
    v_perm_b32 v45, v29, v27, s45
    v_accvgpr_write_b32 a252, v45
    v_perm_b32 v42, v32, v30, s44
    v_accvgpr_write_b32 a229, v42
    v_perm_b32 v43, v32, v30, s45
    v_accvgpr_write_b32 a237, v43
    v_perm_b32 v44, v33, v31, s44
    v_accvgpr_write_b32 a245, v44
    v_perm_b32 v45, v33, v31, s45
    v_accvgpr_write_b32 a253, v45
    v_perm_b32 v42, v36, v34, s44
    v_accvgpr_write_b32 a230, v42
    v_perm_b32 v43, v36, v34, s45
    v_accvgpr_write_b32 a238, v43
    v_perm_b32 v44, v37, v35, s44
    v_accvgpr_write_b32 a246, v44
    v_perm_b32 v45, v37, v35, s45
    v_accvgpr_write_b32 a254, v45
    v_perm_b32 v42, v40, v38, s44
    v_accvgpr_write_b32 a231, v42
    v_perm_b32 v43, v40, v38, s45
    v_accvgpr_write_b32 a239, v43
    v_perm_b32 v44, v41, v39, s44
    v_accvgpr_write_b32 a247, v44
    v_perm_b32 v45, v41, v39, s45
    v_accvgpr_write_b32 a255, v45
    s_waitcnt vmcnt(32)
    s_mov_b32 s38, 0
    buffer_load_dwordx2 v[112:113], v70, s[88:91], s38 offen offset:128
    s_mov_b32 s38, 1152
    buffer_load_dwordx2 v[114:115], v70, s[88:91], s38 offen offset:128
    s_mov_b32 s38, 36864
    buffer_load_dwordx2 v[116:117], v70, s[88:91], s38 offen offset:128
    s_mov_b32 s38, 38016
    buffer_load_dwordx2 v[118:119], v70, s[88:91], s38 offen offset:128
    s_mov_b32 s38, 2304
    buffer_load_dwordx2 v[120:121], v70, s[88:91], s38 offen offset:128
    s_mov_b32 s38, 3456
    buffer_load_dwordx2 v[122:123], v70, s[88:91], s38 offen offset:128
    s_mov_b32 s38, 39168
    buffer_load_dwordx2 v[124:125], v70, s[88:91], s38 offen offset:128
    s_mov_b32 s38, 40320
    buffer_load_dwordx2 v[126:127], v70, s[88:91], s38 offen offset:128
    s_mov_b32 s38, 18432
    buffer_load_dwordx2 v[128:129], v70, s[88:91], s38 offen offset:128
    s_mov_b32 s38, 19584
    buffer_load_dwordx2 v[130:131], v70, s[88:91], s38 offen offset:128
    s_mov_b32 s38, 55296
    buffer_load_dwordx2 v[132:133], v70, s[88:91], s38 offen offset:128
    s_mov_b32 s38, 56448
    buffer_load_dwordx2 v[134:135], v70, s[88:91], s38 offen offset:128
    s_mov_b32 s38, 20736
    buffer_load_dwordx2 v[136:137], v70, s[88:91], s38 offen offset:128
    s_mov_b32 s38, 21888
    buffer_load_dwordx2 v[138:139], v70, s[88:91], s38 offen offset:128
    s_mov_b32 s38, 57600
    buffer_load_dwordx2 v[140:141], v70, s[88:91], s38 offen offset:128
    s_mov_b32 s38, 58752
    buffer_load_dwordx2 v[142:143], v70, s[88:91], s38 offen offset:128
    v_mov_b32 v10, v224
    v_mov_b32 v11, v225
    v_mov_b32 v12, v226
    v_mov_b32 v13, v227
    v_mov_b32 v14, v228
    v_mov_b32 v15, v229
    v_mov_b32 v16, v230
    v_mov_b32 v17, v231
    v_mov_b32 v18, v232
    v_mov_b32 v19, v233
    v_mov_b32 v20, v234
    v_mov_b32 v21, v235
    v_mov_b32 v22, v236
    v_mov_b32 v23, v237
    v_mov_b32 v24, v238
    v_mov_b32 v25, v239
    v_mov_b32 v26, v240
    v_mov_b32 v27, v241
    v_mov_b32 v28, v242
    v_mov_b32 v29, v243
    v_mov_b32 v30, v244
    v_mov_b32 v31, v245
    v_mov_b32 v32, v246
    v_mov_b32 v33, v247
    v_mov_b32 v34, v248
    v_mov_b32 v35, v249
    v_mov_b32 v36, v250
    v_mov_b32 v37, v251
    v_mov_b32 v38, v252
    v_mov_b32 v39, v253
    v_mov_b32 v40, v254
    v_mov_b32 v41, v255
    v_perm_b32 v224, v12, v10, s44
    v_perm_b32 v232, v12, v10, s45
    v_perm_b32 v240, v13, v11, s44
    v_perm_b32 v248, v13, v11, s45
    v_perm_b32 v225, v16, v14, s44
    v_perm_b32 v233, v16, v14, s45
    v_perm_b32 v241, v17, v15, s44
    v_perm_b32 v249, v17, v15, s45
    v_perm_b32 v226, v20, v18, s44
    v_perm_b32 v234, v20, v18, s45
    v_perm_b32 v242, v21, v19, s44
    v_perm_b32 v250, v21, v19, s45
    v_perm_b32 v227, v24, v22, s44
    v_perm_b32 v235, v24, v22, s45
    v_perm_b32 v243, v25, v23, s44
    v_perm_b32 v251, v25, v23, s45
    v_perm_b32 v228, v28, v26, s44
    v_perm_b32 v236, v28, v26, s45
    v_perm_b32 v244, v29, v27, s44
    v_perm_b32 v252, v29, v27, s45
    v_perm_b32 v229, v32, v30, s44
    v_perm_b32 v237, v32, v30, s45
    v_perm_b32 v245, v33, v31, s44
    v_perm_b32 v253, v33, v31, s45
    v_perm_b32 v230, v36, v34, s44
    v_perm_b32 v238, v36, v34, s45
    v_perm_b32 v246, v37, v35, s44
    v_perm_b32 v254, v37, v35, s45
    v_perm_b32 v231, v40, v38, s44
    v_perm_b32 v239, v40, v38, s45
    v_perm_b32 v247, v41, v39, s44
    v_perm_b32 v255, v41, v39, s45
    s_waitcnt vmcnt(32)
    s_mov_b32 s38, 73728
    buffer_load_dwordx2 v[152:153], v70, s[88:91], s38 offen offset:0
    s_mov_b32 s38, 74880
    buffer_load_dwordx2 v[154:155], v70, s[88:91], s38 offen offset:0
    s_mov_b32 s38, 110592
    buffer_load_dwordx2 v[156:157], v70, s[88:91], s38 offen offset:0
    s_mov_b32 s38, 111744
    buffer_load_dwordx2 v[158:159], v70, s[88:91], s38 offen offset:0
    s_mov_b32 s38, 76032
    buffer_load_dwordx2 v[160:161], v70, s[88:91], s38 offen offset:0
    s_mov_b32 s38, 77184
    buffer_load_dwordx2 v[162:163], v70, s[88:91], s38 offen offset:0
    s_mov_b32 s38, 112896
    buffer_load_dwordx2 v[164:165], v70, s[88:91], s38 offen offset:0
    s_mov_b32 s38, 114048
    buffer_load_dwordx2 v[166:167], v70, s[88:91], s38 offen offset:0
    s_mov_b32 s38, 92160
    buffer_load_dwordx2 v[168:169], v70, s[88:91], s38 offen offset:0
    s_mov_b32 s38, 93312
    buffer_load_dwordx2 v[170:171], v70, s[88:91], s38 offen offset:0
    s_mov_b32 s38, 129024
    buffer_load_dwordx2 v[172:173], v70, s[88:91], s38 offen offset:0
    s_mov_b32 s38, 130176
    buffer_load_dwordx2 v[174:175], v70, s[88:91], s38 offen offset:0
    s_mov_b32 s38, 94464
    buffer_load_dwordx2 v[176:177], v70, s[88:91], s38 offen offset:0
    s_mov_b32 s38, 95616
    buffer_load_dwordx2 v[178:179], v70, s[88:91], s38 offen offset:0
    s_mov_b32 s38, 131328
    buffer_load_dwordx2 v[180:181], v70, s[88:91], s38 offen offset:0
    s_mov_b32 s38, 132480
    buffer_load_dwordx2 v[182:183], v70, s[88:91], s38 offen offset:0
    v_perm_b32 v144, v51, v50, v68
    v_perm_b32 v145, v53, v52, v68
    v_perm_b32 v146, v55, v54, v68
    v_perm_b32 v147, v57, v56, v68
    v_perm_b32 v148, v59, v58, v68
    v_perm_b32 v149, v61, v60, v68
    v_perm_b32 v150, v63, v62, v68
    v_perm_b32 v151, v65, v64, v68
    s_waitcnt vmcnt(32)
    s_mov_b32 s38, 73728
    buffer_load_dwordx2 v[184:185], v70, s[88:91], s38 offen offset:128
    s_mov_b32 s38, 74880
    buffer_load_dwordx2 v[186:187], v70, s[88:91], s38 offen offset:128
    s_mov_b32 s38, 110592
    buffer_load_dwordx2 v[188:189], v70, s[88:91], s38 offen offset:128
    s_mov_b32 s38, 111744
    buffer_load_dwordx2 v[190:191], v70, s[88:91], s38 offen offset:128
    s_mov_b32 s38, 76032
    buffer_load_dwordx2 v[192:193], v70, s[88:91], s38 offen offset:128
    s_mov_b32 s38, 77184
    buffer_load_dwordx2 v[194:195], v70, s[88:91], s38 offen offset:128
    s_mov_b32 s38, 112896
    buffer_load_dwordx2 v[196:197], v70, s[88:91], s38 offen offset:128
    s_mov_b32 s38, 114048
    buffer_load_dwordx2 v[198:199], v70, s[88:91], s38 offen offset:128
    s_mov_b32 s38, 92160
    buffer_load_dwordx2 v[200:201], v70, s[88:91], s38 offen offset:128
    s_mov_b32 s38, 93312
    buffer_load_dwordx2 v[202:203], v70, s[88:91], s38 offen offset:128
    s_mov_b32 s38, 129024
    buffer_load_dwordx2 v[204:205], v70, s[88:91], s38 offen offset:128
    s_mov_b32 s38, 130176
    buffer_load_dwordx2 v[206:207], v70, s[88:91], s38 offen offset:128
    s_mov_b32 s38, 94464
    buffer_load_dwordx2 v[208:209], v70, s[88:91], s38 offen offset:128
    s_mov_b32 s38, 95616
    buffer_load_dwordx2 v[210:211], v70, s[88:91], s38 offen offset:128
    s_mov_b32 s38, 131328
    buffer_load_dwordx2 v[212:213], v70, s[88:91], s38 offen offset:128
    s_mov_b32 s38, 132480
    buffer_load_dwordx2 v[214:215], v70, s[88:91], s38 offen offset:128
    v_mov_b32 v10, v80
    v_mov_b32 v11, v81
    v_mov_b32 v12, v82
    v_mov_b32 v13, v83
    v_mov_b32 v14, v84
    v_mov_b32 v15, v85
    v_mov_b32 v16, v86
    v_mov_b32 v17, v87
    v_mov_b32 v18, v88
    v_mov_b32 v19, v89
    v_mov_b32 v20, v90
    v_mov_b32 v21, v91
    v_mov_b32 v22, v92
    v_mov_b32 v23, v93
    v_mov_b32 v24, v94
    v_mov_b32 v25, v95
    v_mov_b32 v26, v96
    v_mov_b32 v27, v97
    v_mov_b32 v28, v98
    v_mov_b32 v29, v99
    v_mov_b32 v30, v100
    v_mov_b32 v31, v101
    v_mov_b32 v32, v102
    v_mov_b32 v33, v103
    v_mov_b32 v34, v104
    v_mov_b32 v35, v105
    v_mov_b32 v36, v106
    v_mov_b32 v37, v107
    v_mov_b32 v38, v108
    v_mov_b32 v39, v109
    v_mov_b32 v40, v110
    v_mov_b32 v41, v111
    v_perm_b32 v80, v12, v10, s44
    v_perm_b32 v88, v12, v10, s45
    v_perm_b32 v96, v13, v11, s44
    v_perm_b32 v104, v13, v11, s45
    v_perm_b32 v81, v16, v14, s44
    v_perm_b32 v89, v16, v14, s45
    v_perm_b32 v97, v17, v15, s44
    v_perm_b32 v105, v17, v15, s45
    v_perm_b32 v82, v20, v18, s44
    v_perm_b32 v90, v20, v18, s45
    v_perm_b32 v98, v21, v19, s44
    v_perm_b32 v106, v21, v19, s45
    v_perm_b32 v83, v24, v22, s44
    v_perm_b32 v91, v24, v22, s45
    v_perm_b32 v99, v25, v23, s44
    v_perm_b32 v107, v25, v23, s45
    v_perm_b32 v84, v28, v26, s44
    v_perm_b32 v92, v28, v26, s45
    v_perm_b32 v100, v29, v27, s44
    v_perm_b32 v108, v29, v27, s45
    v_perm_b32 v85, v32, v30, s44
    v_perm_b32 v93, v32, v30, s45
    v_perm_b32 v101, v33, v31, s44
    v_perm_b32 v109, v33, v31, s45
    v_perm_b32 v86, v36, v34, s44
    v_perm_b32 v94, v36, v34, s45
    v_perm_b32 v102, v37, v35, s44
    v_perm_b32 v110, v37, v35, s45
    v_perm_b32 v87, v40, v38, s44
    v_perm_b32 v95, v40, v38, s45
    v_perm_b32 v103, v41, v39, s44
    v_perm_b32 v111, v41, v39, s45
    s_waitcnt vmcnt(32)
    s_mov_b32 s38, 73728
    buffer_load_dword v50, v69, s[88:91], s38 offen offset:256
    s_mov_b32 s38, 74880
    buffer_load_dword v51, v69, s[88:91], s38 offen offset:256
    s_mov_b32 s38, 110592
    buffer_load_dword v52, v69, s[88:91], s38 offen offset:256
    s_mov_b32 s38, 111744
    buffer_load_dword v53, v69, s[88:91], s38 offen offset:256
    s_mov_b32 s38, 76032
    buffer_load_dword v54, v69, s[88:91], s38 offen offset:256
    s_mov_b32 s38, 77184
    buffer_load_dword v55, v69, s[88:91], s38 offen offset:256
    s_mov_b32 s38, 112896
    buffer_load_dword v56, v69, s[88:91], s38 offen offset:256
    s_mov_b32 s38, 114048
    buffer_load_dword v57, v69, s[88:91], s38 offen offset:256
    s_mov_b32 s38, 92160
    buffer_load_dword v58, v69, s[88:91], s38 offen offset:256
    s_mov_b32 s38, 93312
    buffer_load_dword v59, v69, s[88:91], s38 offen offset:256
    s_mov_b32 s38, 129024
    buffer_load_dword v60, v69, s[88:91], s38 offen offset:256
    s_mov_b32 s38, 130176
    buffer_load_dword v61, v69, s[88:91], s38 offen offset:256
    s_mov_b32 s38, 94464
    buffer_load_dword v62, v69, s[88:91], s38 offen offset:256
    s_mov_b32 s38, 95616
    buffer_load_dword v63, v69, s[88:91], s38 offen offset:256
    s_mov_b32 s38, 131328
    buffer_load_dword v64, v69, s[88:91], s38 offen offset:256
    s_mov_b32 s38, 132480
    buffer_load_dword v65, v69, s[88:91], s38 offen offset:256
    v_mov_b32 v10, v112
    v_mov_b32 v11, v113
    v_mov_b32 v12, v114
    v_mov_b32 v13, v115
    v_mov_b32 v14, v116
    v_mov_b32 v15, v117
    v_mov_b32 v16, v118
    v_mov_b32 v17, v119
    v_mov_b32 v18, v120
    v_mov_b32 v19, v121
    v_mov_b32 v20, v122
    v_mov_b32 v21, v123
    v_mov_b32 v22, v124
    v_mov_b32 v23, v125
    v_mov_b32 v24, v126
    v_mov_b32 v25, v127
    v_mov_b32 v26, v128
    v_mov_b32 v27, v129
    v_mov_b32 v28, v130
    v_mov_b32 v29, v131
    v_mov_b32 v30, v132
    v_mov_b32 v31, v133
    v_mov_b32 v32, v134
    v_mov_b32 v33, v135
    v_mov_b32 v34, v136
    v_mov_b32 v35, v137
    v_mov_b32 v36, v138
    v_mov_b32 v37, v139
    v_mov_b32 v38, v140
    v_mov_b32 v39, v141
    v_mov_b32 v40, v142
    v_mov_b32 v41, v143
    v_perm_b32 v112, v12, v10, s44
    v_perm_b32 v120, v12, v10, s45
    v_perm_b32 v128, v13, v11, s44
    v_perm_b32 v136, v13, v11, s45
    v_perm_b32 v113, v16, v14, s44
    v_perm_b32 v121, v16, v14, s45
    v_perm_b32 v129, v17, v15, s44
    v_perm_b32 v137, v17, v15, s45
    v_perm_b32 v114, v20, v18, s44
    v_perm_b32 v122, v20, v18, s45
    v_perm_b32 v130, v21, v19, s44
    v_perm_b32 v138, v21, v19, s45
    v_perm_b32 v115, v24, v22, s44
    v_perm_b32 v123, v24, v22, s45
    v_perm_b32 v131, v25, v23, s44
    v_perm_b32 v139, v25, v23, s45
    v_perm_b32 v116, v28, v26, s44
    v_perm_b32 v124, v28, v26, s45
    v_perm_b32 v132, v29, v27, s44
    v_perm_b32 v140, v29, v27, s45
    v_perm_b32 v117, v32, v30, s44
    v_perm_b32 v125, v32, v30, s45
    v_perm_b32 v133, v33, v31, s44
    v_perm_b32 v141, v33, v31, s45
    v_perm_b32 v118, v36, v34, s44
    v_perm_b32 v126, v36, v34, s45
    v_perm_b32 v134, v37, v35, s44
    v_perm_b32 v142, v37, v35, s45
    v_perm_b32 v119, v40, v38, s44
    v_perm_b32 v127, v40, v38, s45
    v_perm_b32 v135, v41, v39, s44
    v_perm_b32 v143, v41, v39, s45
    s_waitcnt vmcnt(32)
    v_mov_b32 v10, v152
    v_mov_b32 v11, v153
    v_mov_b32 v12, v154
    v_mov_b32 v13, v155
    v_mov_b32 v14, v156
    v_mov_b32 v15, v157
    v_mov_b32 v16, v158
    v_mov_b32 v17, v159
    v_mov_b32 v18, v160
    v_mov_b32 v19, v161
    v_mov_b32 v20, v162
    v_mov_b32 v21, v163
    v_mov_b32 v22, v164
    v_mov_b32 v23, v165
    v_mov_b32 v24, v166
    v_mov_b32 v25, v167
    v_mov_b32 v26, v168
    v_mov_b32 v27, v169
    v_mov_b32 v28, v170
    v_mov_b32 v29, v171
    v_mov_b32 v30, v172
    v_mov_b32 v31, v173
    v_mov_b32 v32, v174
    v_mov_b32 v33, v175
    v_mov_b32 v34, v176
    v_mov_b32 v35, v177
    v_mov_b32 v36, v178
    v_mov_b32 v37, v179
    v_mov_b32 v38, v180
    v_mov_b32 v39, v181
    v_mov_b32 v40, v182
    v_mov_b32 v41, v183
    v_perm_b32 v152, v12, v10, s44
    v_perm_b32 v160, v12, v10, s45
    v_perm_b32 v168, v13, v11, s44
    v_perm_b32 v176, v13, v11, s45
    v_perm_b32 v153, v16, v14, s44
    v_perm_b32 v161, v16, v14, s45
    v_perm_b32 v169, v17, v15, s44
    v_perm_b32 v177, v17, v15, s45
    v_perm_b32 v154, v20, v18, s44
    v_perm_b32 v162, v20, v18, s45
    v_perm_b32 v170, v21, v19, s44
    v_perm_b32 v178, v21, v19, s45
    v_perm_b32 v155, v24, v22, s44
    v_perm_b32 v163, v24, v22, s45
    v_perm_b32 v171, v25, v23, s44
    v_perm_b32 v179, v25, v23, s45
    v_perm_b32 v156, v28, v26, s44
    v_perm_b32 v164, v28, v26, s45
    v_perm_b32 v172, v29, v27, s44
    v_perm_b32 v180, v29, v27, s45
    v_perm_b32 v157, v32, v30, s44
    v_perm_b32 v165, v32, v30, s45
    v_perm_b32 v173, v33, v31, s44
    v_perm_b32 v181, v33, v31, s45
    v_perm_b32 v158, v36, v34, s44
    v_perm_b32 v166, v36, v34, s45
    v_perm_b32 v174, v37, v35, s44
    v_perm_b32 v182, v37, v35, s45
    v_perm_b32 v159, v40, v38, s44
    v_perm_b32 v167, v40, v38, s45
    v_perm_b32 v175, v41, v39, s44
    v_perm_b32 v183, v41, v39, s45
    s_waitcnt vmcnt(16)
    v_mov_b32 v10, v184
    v_mov_b32 v11, v185
    v_mov_b32 v12, v186
    v_mov_b32 v13, v187
    v_mov_b32 v14, v188
    v_mov_b32 v15, v189
    v_mov_b32 v16, v190
    v_mov_b32 v17, v191
    v_mov_b32 v18, v192
    v_mov_b32 v19, v193
    v_mov_b32 v20, v194
    v_mov_b32 v21, v195
    v_mov_b32 v22, v196
    v_mov_b32 v23, v197
    v_mov_b32 v24, v198
    v_mov_b32 v25, v199
    v_mov_b32 v26, v200
    v_mov_b32 v27, v201
    v_mov_b32 v28, v202
    v_mov_b32 v29, v203
    v_mov_b32 v30, v204
    v_mov_b32 v31, v205
    v_mov_b32 v32, v206
    v_mov_b32 v33, v207
    v_mov_b32 v34, v208
    v_mov_b32 v35, v209
    v_mov_b32 v36, v210
    v_mov_b32 v37, v211
    v_mov_b32 v38, v212
    v_mov_b32 v39, v213
    v_mov_b32 v40, v214
    v_mov_b32 v41, v215
    v_perm_b32 v184, v12, v10, s44
    v_perm_b32 v192, v12, v10, s45
    v_perm_b32 v200, v13, v11, s44
    v_perm_b32 v208, v13, v11, s45
    v_perm_b32 v185, v16, v14, s44
    v_perm_b32 v193, v16, v14, s45
    v_perm_b32 v201, v17, v15, s44
    v_perm_b32 v209, v17, v15, s45
    v_perm_b32 v186, v20, v18, s44
    v_perm_b32 v194, v20, v18, s45
    v_perm_b32 v202, v21, v19, s44
    v_perm_b32 v210, v21, v19, s45
    v_perm_b32 v187, v24, v22, s44
    v_perm_b32 v195, v24, v22, s45
    v_perm_b32 v203, v25, v23, s44
    v_perm_b32 v211, v25, v23, s45
    v_perm_b32 v188, v28, v26, s44
    v_perm_b32 v196, v28, v26, s45
    v_perm_b32 v204, v29, v27, s44
    v_perm_b32 v212, v29, v27, s45
    v_perm_b32 v189, v32, v30, s44
    v_perm_b32 v197, v32, v30, s45
    v_perm_b32 v205, v33, v31, s44
    v_perm_b32 v213, v33, v31, s45
    v_perm_b32 v190, v36, v34, s44
    v_perm_b32 v198, v36, v34, s45
    v_perm_b32 v206, v37, v35, s44
    v_perm_b32 v214, v37, v35, s45
    v_perm_b32 v191, v40, v38, s44
    v_perm_b32 v199, v40, v38, s45
    v_perm_b32 v207, v41, v39, s44
    v_perm_b32 v215, v41, v39, s45
    s_waitcnt vmcnt(0)
    v_perm_b32 v216, v51, v50, v68
    v_perm_b32 v217, v53, v52, v68
    v_perm_b32 v218, v55, v54, v68
    v_perm_b32 v219, v57, v56, v68
    v_perm_b32 v220, v59, v58, v68
    v_perm_b32 v221, v61, v60, v68
    v_perm_b32 v222, v63, v62, v68
    v_perm_b32 v223, v65, v64, v68
    s_mul_i32 s38, s8, 36864
    v_subrev_u32 v64, s38, v0
    v_and_b32 v65, 0xf0, v64
    v_lshrrev_b32 v64, 8, v64
    v_lshlrev_b32 v64, 9, v64
    v_lshrrev_b32 v66, 6, v64
    v_lshl_add_u32 v66, v65, 1, v66
    s_lshl_b32 s38, s8, 9
    v_add_u32 v76, s38, v66
    v_add_u32 v65, v64, v65
    s_and_b32 s38, s8, 1
    s_lshl_b32 s38, s38, 8
    v_add_u32 v75, s38, v65
    v_add_u32 v77, s52, v3
    v_add_u32 v9, s53, v0
    s_mul_i32 s38, s8, 36864
    v_subrev_u32 v64, s38, v0
    v_lshrrev_b32 v65, 9, v64
    s_lshl_b32 s38, s8, 1
    s_add_u32 s38, s38, 64
    v_add_u32 v65, s38, v65
    v_mul_u32_u24 v65, 4224, v65
    v_and_b32 v64, 0x1f0, v64
    v_lshrrev_b32 v64, 2, v64
    v_add_u32 v65, v65, v64
    s_lshl_b32 s38, s9, 7
    v_add_u32 v78, s38, v65
    s_mov_b32 s68, s37
    s_mov_b32 s69, s37
    s_cmp_lg_u32 s8, 3
    s_cbranch_scc1 L_pc_85
    s_mul_i32 s38, s8, 36864
    v_subrev_u32 v64, s38, v0
    v_lshrrev_b32 v64, 4, v64
    v_lshrrev_b32 v65, 4, v64
    v_mul_u32_u24 v67, 144, v65
    v_and_b32 v65, 1, v64
    v_lshl_add_u32 v67, v65, 6, v67
    v_bfe_u32 v65, v64, 1, 1
    v_lshl_add_u32 v67, v65, 5, v67
    v_bfe_u32 v68, v64, 2, 2
    v_lshrrev_b32 v66, 6, v67
    v_lshlrev_b32 v6, 10, v66
    v_bfe_u32 v66, v67, 4, 2
    v_lshl_add_u32 v6, v66, 8, v6
    v_bfe_u32 v66, v67, 3, 1
    v_lshl_add_u32 v6, v66, 5, v6
    v_and_b32 v66, 7, v67
    v_lshl_add_u32 v6, v66, 1, v6
    v_lshl_add_u32 v6, v68, 6, v6
    v_bfe_u32 v65, v64, 1, 2
    v_mul_u32_u24 v67, 144, v65
    v_add_u32 v67, 128, v67
    v_and_b32 v68, 1, v64
    v_lshlrev_b32 v68, 1, v68
    v_lshrrev_b32 v66, 6, v67
    v_lshlrev_b32 v7, 10, v66
    v_bfe_u32 v66, v67, 4, 2
    v_lshl_add_u32 v7, v66, 8, v7
    v_bfe_u32 v66, v67, 3, 1
    v_lshl_add_u32 v7, v66, 5, v7
    v_and_b32 v66, 7, v67
    v_lshl_add_u32 v7, v66, 1, v7
    v_lshl_add_u32 v7, v68, 6, v7
L_pc_85:
    s_mul_i32 s38, s8, -34816
    s_lshl_b32 s39, s9, 13
    s_add_u32 s38, s38, s39
    s_ashr_i32 s47, s38, 31
    s_add_u32 s14, s4, s38
    s_addc_u32 s15, s5, s47
    s_add_u32 s12, s14, 262144
    s_addc_u32 s13, s15, 0
    s_mov_b64 s[50:51], s[14:15]
    s_mul_i32 s38, s8, -71680
    s_lshl_b32 s39, s9, 13
    s_add_u32 s38, s38, s39
    s_ashr_i32 s47, s38, 31
    s_add_u32 s48, s4, s38
    s_addc_u32 s49, s5, s47
    s_add_u32 s60, s48, 262144
    s_addc_u32 s61, s49, 0
    s_add_u32 s48, s48, 17039360
    s_addc_u32 s49, s49, 0
    s_add_u32 s14, s50, 16777216
    s_addc_u32 s15, s51, 0
    s_lshl_b32 s38, s9, 11
    s_add_u32 s16, s4, s38
    s_addc_u32 s17, s5, 0
    s_add_u32 s18, s16, 37748736
    s_addc_u32 s19, s17, 0
    s_cmp_lt_u32 s8, 2
    s_cselect_b32 s38, 12582912, 0
    s_add_u32 s38, s38, 33554432
    s_add_u32 s16, s16, s38
    s_addc_u32 s17, s17, 0
    s_mul_i32 s38, s8, -36864
    s_ashr_i32 s47, s38, 31
    s_add_u32 s24, s34, s38
    s_addc_u32 s25, s35, s47
    s_add_u32 s26, s24, 8192
    s_addc_u32 s27, s25, 0
    s_add_u32 s24, s24, 4096
    s_addc_u32 s25, s25, 0
    s_add_u32 s28, s24, 16384
    s_addc_u32 s29, s25, 0
    s_add_u32 s30, s26, 16384
    s_addc_u32 s31, s27, 0
    s_mov_b32 s10, 0
    s_mov_b32 s11, 0
    s_mov_b32 s3, 0
    v_mov_b32 v74, 160
L_sw_86:
    global_load_dword v79, v74, s[6:7] sc1
    s_waitcnt vmcnt(0)
    v_readfirstlane_b32 s38, v79
    s_cmp_ge_u32 s38, 224
    s_cbranch_scc1 L_swok_87
    s_sub_u32 s36, s36, 1
    s_cbranch_scc1 L_bail
    s_sleep 2
    s_branch L_sw_86
L_swok_87:
    v_mov_b32 v74, 60
L_sw_88:
    global_load_dword v79, v74, s[6:7] sc1
    s_waitcnt vmcnt(0)
    v_readfirstlane_b32 s38, v79
    s_cmp_ge_u32 s38, 128
    s_cbranch_scc1 L_swok_89
    s_sub_u32 s36, s36, 1
    s_cbranch_scc1 L_bail
    s_sleep 2
    s_branch L_sw_88
L_swok_89:
    s_lshl_b32 s38, s8, 11
    s_add_u32 s38, s38, 147456
    s_mov_b32 m0, s38
    s_add_u32 s50, s50, 0
    s_addc_u32 s51, s51, 0
    global_load_lds_dwordx4 v0, s[50:51] offset:0
    global_load_lds_dwordx4 v0, s[50:51] offset:1024
    v_mov_b32 v74, 72
L_sw_90:
    global_load_dword v79, v74, s[6:7] sc1
    s_waitcnt vmcnt(0)
    v_readfirstlane_b32 s38, v79
    s_cmp_ge_u32 s38, 32
    s_cbranch_scc1 L_swok_91
    s_sub_u32 s36, s36, 1
    s_cbranch_scc1 L_bail
    s_sleep 2
    s_branch L_sw_90
L_swok_91:
    s_waitcnt vmcnt(0) lgkmcnt(0)
    s_barrier
    v_mov_b64 v[34:35], 0
    v_mov_b64 v[36:37], 0
    v_mov_b64 v[38:39], 0
    v_mov_b64 v[40:41], 0
    v_mov_b64 v[42:43], 0
    v_mov_b64 v[44:45], 0
    v_mov_b64 v[46:47], 0
    v_mov_b64 v[48:49], 0
    v_mov_b64 v[50:51], 0
    v_mov_b64 v[52:53], 0
    v_mov_b64 v[54:55], 0
    v_mov_b64 v[56:57], 0
    s_lshl_b32 s38, s8, 11
    s_add_u32 s38, s38, 147456
    s_mov_b32 m0, s38
    ds_read_b128 v[58:61], v0 offset:0
    ds_read_b128 v[62:65], v0 offset:1024
    s_waitcnt lgkmcnt(0)
    ds_read_b128 v[66:69], v0 offset:2048
    ds_read_b128 v[70:73], v0 offset:3072
    ds_read_b128 v[26:29], v0 offset:4096
    ds_read_b128 v[30:33], v0 offset:5120
    s_barrier
    global_load_dwordx4 v[10:13], v0, s[24:25] offset:-4096 sc1
    global_load_dwordx4 v[14:17], v0, s[24:25] offset:-3072 sc1
    global_load_dwordx4 v[18:21], v0, s[24:25] offset:-2048 sc1
    global_load_dwordx4 v[22:25], v0, s[24:25] offset:-1024 sc1
L_step_92:
L_gstart_93:
    s_waitcnt vmcnt(3)
    v_max3_u32 v74, v10, v11, v12
    v_max_u32 v74, v74, v13
    v_cmp_eq_u32 vcc, -1, v74
    s_cbranch_vccnz L_fr_94
L_fb_95:
    v_smfmac_f32_16x16x64_bf16 v[50:53], v[10:13], v[58:65], v1
    ds_read_b128 v[58:61], v0 offset:6144
    ds_read_b128 v[62:65], v0 offset:7168
    s_waitcnt vmcnt(2)
    v_max3_u32 v74, v14, v15, v16
    v_smfmac_f32_16x16x64_bf16 v[34:37], v[10:13], a[0:7], v1
    v_max_u32 v74, v74, v17
    v_smfmac_f32_16x16x64_bf16 v[38:41], v[10:13], a[8:15], v1
    v_cmp_eq_u32 vcc, -1, v74
    s_waitcnt lgkmcnt(4)
    v_smfmac_f32_16x16x64_bf16 v[54:57], v[10:13], v[66:73], v1
    ds_read_b128 v[66:69], v0 offset:8192
    ds_read_b128 v[70:73], v0 offset:9216
    v_smfmac_f32_16x16x64_bf16 v[42:45], v[10:13], a[16:23], v1
    v_smfmac_f32_16x16x64_bf16 v[46:49], v[10:13], a[24:31], v1
    global_load_dwordx4 v[10:13], v0, s[24:25] offset:0 sc1
    s_cbranch_vccnz L_fr_96
L_fb_97:
    s_waitcnt lgkmcnt(4)
    v_smfmac_f32_16x16x64_bf16 v[50:53], v[14:17], v[26:33], v1
    ds_read_b128 v[26:29], v0 offset:10240
    ds_read_b128 v[30:33], v0 offset:11264
    s_waitcnt vmcnt(2)
    v_max3_u32 v74, v18, v19, v20
    v_smfmac_f32_16x16x64_bf16 v[34:37], v[14:17], a[32:39], v1
    v_max_u32 v74, v74, v21
    v_smfmac_f32_16x16x64_bf16 v[38:41], v[14:17], a[40:47], v1
    v_cmp_eq_u32 vcc, -1, v74
    s_waitcnt lgkmcnt(4)
    v_smfmac_f32_16x16x64_bf16 v[54:57], v[14:17], v[58:65], v1
    ds_read_b128 v[58:61], v0 offset:12288
    ds_read_b128 v[62:65], v0 offset:13312
    v_smfmac_f32_16x16x64_bf16 v[42:45], v[14:17], a[48:55], v1
    v_smfmac_f32_16x16x64_bf16 v[46:49], v[14:17], a[56:63], v1
    global_load_dwordx4 v[14:17], v0, s[24:25] offset:1024 sc1
    s_cbranch_vccnz L_fr_98
L_fb_99:
    s_waitcnt lgkmcnt(4)
    v_smfmac_f32_16x16x64_bf16 v[50:53], v[18:21], v[66:73], v1
    ds_read_b128 v[66:69], v0 offset:14336
    ds_read_b128 v[70:73], v0 offset:15360
    s_waitcnt vmcnt(2)
    v_max3_u32 v74, v22, v23, v24
    v_smfmac_f32_16x16x64_bf16 v[34:37], v[18:21], a[64:71], v1
    v_max_u32 v74, v74, v25
    v_smfmac_f32_16x16x64_bf16 v[38:41], v[18:21], a[72:79], v1
    v_cmp_eq_u32 vcc, -1, v74
    s_waitcnt lgkmcnt(4)
    v_smfmac_f32_16x16x64_bf16 v[54:57], v[18:21], v[26:33], v1
    ds_read_b128 v[26:29], v0 offset:16384
    ds_read_b128 v[30:33], v0 offset:17408
    v_smfmac_f32_16x16x64_bf16 v[42:45], v[18:21], a[80:87], v1
    v_smfmac_f32_16x16x64_bf16 v[46:49], v[18:21], a[88:95], v1
    global_load_dwordx4 v[18:21], v0, s[24:25] offset:2048 sc1
    s_cbranch_vccnz L_fr_100
L_fb_101:
    s_waitcnt lgkmcnt(4)
    v_smfmac_f32_16x16x64_bf16 v[50:53], v[22:25], v[58:65], v1
    ds_read_b128 v[58:61], v0 offset:18432
    ds_read_b128 v[62:65], v0 offset:19456
    v_smfmac_f32_16x16x64_bf16 v[34:37], v[22:25], a[96:103], v1
    v_smfmac_f32_16x16x64_bf16 v[38:41], v[22:25], a[104:111], v1
    s_waitcnt lgkmcnt(4)
    v_smfmac_f32_16x16x64_bf16 v[54:57], v[22:25], v[66:73], v1
    ds_read_b128 v[66:69], v0 offset:20480
    ds_read_b128 v[70:73], v0 offset:21504
    v_smfmac_f32_16x16x64_bf16 v[42:45], v[22:25], a[112:119], v1
    v_smfmac_f32_16x16x64_bf16 v[46:49], v[22:25], a[120:127], v1
    global_load_dwordx4 v[22:25], v0, s[24:25] offset:3072 sc1
    s_waitcnt vmcnt(3)
    s_waitcnt lgkmcnt(4)
    v_smfmac_f32_16x16x64_bf16 v[50:53], v[10:13], v[26:33], v1
    ds_read_b128 v[26:29], v0 offset:22528
    ds_read_b128 v[30:33], v0 offset:23552
    v_max3_u32 v79, v10, v11, v12
    v_smfmac_f32_16x16x64_bf16 v[34:37], v[10:13], a[128:135], v1
    v_max_u32 v79, v79, v13
    v_smfmac_f32_16x16x64_bf16 v[38:41], v[10:13], a[136:143], v1
    s_waitcnt lgkmcnt(4)
    v_smfmac_f32_16x16x64_bf16 v[54:57], v[10:13], v[58:65], v1
    ds_read_b128 v[58:61], v0 offset:24576
    ds_read_b128 v[62:65], v0 offset:25600
    v_smfmac_f32_16x16x64_bf16 v[42:45], v[10:13], a[144:151], v1
    v_smfmac_f32_16x16x64_bf16 v[46:49], v[10:13], a[152:159], v1
    global_load_dwordx4 v[10:13], v0, s[26:27] sc1
    s_waitcnt vmcnt(3)
    s_waitcnt lgkmcnt(4)
    v_smfmac_f32_16x16x64_bf16 v[50:53], v[14:17], v[66:73], v1
    ds_read_b128 v[66:69], v0 offset:26624
    ds_read_b128 v[70:73], v0 offset:27648
    v_max3_u32 v79, v79, v14, v15
    v_smfmac_f32_16x16x64_bf16 v[34:37], v[14:17], a[160:167], v1
    v_max3_u32 v79, v79, v16, v17
    v_smfmac_f32_16x16x64_bf16 v[38:41], v[14:17], a[168:175], v1
    s_waitcnt lgkmcnt(4)
    v_smfmac_f32_16x16x64_bf16 v[54:57], v[14:17], v[26:33], v1
    ds_read_b128 v[26:29], v0 offset:28672
    ds_read_b128 v[30:33], v0 offset:29696
    v_smfmac_f32_16x16x64_bf16 v[42:45], v[14:17], a[176:183], v1
    v_smfmac_f32_16x16x64_bf16 v[46:49], v[14:17], a[184:191], v1
    s_waitcnt vmcnt(2)
    s_waitcnt lgkmcnt(4)
    v_smfmac_f32_16x16x64_bf16 v[50:53], v[18:21], v[58:65], v1
    ds_read_b128 v[58:61], v0 offset:30720
    ds_read_b128 v[62:65], v0 offset:31744
    v_max3_u32 v79, v79, v18, v19
    v_smfmac_f32_16x16x64_bf16 v[34:37], v[18:21], a[192:199], v1
    v_max3_u32 v79, v79, v20, v21
    v_smfmac_f32_16x16x64_bf16 v[38:41], v[18:21], a[200:207], v1
    s_waitcnt lgkmcnt(4)
    v_smfmac_f32_16x16x64_bf16 v[54:57], v[18:21], v[66:73], v1
    ds_read_b128 v[66:69], v0 offset:32768
    ds_read_b128 v[70:73], v0 offset:33792
    v_smfmac_f32_16x16x64_bf16 v[42:45], v[18:21], a[208:215], v1
    v_smfmac_f32_16x16x64_bf16 v[46:49], v[18:21], a[216:223], v1
    s_waitcnt vmcnt(1)
    s_waitcnt lgkmcnt(4)
    v_smfmac_f32_16x16x64_bf16 v[50:53], v[22:25], v[26:33], v1
    ds_read_b128 v[26:29], v0 offset:34816
    ds_read_b128 v[30:33], v0 offset:35840
    v_max3_u32 v79, v79, v22, v23
    v_smfmac_f32_16x16x64_bf16 v[34:37], v[22:25], a[224:231], v1
    v_max3_u32 v79, v79, v24, v25
    v_smfmac_f32_16x16x64_bf16 v[38:41], v[22:25], a[232:239], v1
    s_waitcnt lgkmcnt(4)
    v_smfmac_f32_16x16x64_bf16 v[54:57], v[22:25], v[58:65], v1
    v_smfmac_f32_16x16x64_bf16 v[42:45], v[22:25], a[240:247], v1
    v_smfmac_f32_16x16x64_bf16 v[46:49], v[22:25], a[248:255], v1
    s_waitcnt vmcnt(0)
    v_smfmac_f32_16x16x64_bf16 v[34:37], v[10:13], v[224:231], v1
    v_max3_u32 v79, v79, v10, v11
    v_smfmac_f32_16x16x64_bf16 v[38:41], v[10:13], v[232:239], v1
    v_max3_u32 v79, v79, v12, v13
    v_smfmac_f32_16x16x64_bf16 v[42:45], v[10:13], v[240:247], v1
    v_smfmac_f32_16x16x64_bf16 v[46:49], v[10:13], v[248:255], v1
    s_waitcnt lgkmcnt(2)
    v_smfmac_f32_16x16x64_bf16 v[50:53], v[10:13], v[66:73], v1
    s_waitcnt lgkmcnt(0)
    v_smfmac_f32_16x16x64_bf16 v[54:57], v[10:13], v[26:33], v1
    v_cmp_eq_u32 vcc, -1, v79
    s_cbranch_vccnz L_redo_102
    global_load_dwordx4 v[26:29], v0, s[14:15] offset:0
    global_load_dwordx4 v[30:33], v0, s[14:15] offset:1024
    ds_read_b128 v[10:13], v9 offset:0
    ds_read_b128 v[14:17], v9 offset:4096
    ds_read_b128 v[18:21], v9 offset:1024
    ds_read_b128 v[22:25], v9 offset:5120
    v_pk_add_f32 v[34:35], v[34:35], v[36:37]
    v_pk_add_f32 v[38:39], v[38:39], v[40:41]
    v_pk_add_f32 v[42:43], v[42:43], v[44:45]
    v_pk_add_f32 v[46:47], v[46:47], v[48:49]
    v_cvt_pk_bf16_f32 v58, v34, v38
    v_cvt_pk_bf16_f32 v59, v42, v46
    ds_write_b64 v2, v[58:59]
    v_cvt_pk_bf16_f32 v60, v35, v39
    v_cvt_pk_bf16_f32 v61, v43, v47
    ds_write_b64 v2, v[60:61] offset:288
    v_pk_add_f32 v[50:51], v[50:51], v[52:53]
    v_pk_add_f32 v[54:55], v[54:55], v[56:57]
    v_cvt_pk_bf16_f32 v56, v50, v51
    v_cvt_pk_bf16_f32 v57, v54, v55
    v_min_u32 v58, -2, v58
    v_min_u32 v59, -2, v59
    v_min_u32 v60, -2, v60
    v_min_u32 v61, -2, v61
    v_min_u32 v62, -2, v56
    v_min_u32 v63, -2, v57
    s_waitcnt lgkmcnt(0)
    s_barrier
    ds_read_b128 v[34:37], v3 offset:0
    ds_read_b128 v[38:41], v3 offset:64
    global_store_dwordx4 v75, v[58:61], s[16:17] sc1
    global_store_dwordx2 v76, v[62:63], s[18:19] sc1
    ds_read_b128 v[58:61], v4 offset:0
    ds_read_b128 v[42:45], v3 offset:128
    ds_read_b128 v[62:65], v4 offset:64
    ds_read_b128 v[66:69], v4 offset:128
    v_lshlrev_b32 v74, 1, v0
    global_load_dword v8, v74, s[60:61]
    global_load_dword v8, v74, s[48:49]
    s_waitcnt lgkmcnt(5)
    v_mfma_f32_16x16x32_bf16 v[50:53], v[10:13], v[34:37], 0
    v_mfma_f32_16x16x32_bf16 v[70:73], v[14:17], v[34:37], 0
    ds_read_b128 v[10:13], v9 offset:2048
    ds_read_b128 v[14:17], v9 offset:6144
    s_waitcnt lgkmcnt(5)
    v_mfma_f32_16x16x32_bf16 v[46:49], v[58:61], v[34:37], 0
    ds_read_b128 v[34:37], v3 offset:192
    ds_read_b128 v[58:61], v4 offset:192
    v_mfma_f32_16x16x32_bf16 v[50:53], v[18:21], v[38:41], v[50:53]
    v_mfma_f32_16x16x32_bf16 v[70:73], v[22:25], v[38:41], v[70:73]
    ds_read_b128 v[18:21], v9 offset:3072
    ds_read_b128 v[22:25], v9 offset:7168
    s_waitcnt lgkmcnt(7)
    v_mfma_f32_16x16x32_bf16 v[46:49], v[62:65], v[38:41], v[46:49]
    s_waitcnt lgkmcnt(4)
    v_mfma_f32_16x16x32_bf16 v[50:53], v[10:13], v[42:45], v[50:53]
    v_mfma_f32_16x16x32_bf16 v[70:73], v[14:17], v[42:45], v[70:73]
    v_mfma_f32_16x16x32_bf16 v[46:49], v[66:69], v[42:45], v[46:49]
    s_waitcnt lgkmcnt(3)
    s_waitcnt lgkmcnt(0)
    v_mfma_f32_16x16x32_bf16 v[50:53], v[18:21], v[34:37], v[50:53]
    v_mfma_f32_16x16x32_bf16 v[70:73], v[22:25], v[34:37], v[70:73]
    v_mfma_f32_16x16x32_bf16 v[46:49], v[58:61], v[34:37], v[46:49]
    v_mov_b32 v63, 0
    v_mov_b32 v64, 0
    s_nop 3
    v_max3_f32 v11, v50, v51, v52
    v_max3_f32 v12, v70, v71, v72
    v_max3_f32 v11, v11, v53, v73
    v_max3_f32 v13, v46, v47, v12
    v_max_f32 v10, v11, v13
    v_max_f32 v11, v11, v13
    s_nop 1
    v_permlane32_swap_b32 v10, v11
    v_max_f32 v12, v10, v11
    v_max_f32 v10, v10, v11
    s_nop 1
    v_permlane16_swap_b32 v10, v12
    v_max_f32 v10, v10, v12
    v_mul_f32 v16, s37, v10
    v_pk_fma_f32 v[50:51], v[50:51], s[68:69], v[16:17] op_sel_hi:[1,1,0] neg_lo:[0,0,1] neg_hi:[0,0,1]
    v_pk_fma_f32 v[52:53], v[52:53], s[68:69], v[16:17] op_sel_hi:[1,1,0] neg_lo:[0,0,1] neg_hi:[0,0,1]
    v_pk_fma_f32 v[70:71], v[70:71], s[68:69], v[16:17] op_sel_hi:[1,1,0] neg_lo:[0,0,1] neg_hi:[0,0,1]
    v_pk_fma_f32 v[72:73], v[72:73], s[68:69], v[16:17] op_sel_hi:[1,1,0] neg_lo:[0,0,1] neg_hi:[0,0,1]
    v_pk_fma_f32 v[46:47], v[46:47], s[68:69], v[16:17] op_sel_hi:[1,1,0] neg_lo:[0,0,1] neg_hi:[0,0,1]
    v_exp_f32 v50, v50
    v_exp_f32 v51, v51
    v_exp_f32 v52, v52
    v_exp_f32 v53, v53
    v_exp_f32 v70, v70
    v_exp_f32 v71, v71
    v_exp_f32 v72, v72
    v_exp_f32 v73, v73
    v_exp_f32 v46, v46
    v_exp_f32 v47, v47
    v_cvt_pk_bf16_f32 v58, v50, v51
    v_cvt_pk_bf16_f32 v59, v52, v53
    v_cvt_pk_bf16_f32 v60, v70, v71
    v_cvt_pk_bf16_f32 v61, v72, v73
    v_cvt_pk_bf16_f32 v62, v46, v47
    v_cvt_pk_bf16_f32 v65, v46, v47
    s_waitcnt vmcnt(4)
    v_mfma_f32_16x16x32_bf16 v[34:37], v[26:29], v[58:61], 0
    v_mfma_f32_16x16x32_bf16 v[38:41], v[30:33], v[58:61], 0
    v_mfma_f32_16x16x16_bf16 v[34:37], v[56:57], v[62:63], v[34:37]
    v_mfma_f32_16x16x16_bf16 v[38:41], v[56:57], v[64:65], v[38:41]
    v_pk_add_f32 v[50:51], v[50:51], v[52:53]
    v_pk_add_f32 v[70:71], v[70:71], v[72:73]
    v_pk_add_f32 v[50:51], v[50:51], v[46:47]
    v_pk_add_f32 v[50:51], v[50:51], v[70:71]
    v_add_f32 v14, v50, v51
    v_add_f32 v11, v50, v51
    s_nop 1
    v_permlane32_swap_b32 v14, v11
    v_add_f32 v12, v14, v11
    v_add_f32 v14, v14, v11
    s_nop 1
    v_permlane16_swap_b32 v14, v12
    v_add_f32 v14, v14, v12
    v_rcp_f32 v16, v14
    s_nop 0
    v_pk_mul_f32 v[34:35], v[34:35], v[16:17] op_sel_hi:[1,0]
    v_pk_mul_f32 v[38:39], v[38:39], v[16:17] op_sel_hi:[1,0]
    v_pk_mul_f32 v[36:37], v[36:37], v[16:17] op_sel_hi:[1,0]
    v_pk_mul_f32 v[40:41], v[40:41], v[16:17] op_sel_hi:[1,0]
    v_cvt_pk_bf16_f32 v42, v34, v38
    v_cvt_pk_bf16_f32 v43, v35, v39
    v_cvt_pk_bf16_f32 v44, v36, v40
    v_cvt_pk_bf16_f32 v45, v37, v41
    s_mov_b32 exec_lo, 0x00ff00ff
    s_mov_b32 exec_hi, 0x00ff00ff
    ds_write_b128 v77, v[42:45]
    s_mov_b64 exec, -1
    v_mov_b64 v[10:11], 0
    v_mov_b64 v[12:13], 0
    s_nop 1
    v_mfma_f32_32x32x16_bf16 v[18:33], v[10:13], v[10:13], 0
    v_mfma_f32_32x32x16_bf16 v[34:49], v[10:13], v[10:13], 0
    v_mfma_f32_16x16x32_bf16 v[50:53], v[10:13], v[10:13], 0
    s_waitcnt lgkmcnt(0)
    s_barrier
    ds_read_b128 v[10:13], v4 offset:2304
    ds_read_b128 v[14:17], v4 offset:2432
    s_waitcnt lgkmcnt(1)
    s_nop 2
    v_smfmac_f32_16x16x64_bf16 v[18:21], v[10:13], v[80:87], v1
    v_smfmac_f32_16x16x64_bf16 v[22:25], v[10:13], v[88:95], v1
    v_smfmac_f32_16x16x64_bf16 v[26:29], v[10:13], v[96:103], v1
    v_smfmac_f32_16x16x64_bf16 v[30:33], v[10:13], v[104:111], v1
    s_waitcnt lgkmcnt(0)
    v_smfmac_f32_16x16x64_bf16 v[18:21], v[14:17], v[152:159], v1
    v_smfmac_f32_16x16x64_bf16 v[22:25], v[14:17], v[160:167], v1
    v_smfmac_f32_16x16x64_bf16 v[26:29], v[14:17], v[168:175], v1
    v_smfmac_f32_16x16x64_bf16 v[30:33], v[14:17], v[176:183], v1
    v_smfmac_f32_16x16x64_bf16 v[34:37], v[10:13], v[112:119], v1
    v_smfmac_f32_16x16x64_bf16 v[38:41], v[10:13], v[120:127], v1
    v_smfmac_f32_16x16x64_bf16 v[42:45], v[10:13], v[128:135], v1
    s_nop 1
    v_pk_add_f32 v[18:19], v[18:19], v[20:21]
    v_pk_add_f32 v[22:23], v[22:23], v[24:25]
    v_pk_add_f32 v[26:27], v[26:27], v[28:29]
    v_pk_add_f32 v[30:31], v[30:31], v[32:33]
    v_smfmac_f32_16x16x64_bf16 v[46:49], v[10:13], v[136:143], v1
    v_cvt_pk_bf16_f32 v58, v18, v22
    v_cvt_pk_bf16_f32 v59, v26, v30
    v_cvt_pk_bf16_f32 v60, v19, v23
    v_cvt_pk_bf16_f32 v61, v27, v31
    v_and_or_b32 v58, v58, -2, s11
    global_store_dwordx4 v5, v[58:61], s[20:21] offset:-2112
    v_smfmac_f32_16x16x64_bf16 v[50:53], v[10:13], v[144:151], v1
    v_smfmac_f32_16x16x64_bf16 v[50:53], v[14:17], v[216:223], v1
    v_smfmac_f32_16x16x64_bf16 v[34:37], v[14:17], v[184:191], v1
    v_smfmac_f32_16x16x64_bf16 v[38:41], v[14:17], v[192:199], v1
    v_smfmac_f32_16x16x64_bf16 v[42:45], v[14:17], v[200:207], v1
    v_smfmac_f32_16x16x64_bf16 v[46:49], v[14:17], v[208:215], v1
    s_nop 3
    v_pk_add_f32 v[50:51], v[50:51], v[52:53]
    v_cvt_pk_bf16_f32 v50, v50, v51
    v_and_or_b32 v50, v50, -2, s11
    global_store_dword v78, v50, s[20:21]
    v_pk_add_f32 v[34:35], v[34:35], v[36:37]
    v_pk_add_f32 v[38:39], v[38:39], v[40:41]
    v_pk_add_f32 v[42:43], v[42:43], v[44:45]
    v_pk_add_f32 v[46:47], v[46:47], v[48:49]
    v_cvt_pk_bf16_f32 v62, v34, v38
    v_cvt_pk_bf16_f32 v63, v42, v46
    v_cvt_pk_bf16_f32 v64, v35, v39
    v_cvt_pk_bf16_f32 v65, v43, v47
    v_and_or_b32 v62, v62, -2, s11
    global_store_dwordx4 v5, v[62:65], s[20:21] offset:2112
    global_load_lds_dwordx4 v0, s[12:13] offset:0
    global_load_lds_dwordx4 v0, s[12:13] offset:1024
    v_add_u32 v30, 15104, v9
    ds_read_b128 v[66:69], v30
    s_add_u32 s12, s12, 262144
    s_addc_u32 s13, s13, 0
    v_mov_b64 v[32:33], -1
    ds_read_b128 v[58:61], v0 offset:0
    ds_read_b128 v[62:65], v0 offset:1024
    s_cmp_lt_u32 s8, 2
    s_cbranch_scc1 L_isred_106
    s_cmp_eq_u32 s8, 3
    s_cbranch_scc1 L_red3_104
    s_cmp_ge_u32 s9, 8
    s_cbranch_scc1 L_red3_104
L_isred_106:
    s_waitcnt vmcnt(3)
    global_load_dwordx4 v[10:13], v6, s[20:21] offset:0 sc1
    global_load_dwordx4 v[14:17], v6, s[20:21] offset:128 sc1
    global_load_dwordx4 v[18:21], v6, s[20:21] offset:256 sc1
    global_load_dwordx4 v[22:25], v6, s[20:21] offset:384 sc1
    s_add_u32 s14, s14, 262144
    s_addc_u32 s15, s15, 0
    s_add_u32 s48, s48, 262144
    s_addc_u32 s49, s49, 0
    s_add_u32 s60, s60, 262144
    s_addc_u32 s61, s61, 0
    s_add_u32 s16, s16, 65536
    s_addc_u32 s17, s17, 0
    s_add_u32 s18, s18, 65536
    s_addc_u32 s19, s19, 0
    v_mov_b64 v[50:51], 0
    v_mov_b64 v[52:53], 0
    v_mov_b64 v[54:55], 0
    v_mov_b64 v[56:57], 0
    global_load_dwordx4 v[34:37], v6, s[20:21] offset:0 sc1
    global_load_dwordx4 v[38:41], v6, s[20:21] offset:128 sc1
    global_load_dwordx4 v[42:45], v6, s[20:21] offset:256 sc1
    global_load_dwordx4 v[46:49], v6, s[20:21] offset:384 sc1
    s_waitcnt vmcnt(4) lgkmcnt(0)
    v_mfma_f32_16x16x32_bf16 v[26:29], v[66:69], v[10:13], 0
    v_xor_b32 v30, s11, v10
    v_bitop3_b32 v30, v14, s11, v30 bitop3:0xbe
    v_mfma_f32_16x16x32_bf16 v[26:29], v[66:69], v[14:17], v[26:29]
    v_bitop3_b32 v30, v18, s11, v30 bitop3:0xbe
    v_bitop3_b32 v30, v22, s11, v30 bitop3:0xbe
    v_mfma_f32_16x16x32_bf16 v[26:29], v[66:69], v[18:21], v[26:29]
    v_and_b32 v30, 1, v30
    v_cmp_ne_u32 vcc, 0, v30
    v_mfma_f32_16x16x32_bf16 v[26:29], v[66:69], v[22:25], v[26:29]
    s_cbranch_vccnz L_rB_108
L_rmf_109:
    s_cmp_eq_u32 s8, 2
    s_nop 5
    v_add_f32_dpp v26, v26, v26 row_ror:8 row_mask:0xf bank_mask:0xf
    v_add_f32_dpp v27, v27, v27 row_ror:8 row_mask:0xf bank_mask:0xf
    v_add_f32_dpp v28, v28, v28 row_ror:8 row_mask:0xf bank_mask:0xf
    v_add_f32_dpp v29, v29, v29 row_ror:8 row_mask:0xf bank_mask:0xf
    s_mov_b32 exec_lo, 0x00ff00ff
    s_mov_b32 exec_hi, 0
    s_cbranch_scc1 L_red2_103
    v_cvt_pk_bf16_f32 v70, v26, v27
    v_cvt_pk_bf16_f32 v71, v28, v29
    v_min_u32 v70, -2, v70
    v_min_u32 v71, -2, v71
    global_store_dwordx2 v7, v[70:71], s[32:33]
    global_store_dwordx2 v7, v[32:33], s[34:35]
    s_mov_b64 exec, -1
    s_waitcnt vmcnt(2)
    v_mov_b64 v[34:35], 0
    v_mov_b64 v[36:37], 0
    v_mov_b64 v[38:39], 0
    v_mov_b64 v[40:41], 0
    v_mov_b64 v[42:43], 0
    v_mov_b64 v[44:45], 0
    v_mov_b64 v[46:47], 0
    v_mov_b64 v[48:49], 0
    s_branch L_redd_105
L_red2_103:
    v_cvt_pk_bf16_f32 v70, v26, v28
    v_cvt_pk_bf16_f32 v71, v27, v29
    v_min_u32 v70, -2, v70
    v_min_u32 v71, -2, v71
    global_store_dword v7, v70, s[32:33]
    global_store_dword v7, v71, s[32:33] offset:16
    global_store_dword v7, v32, s[34:35]
    global_store_dword v7, v32, s[34:35] offset:16
    s_mov_b64 exec, -1
    s_waitcnt vmcnt(4)
    v_mov_b64 v[34:35], 0
    v_mov_b64 v[36:37], 0
    v_mov_b64 v[38:39], 0
    v_mov_b64 v[40:41], 0
    v_mov_b64 v[42:43], 0
    v_mov_b64 v[44:45], 0
    v_mov_b64 v[46:47], 0
    v_mov_b64 v[48:49], 0
    s_branch L_redd_105
L_red3_104:
    s_add_u32 s14, s14, 262144
    s_addc_u32 s15, s15, 0
    s_add_u32 s48, s48, 262144
    s_addc_u32 s49, s49, 0
    s_add_u32 s60, s60, 262144
    s_addc_u32 s61, s61, 0
    s_add_u32 s16, s16, 65536
    s_addc_u32 s17, s17, 0
    s_add_u32 s18, s18, 65536
    s_addc_u32 s19, s19, 0
    v_mov_b64 v[34:35], 0
    v_mov_b64 v[36:37], 0
    v_mov_b64 v[38:39], 0
    v_mov_b64 v[40:41], 0
    v_mov_b64 v[42:43], 0
    v_mov_b64 v[44:45], 0
    v_mov_b64 v[46:47], 0
    v_mov_b64 v[48:49], 0
    v_mov_b64 v[50:51], 0
    v_mov_b64 v[52:53], 0
    v_mov_b64 v[54:55], 0
    v_mov_b64 v[56:57], 0
    s_and_b32 s38, s10, 7
    s_cmp_eq_u32 s38, 6
    s_cbranch_scc1 L_kvw_110
L_kvb_111:
    s_waitcnt vmcnt(0) lgkmcnt(0)
L_redd_105:
    s_add_u32 s10, s10, 1
    s_bfe_u32 s11, s10, 0x10001
    ds_read_b128 v[66:69], v0 offset:2048
    ds_read_b128 v[70:73], v0 offset:3072
    ds_read_b128 v[26:29], v0 offset:4096
    ds_read_b128 v[30:33], v0 offset:5120
    s_barrier
    global_load_dwordx4 v[10:13], v0, s[28:29] offset:-4096 sc1
    global_load_dwordx4 v[14:17], v0, s[28:29] offset:-3072 sc1
    global_load_dwordx4 v[18:21], v0, s[28:29] offset:-2048 sc1
    global_load_dwordx4 v[22:25], v0, s[28:29] offset:-1024 sc1
L_gstart_112:
    s_waitcnt vmcnt(3)
    v_max3_u32 v74, v10, v11, v12
    v_max_u32 v74, v74, v13
    v_cmp_eq_u32 vcc, -1, v74
    s_cbranch_vccnz L_fr_113
L_fb_114:
    v_smfmac_f32_16x16x64_bf16 v[50:53], v[10:13], v[58:65], v1
    ds_read_b128 v[58:61], v0 offset:6144
    ds_read_b128 v[62:65], v0 offset:7168
    s_waitcnt vmcnt(2)
    v_max3_u32 v74, v14, v15, v16
    v_smfmac_f32_16x16x64_bf16 v[34:37], v[10:13], a[0:7], v1
    v_max_u32 v74, v74, v17
    v_smfmac_f32_16x16x64_bf16 v[38:41], v[10:13], a[8:15], v1
    v_cmp_eq_u32 vcc, -1, v74
    s_waitcnt lgkmcnt(4)
    v_smfmac_f32_16x16x64_bf16 v[54:57], v[10:13], v[66:73], v1
    ds_read_b128 v[66:69], v0 offset:8192
    ds_read_b128 v[70:73], v0 offset:9216
    v_smfmac_f32_16x16x64_bf16 v[42:45], v[10:13], a[16:23], v1
    v_smfmac_f32_16x16x64_bf16 v[46:49], v[10:13], a[24:31], v1
    global_load_dwordx4 v[10:13], v0, s[28:29] offset:0 sc1
    s_cbranch_vccnz L_fr_115
L_fb_116:
    s_waitcnt lgkmcnt(4)
    v_smfmac_f32_16x16x64_bf16 v[50:53], v[14:17], v[26:33], v1
    ds_read_b128 v[26:29], v0 offset:10240
    ds_read_b128 v[30:33], v0 offset:11264
    s_waitcnt vmcnt(2)
    v_max3_u32 v74, v18, v19, v20
    v_smfmac_f32_16x16x64_bf16 v[34:37], v[14:17], a[32:39], v1
    v_max_u32 v74, v74, v21
    v_smfmac_f32_16x16x64_bf16 v[38:41], v[14:17], a[40:47], v1
    v_cmp_eq_u32 vcc, -1, v74
    s_waitcnt lgkmcnt(4)
    v_smfmac_f32_16x16x64_bf16 v[54:57], v[14:17], v[58:65], v1
    ds_read_b128 v[58:61], v0 offset:12288
    ds_read_b128 v[62:65], v0 offset:13312
    v_smfmac_f32_16x16x64_bf16 v[42:45], v[14:17], a[48:55], v1
    v_smfmac_f32_16x16x64_bf16 v[46:49], v[14:17], a[56:63], v1
    global_load_dwordx4 v[14:17], v0, s[28:29] offset:1024 sc1
    s_cbranch_vccnz L_fr_117
L_fb_118:
    s_waitcnt lgkmcnt(4)
    v_smfmac_f32_16x16x64_bf16 v[50:53], v[18:21], v[66:73], v1
    ds_read_b128 v[66:69], v0 offset:14336
    ds_read_b128 v[70:73], v0 offset:15360
    s_waitcnt vmcnt(2)
    v_max3_u32 v74, v22, v23, v24
    v_smfmac_f32_16x16x64_bf16 v[34:37], v[18:21], a[64:71], v1
    v_max_u32 v74, v74, v25
    v_smfmac_f32_16x16x64_bf16 v[38:41], v[18:21], a[72:79], v1
    v_cmp_eq_u32 vcc, -1, v74
    s_waitcnt lgkmcnt(4)
    v_smfmac_f32_16x16x64_bf16 v[54:57], v[18:21], v[26:33], v1
    ds_read_b128 v[26:29], v0 offset:16384
    ds_read_b128 v[30:33], v0 offset:17408
    v_smfmac_f32_16x16x64_bf16 v[42:45], v[18:21], a[80:87], v1
    v_smfmac_f32_16x16x64_bf16 v[46:49], v[18:21], a[88:95], v1
    global_load_dwordx4 v[18:21], v0, s[28:29] offset:2048 sc1
    s_cbranch_vccnz L_fr_119
L_fb_120:
    s_waitcnt lgkmcnt(4)
    v_smfmac_f32_16x16x64_bf16 v[50:53], v[22:25], v[58:65], v1
    ds_read_b128 v[58:61], v0 offset:18432
    ds_read_b128 v[62:65], v0 offset:19456
    v_smfmac_f32_16x16x64_bf16 v[34:37], v[22:25], a[96:103], v1
    v_smfmac_f32_16x16x64_bf16 v[38:41], v[22:25], a[104:111], v1
    s_waitcnt lgkmcnt(4)
    v_smfmac_f32_16x16x64_bf16 v[54:57], v[22:25], v[66:73], v1
    ds_read_b128 v[66:69], v0 offset:20480
    ds_read_b128 v[70:73], v0 offset:21504
    v_smfmac_f32_16x16x64_bf16 v[42:45], v[22:25], a[112:119], v1
    v_smfmac_f32_16x16x64_bf16 v[46:49], v[22:25], a[120:127], v1
    global_load_dwordx4 v[22:25], v0, s[28:29] offset:3072 sc1
    s_waitcnt vmcnt(3)
    s_waitcnt lgkmcnt(4)
    v_smfmac_f32_16x16x64_bf16 v[50:53], v[10:13], v[26:33], v1
    ds_read_b128 v[26:29], v0 offset:22528
    ds_read_b128 v[30:33], v0 offset:23552
    v_max3_u32 v79, v10, v11, v12
    v_smfmac_f32_16x16x64_bf16 v[34:37], v[10:13], a[128:135], v1
    v_max_u32 v79, v79, v13
    v_smfmac_f32_16x16x64_bf16 v[38:41], v[10:13], a[136:143], v1
    s_waitcnt lgkmcnt(4)
    v_smfmac_f32_16x16x64_bf16 v[54:57], v[10:13], v[58:65], v1
    ds_read_b128 v[58:61], v0 offset:24576
    ds_read_b128 v[62:65], v0 offset:25600
    v_smfmac_f32_16x16x64_bf16 v[42:45], v[10:13], a[144:151], v1
    v_smfmac_f32_16x16x64_bf16 v[46:49], v[10:13], a[152:159], v1
    global_load_dwordx4 v[10:13], v0, s[30:31] sc1
    s_waitcnt vmcnt(3)
    s_waitcnt lgkmcnt(4)
    v_smfmac_f32_16x16x64_bf16 v[50:53], v[14:17], v[66:73], v1
    ds_read_b128 v[66:69], v0 offset:26624
    ds_read_b128 v[70:73], v0 offset:27648
    v_max3_u32 v79, v79, v14, v15
    v_smfmac_f32_16x16x64_bf16 v[34:37], v[14:17], a[160:167], v1
    v_max3_u32 v79, v79, v16, v17
    v_smfmac_f32_16x16x64_bf16 v[38:41], v[14:17], a[168:175], v1
    s_waitcnt lgkmcnt(4)
    v_smfmac_f32_16x16x64_bf16 v[54:57], v[14:17], v[26:33], v1
    ds_read_b128 v[26:29], v0 offset:28672
    ds_read_b128 v[30:33], v0 offset:29696
    v_smfmac_f32_16x16x64_bf16 v[42:45], v[14:17], a[176:183], v1
    v_smfmac_f32_16x16x64_bf16 v[46:49], v[14:17], a[184:191], v1
    s_waitcnt vmcnt(2)
    s_waitcnt lgkmcnt(4)
    v_smfmac_f32_16x16x64_bf16 v[50:53], v[18:21], v[58:65], v1
    ds_read_b128 v[58:61], v0 offset:30720
    ds_read_b128 v[62:65], v0 offset:31744
    v_max3_u32 v79, v79, v18, v19
    v_smfmac_f32_16x16x64_bf16 v[34:37], v[18:21], a[192:199], v1
    v_max3_u32 v79, v79, v20, v21
    v_smfmac_f32_16x16x64_bf16 v[38:41], v[18:21], a[200:207], v1
    s_waitcnt lgkmcnt(4)
    v_smfmac_f32_16x16x64_bf16 v[54:57], v[18:21], v[66:73], v1
    ds_read_b128 v[66:69], v0 offset:32768
    ds_read_b128 v[70:73], v0 offset:33792
    v_smfmac_f32_16x16x64_bf16 v[42:45], v[18:21], a[208:215], v1
    v_smfmac_f32_16x16x64_bf16 v[46:49], v[18:21], a[216:223], v1
    s_waitcnt vmcnt(1)
    s_waitcnt lgkmcnt(4)
    v_smfmac_f32_16x16x64_bf16 v[50:53], v[22:25], v[26:33], v1
    ds_read_b128 v[26:29], v0 offset:34816
    ds_read_b128 v[30:33], v0 offset:35840
    v_max3_u32 v79, v79, v22, v23
    v_smfmac_f32_16x16x64_bf16 v[34:37], v[22:25], a[224:231], v1
    v_max3_u32 v79, v79, v24, v25
    v_smfmac_f32_16x16x64_bf16 v[38:41], v[22:25], a[232:239], v1
    s_waitcnt lgkmcnt(4)
    v_smfmac_f32_16x16x64_bf16 v[54:57], v[22:25], v[58:65], v1
    v_smfmac_f32_16x16x64_bf16 v[42:45], v[22:25], a[240:247], v1
    v_smfmac_f32_16x16x64_bf16 v[46:49], v[22:25], a[248:255], v1
    s_waitcnt vmcnt(0)
    v_smfmac_f32_16x16x64_bf16 v[34:37], v[10:13], v[224:231], v1
    v_max3_u32 v79, v79, v10, v11
    v_smfmac_f32_16x16x64_bf16 v[38:41], v[10:13], v[232:239], v1
    v_max3_u32 v79, v79, v12, v13
    v_smfmac_f32_16x16x64_bf16 v[42:45], v[10:13], v[240:247], v1
    v_smfmac_f32_16x16x64_bf16 v[46:49], v[10:13], v[248:255], v1
    s_waitcnt lgkmcnt(2)
    v_smfmac_f32_16x16x64_bf16 v[50:53], v[10:13], v[66:73], v1
    s_waitcnt lgkmcnt(0)
    v_smfmac_f32_16x16x64_bf16 v[54:57], v[10:13], v[26:33], v1
    v_cmp_eq_u32 vcc, -1, v79
    s_cbranch_vccnz L_redo_121
    global_load_dwordx4 v[26:29], v0, s[14:15] offset:0
    global_load_dwordx4 v[30:33], v0, s[14:15] offset:1024
    ds_read_b128 v[10:13], v9 offset:0
    ds_read_b128 v[14:17], v9 offset:4096
    ds_read_b128 v[18:21], v9 offset:1024
    ds_read_b128 v[22:25], v9 offset:5120
    v_pk_add_f32 v[34:35], v[34:35], v[36:37]
    v_pk_add_f32 v[38:39], v[38:39], v[40:41]
    v_pk_add_f32 v[42:43], v[42:43], v[44:45]
    v_pk_add_f32 v[46:47], v[46:47], v[48:49]
    v_cvt_pk_bf16_f32 v58, v34, v38
    v_cvt_pk_bf16_f32 v59, v42, v46
    ds_write_b64 v2, v[58:59]
    v_cvt_pk_bf16_f32 v60, v35, v39
    v_cvt_pk_bf16_f32 v61, v43, v47
    ds_write_b64 v2, v[60:61] offset:288
    v_pk_add_f32 v[50:51], v[50:51], v[52:53]
    v_pk_add_f32 v[54:55], v[54:55], v[56:57]
    v_cvt_pk_bf16_f32 v56, v50, v51
    v_cvt_pk_bf16_f32 v57, v54, v55
    v_min_u32 v58, -2, v58
    v_min_u32 v59, -2, v59
    v_min_u32 v60, -2, v60
    v_min_u32 v61, -2, v61
    v_min_u32 v62, -2, v56
    v_min_u32 v63, -2, v57
    s_cmp_eq_u32 s10, 63
    s_cbranch_scc1 L_exit
    s_waitcnt lgkmcnt(0)
    s_barrier
    ds_read_b128 v[34:37], v3 offset:0
    ds_read_b128 v[38:41], v3 offset:64
    global_store_dwordx4 v75, v[58:61], s[16:17] sc1
    global_store_dwordx2 v76, v[62:63], s[18:19] sc1
    ds_read_b128 v[58:61], v4 offset:0
    ds_read_b128 v[42:45], v3 offset:128
    ds_read_b128 v[62:65], v4 offset:64
    ds_read_b128 v[66:69], v4 offset:128
    v_lshlrev_b32 v74, 1, v0
    global_load_dword v8, v74, s[60:61]
    global_load_dword v8, v74, s[48:49]
    s_waitcnt lgkmcnt(5)
    v_mfma_f32_16x16x32_bf16 v[50:53], v[10:13], v[34:37], 0
    v_mfma_f32_16x16x32_bf16 v[70:73], v[14:17], v[34:37], 0
    ds_read_b128 v[10:13], v9 offset:2048
    ds_read_b128 v[14:17], v9 offset:6144
    s_waitcnt lgkmcnt(5)
    v_mfma_f32_16x16x32_bf16 v[46:49], v[58:61], v[34:37], 0
    ds_read_b128 v[34:37], v3 offset:192
    ds_read_b128 v[58:61], v4 offset:192
    v_mfma_f32_16x16x32_bf16 v[50:53], v[18:21], v[38:41], v[50:53]
    v_mfma_f32_16x16x32_bf16 v[70:73], v[22:25], v[38:41], v[70:73]
    ds_read_b128 v[18:21], v9 offset:3072
    ds_read_b128 v[22:25], v9 offset:7168
    s_waitcnt lgkmcnt(7)
    v_mfma_f32_16x16x32_bf16 v[46:49], v[62:65], v[38:41], v[46:49]
    s_waitcnt lgkmcnt(4)
    v_mfma_f32_16x16x32_bf16 v[50:53], v[10:13], v[42:45], v[50:53]
    v_mfma_f32_16x16x32_bf16 v[70:73], v[14:17], v[42:45], v[70:73]
    v_mfma_f32_16x16x32_bf16 v[46:49], v[66:69], v[42:45], v[46:49]
    s_waitcnt lgkmcnt(3)
    s_waitcnt lgkmcnt(0)
    v_mfma_f32_16x16x32_bf16 v[50:53], v[18:21], v[34:37], v[50:53]
    v_mfma_f32_16x16x32_bf16 v[70:73], v[22:25], v[34:37], v[70:73]
    v_mfma_f32_16x16x32_bf16 v[46:49], v[58:61], v[34:37], v[46:49]
    v_mov_b32 v63, 0
    v_mov_b32 v64, 0
    s_nop 3
    v_max3_f32 v11, v50, v51, v52
    v_max3_f32 v12, v70, v71, v72
    v_max3_f32 v11, v11, v53, v73
    v_max3_f32 v13, v46, v47, v12
    v_max_f32 v10, v11, v13
    v_max_f32 v11, v11, v13
    s_nop 1
    v_permlane32_swap_b32 v10, v11
    v_max_f32 v12, v10, v11
    v_max_f32 v10, v10, v11
    s_nop 1
    v_permlane16_swap_b32 v10, v12
    v_max_f32 v10, v10, v12
    v_mul_f32 v16, s37, v10
    v_pk_fma_f32 v[50:51], v[50:51], s[68:69], v[16:17] op_sel_hi:[1,1,0] neg_lo:[0,0,1] neg_hi:[0,0,1]
    v_pk_fma_f32 v[52:53], v[52:53], s[68:69], v[16:17] op_sel_hi:[1,1,0] neg_lo:[0,0,1] neg_hi:[0,0,1]
    v_pk_fma_f32 v[70:71], v[70:71], s[68:69], v[16:17] op_sel_hi:[1,1,0] neg_lo:[0,0,1] neg_hi:[0,0,1]
    v_pk_fma_f32 v[72:73], v[72:73], s[68:69], v[16:17] op_sel_hi:[1,1,0] neg_lo:[0,0,1] neg_hi:[0,0,1]
    v_pk_fma_f32 v[46:47], v[46:47], s[68:69], v[16:17] op_sel_hi:[1,1,0] neg_lo:[0,0,1] neg_hi:[0,0,1]
    v_exp_f32 v50, v50
    v_exp_f32 v51, v51
    v_exp_f32 v52, v52
    v_exp_f32 v53, v53
    v_exp_f32 v70, v70
    v_exp_f32 v71, v71
    v_exp_f32 v72, v72
    v_exp_f32 v73, v73
    v_exp_f32 v46, v46
    v_exp_f32 v47, v47
    v_cvt_pk_bf16_f32 v58, v50, v51
    v_cvt_pk_bf16_f32 v59, v52, v53
    v_cvt_pk_bf16_f32 v60, v70, v71
    v_cvt_pk_bf16_f32 v61, v72, v73
    v_cvt_pk_bf16_f32 v62, v46, v47
    v_cvt_pk_bf16_f32 v65, v46, v47
    s_waitcnt vmcnt(4)
    v_mfma_f32_16x16x32_bf16 v[34:37], v[26:29], v[58:61], 0
    v_mfma_f32_16x16x32_bf16 v[38:41], v[30:33], v[58:61], 0
    v_mfma_f32_16x16x16_bf16 v[34:37], v[56:57], v[62:63], v[34:37]
    v_mfma_f32_16x16x16_bf16 v[38:41], v[56:57], v[64:65], v[38:41]
    v_pk_add_f32 v[50:51], v[50:51], v[52:53]
    v_pk_add_f32 v[70:71], v[70:71], v[72:73]
    v_pk_add_f32 v[50:51], v[50:51], v[46:47]
    v_pk_add_f32 v[50:51], v[50:51], v[70:71]
    v_add_f32 v14, v50, v51
    v_add_f32 v11, v50, v51
    s_nop 1
    v_permlane32_swap_b32 v14, v11
    v_add_f32 v12, v14, v11
    v_add_f32 v14, v14, v11
    s_nop 1
    v_permlane16_swap_b32 v14, v12
    v_add_f32 v14, v14, v12
    v_rcp_f32 v16, v14
    s_nop 0
    v_pk_mul_f32 v[34:35], v[34:35], v[16:17] op_sel_hi:[1,0]
    v_pk_mul_f32 v[38:39], v[38:39], v[16:17] op_sel_hi:[1,0]
    v_pk_mul_f32 v[36:37], v[36:37], v[16:17] op_sel_hi:[1,0]
    v_pk_mul_f32 v[40:41], v[40:41], v[16:17] op_sel_hi:[1,0]
    v_cvt_pk_bf16_f32 v42, v34, v38
    v_cvt_pk_bf16_f32 v43, v35, v39
    v_cvt_pk_bf16_f32 v44, v36, v40
    v_cvt_pk_bf16_f32 v45, v37, v41
    s_mov_b32 exec_lo, 0x00ff00ff
    s_mov_b32 exec_hi, 0x00ff00ff
    ds_write_b128 v77, v[42:45]
    s_mov_b64 exec, -1
    v_mov_b64 v[10:11], 0
    v_mov_b64 v[12:13], 0
    s_nop 1
    v_mfma_f32_32x32x16_bf16 v[18:33], v[10:13], v[10:13], 0
    v_mfma_f32_32x32x16_bf16 v[34:49], v[10:13], v[10:13], 0
    v_mfma_f32_16x16x32_bf16 v[50:53], v[10:13], v[10:13], 0
    s_waitcnt lgkmcnt(0)
    s_barrier
    ds_read_b128 v[10:13], v4 offset:2304
    ds_read_b128 v[14:17], v4 offset:2432
    s_waitcnt lgkmcnt(1)
    s_nop 2
    v_smfmac_f32_16x16x64_bf16 v[18:21], v[10:13], v[80:87], v1
    v_smfmac_f32_16x16x64_bf16 v[22:25], v[10:13], v[88:95], v1
    v_smfmac_f32_16x16x64_bf16 v[26:29], v[10:13], v[96:103], v1
    v_smfmac_f32_16x16x64_bf16 v[30:33], v[10:13], v[104:111], v1
    s_waitcnt lgkmcnt(0)
    v_smfmac_f32_16x16x64_bf16 v[18:21], v[14:17], v[152:159], v1
    v_smfmac_f32_16x16x64_bf16 v[22:25], v[14:17], v[160:167], v1
    v_smfmac_f32_16x16x64_bf16 v[26:29], v[14:17], v[168:175], v1
    v_smfmac_f32_16x16x64_bf16 v[30:33], v[14:17], v[176:183], v1
    v_smfmac_f32_16x16x64_bf16 v[34:37], v[10:13], v[112:119], v1
    v_smfmac_f32_16x16x64_bf16 v[38:41], v[10:13], v[120:127], v1
    v_smfmac_f32_16x16x64_bf16 v[42:45], v[10:13], v[128:135], v1
    s_nop 1
    v_pk_add_f32 v[18:19], v[18:19], v[20:21]
    v_pk_add_f32 v[22:23], v[22:23], v[24:25]
    v_pk_add_f32 v[26:27], v[26:27], v[28:29]
    v_pk_add_f32 v[30:31], v[30:31], v[32:33]
    v_smfmac_f32_16x16x64_bf16 v[46:49], v[10:13], v[136:143], v1
    v_cvt_pk_bf16_f32 v58, v18, v22
    v_cvt_pk_bf16_f32 v59, v26, v30
    v_cvt_pk_bf16_f32 v60, v19, v23
    v_cvt_pk_bf16_f32 v61, v27, v31
    v_and_or_b32 v58, v58, -2, s11
    global_store_dwordx4 v5, v[58:61], s[22:23] offset:-2112
    v_smfmac_f32_16x16x64_bf16 v[50:53], v[10:13], v[144:151], v1
    v_smfmac_f32_16x16x64_bf16 v[50:53], v[14:17], v[216:223], v1
    v_smfmac_f32_16x16x64_bf16 v[34:37], v[14:17], v[184:191], v1
    v_smfmac_f32_16x16x64_bf16 v[38:41], v[14:17], v[192:199], v1
    v_smfmac_f32_16x16x64_bf16 v[42:45], v[14:17], v[200:207], v1
    v_smfmac_f32_16x16x64_bf16 v[46:49], v[14:17], v[208:215], v1
    s_nop 3
    v_pk_add_f32 v[50:51], v[50:51], v[52:53]
    v_cvt_pk_bf16_f32 v50, v50, v51
    v_and_or_b32 v50, v50, -2, s11
    global_store_dword v78, v50, s[22:23]
    v_pk_add_f32 v[34:35], v[34:35], v[36:37]
    v_pk_add_f32 v[38:39], v[38:39], v[40:41]
    v_pk_add_f32 v[42:43], v[42:43], v[44:45]
    v_pk_add_f32 v[46:47], v[46:47], v[48:49]
    v_cvt_pk_bf16_f32 v62, v34, v38
    v_cvt_pk_bf16_f32 v63, v42, v46
    v_cvt_pk_bf16_f32 v64, v35, v39
    v_cvt_pk_bf16_f32 v65, v43, v47
    v_and_or_b32 v62, v62, -2, s11
    global_store_dwordx4 v5, v[62:65], s[22:23] offset:2112
    global_load_lds_dwordx4 v0, s[12:13] offset:0
    global_load_lds_dwordx4 v0, s[12:13] offset:1024
    v_add_u32 v30, 15104, v9
    ds_read_b128 v[66:69], v30
    s_add_u32 s12, s12, 262144
    s_addc_u32 s13, s13, 0
    v_mov_b64 v[32:33], -1
    ds_read_b128 v[58:61], v0 offset:0
    ds_read_b128 v[62:65], v0 offset:1024
    s_cmp_lt_u32 s8, 2
    s_cbranch_scc1 L_isred_125
    s_cmp_eq_u32 s8, 3
    s_cbranch_scc1 L_red3_123
    s_cmp_ge_u32 s9, 8
    s_cbranch_scc1 L_red3_123
L_isred_125:
    s_waitcnt vmcnt(3)
    global_load_dwordx4 v[10:13], v6, s[22:23] offset:0 sc1
    global_load_dwordx4 v[14:17], v6, s[22:23] offset:128 sc1
    global_load_dwordx4 v[18:21], v6, s[22:23] offset:256 sc1
    global_load_dwordx4 v[22:25], v6, s[22:23] offset:384 sc1
    s_add_u32 s14, s14, 262144
    s_addc_u32 s15, s15, 0
    s_add_u32 s48, s48, 262144
    s_addc_u32 s49, s49, 0
    s_add_u32 s60, s60, 262144
    s_addc_u32 s61, s61, 0
    s_add_u32 s16, s16, 65536
    s_addc_u32 s17, s17, 0
    s_add_u32 s18, s18, 65536
    s_addc_u32 s19, s19, 0
    v_mov_b64 v[50:51], 0
    v_mov_b64 v[52:53], 0
    v_mov_b64 v[54:55], 0
    v_mov_b64 v[56:57], 0
    global_load_dwordx4 v[34:37], v6, s[22:23] offset:0 sc1
    global_load_dwordx4 v[38:41], v6, s[22:23] offset:128 sc1
    global_load_dwordx4 v[42:45], v6, s[22:23] offset:256 sc1
    global_load_dwordx4 v[46:49], v6, s[22:23] offset:384 sc1
    s_waitcnt vmcnt(4) lgkmcnt(0)
    v_mfma_f32_16x16x32_bf16 v[26:29], v[66:69], v[10:13], 0
    v_xor_b32 v30, s11, v10
    v_bitop3_b32 v30, v14, s11, v30 bitop3:0xbe
    v_mfma_f32_16x16x32_bf16 v[26:29], v[66:69], v[14:17], v[26:29]
    v_bitop3_b32 v30, v18, s11, v30 bitop3:0xbe
    v_bitop3_b32 v30, v22, s11, v30 bitop3:0xbe
    v_mfma_f32_16x16x32_bf16 v[26:29], v[66:69], v[18:21], v[26:29]
    v_and_b32 v30, 1, v30
    v_cmp_ne_u32 vcc, 0, v30
    v_mfma_f32_16x16x32_bf16 v[26:29], v[66:69], v[22:25], v[26:29]
    s_cbranch_vccnz L_rB_127
L_rmf_128:
    s_cmp_eq_u32 s8, 2
    s_nop 5
    v_add_f32_dpp v26, v26, v26 row_ror:8 row_mask:0xf bank_mask:0xf
    v_add_f32_dpp v27, v27, v27 row_ror:8 row_mask:0xf bank_mask:0xf
    v_add_f32_dpp v28, v28, v28 row_ror:8 row_mask:0xf bank_mask:0xf
    v_add_f32_dpp v29, v29, v29 row_ror:8 row_mask:0xf bank_mask:0xf
    s_mov_b32 exec_lo, 0x00ff00ff
    s_mov_b32 exec_hi, 0
    s_cbranch_scc1 L_red2_122
    v_cvt_pk_bf16_f32 v70, v26, v27
    v_cvt_pk_bf16_f32 v71, v28, v29
    v_min_u32 v70, -2, v70
    v_min_u32 v71, -2, v71
    global_store_dwordx2 v7, v[70:71], s[34:35]
    global_store_dwordx2 v7, v[32:33], s[32:33]
    s_mov_b64 exec, -1
    s_waitcnt vmcnt(2)
    v_mov_b64 v[34:35], 0
    v_mov_b64 v[36:37], 0
    v_mov_b64 v[38:39], 0
    v_mov_b64 v[40:41], 0
    v_mov_b64 v[42:43], 0
    v_mov_b64 v[44:45], 0
    v_mov_b64 v[46:47], 0
    v_mov_b64 v[48:49], 0
    s_branch L_redd_124
L_red2_122:
    v_cvt_pk_bf16_f32 v70, v26, v28
    v_cvt_pk_bf16_f32 v71, v27, v29
    v_min_u32 v70, -2, v70
    v_min_u32 v71, -2, v71
    global_store_dword v7, v70, s[34:35]
    global_store_dword v7, v71, s[34:35] offset:16
    global_store_dword v7, v32, s[32:33]
    global_store_dword v7, v32, s[32:33] offset:16
    s_mov_b64 exec, -1
    s_waitcnt vmcnt(4)
    v_mov_b64 v[34:35], 0
    v_mov_b64 v[36:37], 0
    v_mov_b64 v[38:39], 0
    v_mov_b64 v[40:41], 0
    v_mov_b64 v[42:43], 0
    v_mov_b64 v[44:45], 0
    v_mov_b64 v[46:47], 0
    v_mov_b64 v[48:49], 0
    s_branch L_redd_124
L_red3_123:
    s_add_u32 s14, s14, 262144
    s_addc_u32 s15, s15, 0
    s_add_u32 s48, s48, 262144
    s_addc_u32 s49, s49, 0
    s_add_u32 s60, s60, 262144
    s_addc_u32 s61, s61, 0
    s_add_u32 s16, s16, 65536
    s_addc_u32 s17, s17, 0
    s_add_u32 s18, s18, 65536
    s_addc_u32 s19, s19, 0
    v_mov_b64 v[34:35], 0
    v_mov_b64 v[36:37], 0
    v_mov_b64 v[38:39], 0
    v_mov_b64 v[40:41], 0
    v_mov_b64 v[42:43], 0
    v_mov_b64 v[44:45], 0
    v_mov_b64 v[46:47], 0
    v_mov_b64 v[48:49], 0
    v_mov_b64 v[50:51], 0
    v_mov_b64 v[52:53], 0
    v_mov_b64 v[54:55], 0
    v_mov_b64 v[56:57], 0
    s_waitcnt vmcnt(0) lgkmcnt(0)
L_redd_124:
    s_add_u32 s10, s10, 1
    s_bfe_u32 s11, s10, 0x10001
    ds_read_b128 v[66:69], v0 offset:2048
    ds_read_b128 v[70:73], v0 offset:3072
    ds_read_b128 v[26:29], v0 offset:4096
    ds_read_b128 v[30:33], v0 offset:5120
    s_barrier
    global_load_dwordx4 v[10:13], v0, s[24:25] offset:-4096 sc1
    global_load_dwordx4 v[14:17], v0, s[24:25] offset:-3072 sc1
    global_load_dwordx4 v[18:21], v0, s[24:25] offset:-2048 sc1
    global_load_dwordx4 v[22:25], v0, s[24:25] offset:-1024 sc1
    s_branch L_step_92
L_fr_94:
    s_sub_u32 s36, s36, 1
    s_cbranch_scc1 L_bail
    global_load_dwordx4 v[10:13], v0, s[24:25] offset:-4096 sc1
    global_load_dwordx4 v[14:17], v0, s[24:25] offset:-3072 sc1
    global_load_dwordx4 v[18:21], v0, s[24:25] offset:-2048 sc1
    global_load_dwordx4 v[22:25], v0, s[24:25] offset:-1024 sc1
    s_waitcnt vmcnt(0)
    v_max3_u32 v74, v10, v11, v12
    v_max_u32 v74, v74, v13
    v_cmp_eq_u32 vcc, -1, v74
    s_cbranch_vccnz L_fr_94
    s_branch L_fb_95
L_fr_96:
    s_sub_u32 s36, s36, 1
    s_cbranch_scc1 L_bail
    global_load_dwordx4 v[14:17], v0, s[24:25] offset:-3072 sc1
    global_load_dwordx4 v[18:21], v0, s[24:25] offset:-2048 sc1
    global_load_dwordx4 v[22:25], v0, s[24:25] offset:-1024 sc1
    global_load_dwordx4 v[10:13], v0, s[24:25] offset:0 sc1
    s_waitcnt vmcnt(0)
    v_max3_u32 v74, v14, v15, v16
    v_max_u32 v74, v74, v17
    v_cmp_eq_u32 vcc, -1, v74
    s_cbranch_vccnz L_fr_96
    s_branch L_fb_97
L_fr_98:
    s_sub_u32 s36, s36, 1
    s_cbranch_scc1 L_bail
    global_load_dwordx4 v[18:21], v0, s[24:25] offset:-2048 sc1
    global_load_dwordx4 v[22:25], v0, s[24:25] offset:-1024 sc1
    global_load_dwordx4 v[10:13], v0, s[24:25] offset:0 sc1
    global_load_dwordx4 v[14:17], v0, s[24:25] offset:1024 sc1
    s_waitcnt vmcnt(0)
    v_max3_u32 v74, v18, v19, v20
    v_max_u32 v74, v74, v21
    v_cmp_eq_u32 vcc, -1, v74
    s_cbranch_vccnz L_fr_98
    s_branch L_fb_99
L_fr_100:
    s_sub_u32 s36, s36, 1
    s_cbranch_scc1 L_bail
    global_load_dwordx4 v[22:25], v0, s[24:25] offset:-1024 sc1
    global_load_dwordx4 v[10:13], v0, s[24:25] offset:0 sc1
    global_load_dwordx4 v[14:17], v0, s[24:25] offset:1024 sc1
    global_load_dwordx4 v[18:21], v0, s[24:25] offset:2048 sc1
    s_waitcnt vmcnt(0)
    v_max3_u32 v74, v22, v23, v24
    v_max_u32 v74, v74, v25
    v_cmp_eq_u32 vcc, -1, v74
    s_cbranch_vccnz L_fr_100
    s_branch L_fb_101
L_redo_102:
    s_sub_u32 s36, s36, 1
    s_cbranch_scc1 L_bail
    s_nop 7
    s_nop 7
    v_mov_b64 v[34:35], 0
    v_mov_b64 v[36:37], 0
    v_mov_b64 v[38:39], 0
    v_mov_b64 v[40:41], 0
    v_mov_b64 v[42:43], 0
    v_mov_b64 v[44:45], 0
    v_mov_b64 v[46:47], 0
    v_mov_b64 v[48:49], 0
    v_mov_b64 v[50:51], 0
    v_mov_b64 v[52:53], 0
    v_mov_b64 v[54:55], 0
    v_mov_b64 v[56:57], 0
    s_waitcnt vmcnt(0) lgkmcnt(0)
    ds_read_b128 v[58:61], v0 offset:0
    ds_read_b128 v[62:65], v0 offset:1024
    s_waitcnt lgkmcnt(0)
    ds_read_b128 v[66:69], v0 offset:2048
    ds_read_b128 v[70:73], v0 offset:3072
    ds_read_b128 v[26:29], v0 offset:4096
    ds_read_b128 v[30:33], v0 offset:5120
    global_load_dwordx4 v[10:13], v0, s[24:25] offset:-4096 sc1
    global_load_dwordx4 v[14:17], v0, s[24:25] offset:-3072 sc1
    global_load_dwordx4 v[18:21], v0, s[24:25] offset:-2048 sc1
    global_load_dwordx4 v[22:25], v0, s[24:25] offset:-1024 sc1
    s_waitcnt vmcnt(0)
    s_branch L_gstart_93
L_rB_108:
    s_waitcnt vmcnt(0)
    v_xor_b32 v30, s11, v34
    v_bitop3_b32 v30, v38, s11, v30 bitop3:0xbe
    v_bitop3_b32 v30, v42, s11, v30 bitop3:0xbe
    v_bitop3_b32 v30, v46, s11, v30 bitop3:0xbe
    v_and_b32 v30, 1, v30
    v_cmp_ne_u32 vcc, 0, v30
    s_cbranch_vccnz L_rBr_129
    v_mfma_f32_16x16x32_bf16 v[26:29], v[66:69], v[34:37], 0
    v_mfma_f32_16x16x32_bf16 v[26:29], v[66:69], v[38:41], v[26:29]
    v_mfma_f32_16x16x32_bf16 v[26:29], v[66:69], v[42:45], v[26:29]
    v_mfma_f32_16x16x32_bf16 v[26:29], v[66:69], v[46:49], v[26:29]
    s_branch L_rmf_109
L_rBr_129:
    s_sub_u32 s36, s36, 1
    s_cbranch_scc1 L_bail
    s_add_u32 s3, s3, 1
    global_load_dwordx4 v[10:13], v6, s[20:21] offset:0 sc1
    global_load_dwordx4 v[14:17], v6, s[20:21] offset:128 sc1
    global_load_dwordx4 v[18:21], v6, s[20:21] offset:256 sc1
    global_load_dwordx4 v[22:25], v6, s[20:21] offset:384 sc1
    s_waitcnt vmcnt(0)
    v_xor_b32 v30, s11, v10
    v_bitop3_b32 v30, v14, s11, v30 bitop3:0xbe
    v_bitop3_b32 v30, v18, s11, v30 bitop3:0xbe
    v_bitop3_b32 v30, v22, s11, v30 bitop3:0xbe
    v_and_b32 v30, 1, v30
    v_cmp_ne_u32 vcc, 0, v30
    s_cbranch_vccnz L_rBr_129
    v_mfma_f32_16x16x32_bf16 v[26:29], v[66:69], v[10:13], 0
    v_mfma_f32_16x16x32_bf16 v[26:29], v[66:69], v[14:17], v[26:29]
    v_mfma_f32_16x16x32_bf16 v[26:29], v[66:69], v[18:21], v[26:29]
    v_mfma_f32_16x16x32_bf16 v[26:29], v[66:69], v[22:25], v[26:29]
    s_branch L_rmf_109
L_kvw_110:
    s_cmp_lg_u32 s8, 3
    s_cbranch_scc1 L_kvb_111
    s_cmp_gt_u32 s10, 14
    s_cbranch_scc1 L_kvb_111
    s_cmp_eq_u32 s10, 6
    s_mov_b32 s38, 80
    s_cselect_b32 s38, 168, s38
    s_mov_b32 s39, 196
    s_cselect_b32 s39, 84, s39
    v_mov_b32 v74, s38
L_kvp_130:
    global_load_dword v79, v74, s[6:7] sc1
    s_waitcnt vmcnt(0)
    v_readfirstlane_b32 s38, v79
    s_cmp_ge_u32 s38, s39
    s_cbranch_scc1 L_kvb_111
    s_sub_u32 s36, s36, 1
    s_cbranch_scc1 L_bail
    s_sleep 2
    s_branch L_kvp_130
L_fr_113:
    s_sub_u32 s36, s36, 1
    s_cbranch_scc1 L_bail
    global_load_dwordx4 v[10:13], v0, s[28:29] offset:-4096 sc1
    global_load_dwordx4 v[14:17], v0, s[28:29] offset:-3072 sc1
    global_load_dwordx4 v[18:21], v0, s[28:29] offset:-2048 sc1
    global_load_dwordx4 v[22:25], v0, s[28:29] offset:-1024 sc1
    s_waitcnt vmcnt(0)
    v_max3_u32 v74, v10, v11, v12
    v_max_u32 v74, v74, v13
    v_cmp_eq_u32 vcc, -1, v74
    s_cbranch_vccnz L_fr_113
    s_branch L_fb_114
L_fr_115:
    s_sub_u32 s36, s36, 1
    s_cbranch_scc1 L_bail
    global_load_dwordx4 v[14:17], v0, s[28:29] offset:-3072 sc1
    global_load_dwordx4 v[18:21], v0, s[28:29] offset:-2048 sc1
    global_load_dwordx4 v[22:25], v0, s[28:29] offset:-1024 sc1
    global_load_dwordx4 v[10:13], v0, s[28:29] offset:0 sc1
    s_waitcnt vmcnt(0)
    v_max3_u32 v74, v14, v15, v16
    v_max_u32 v74, v74, v17
    v_cmp_eq_u32 vcc, -1, v74
    s_cbranch_vccnz L_fr_115
    s_branch L_fb_116
L_fr_117:
    s_sub_u32 s36, s36, 1
    s_cbranch_scc1 L_bail
    global_load_dwordx4 v[18:21], v0, s[28:29] offset:-2048 sc1
    global_load_dwordx4 v[22:25], v0, s[28:29] offset:-1024 sc1
    global_load_dwordx4 v[10:13], v0, s[28:29] offset:0 sc1
    global_load_dwordx4 v[14:17], v0, s[28:29] offset:1024 sc1
    s_waitcnt vmcnt(0)
    v_max3_u32 v74, v18, v19, v20
    v_max_u32 v74, v74, v21
    v_cmp_eq_u32 vcc, -1, v74
    s_cbranch_vccnz L_fr_117
    s_branch L_fb_118
L_fr_119:
    s_sub_u32 s36, s36, 1
    s_cbranch_scc1 L_bail
    global_load_dwordx4 v[22:25], v0, s[28:29] offset:-1024 sc1
    global_load_dwordx4 v[10:13], v0, s[28:29] offset:0 sc1
    global_load_dwordx4 v[14:17], v0, s[28:29] offset:1024 sc1
    global_load_dwordx4 v[18:21], v0, s[28:29] offset:2048 sc1
    s_waitcnt vmcnt(0)
    v_max3_u32 v74, v22, v23, v24
    v_max_u32 v74, v74, v25
    v_cmp_eq_u32 vcc, -1, v74
    s_cbranch_vccnz L_fr_119
    s_branch L_fb_120
L_redo_121:
    s_sub_u32 s36, s36, 1
    s_cbranch_scc1 L_bail
    s_nop 7
    s_nop 7
    v_mov_b64 v[34:35], 0
    v_mov_b64 v[36:37], 0
    v_mov_b64 v[38:39], 0
    v_mov_b64 v[40:41], 0
    v_mov_b64 v[42:43], 0
    v_mov_b64 v[44:45], 0
    v_mov_b64 v[46:47], 0
    v_mov_b64 v[48:49], 0
    v_mov_b64 v[50:51], 0
    v_mov_b64 v[52:53], 0
    v_mov_b64 v[54:55], 0
    v_mov_b64 v[56:57], 0
    s_waitcnt vmcnt(0) lgkmcnt(0)
    ds_read_b128 v[58:61], v0 offset:0
    ds_read_b128 v[62:65], v0 offset:1024
    s_waitcnt lgkmcnt(0)
    ds_read_b128 v[66:69], v0 offset:2048
    ds_read_b128 v[70:73], v0 offset:3072
    ds_read_b128 v[26:29], v0 offset:4096
    ds_read_b128 v[30:33], v0 offset:5120
    global_load_dwordx4 v[10:13], v0, s[28:29] offset:-4096 sc1
    global_load_dwordx4 v[14:17], v0, s[28:29] offset:-3072 sc1
    global_load_dwordx4 v[18:21], v0, s[28:29] offset:-2048 sc1
    global_load_dwordx4 v[22:25], v0, s[28:29] offset:-1024 sc1
    s_waitcnt vmcnt(0)
    s_branch L_gstart_112
L_rB_127:
    s_waitcnt vmcnt(0)
    v_xor_b32 v30, s11, v34
    v_bitop3_b32 v30, v38, s11, v30 bitop3:0xbe
    v_bitop3_b32 v30, v42, s11, v30 bitop3:0xbe
    v_bitop3_b32 v30, v46, s11, v30 bitop3:0xbe
    v_and_b32 v30, 1, v30
    v_cmp_ne_u32 vcc, 0, v30
    s_cbranch_vccnz L_rBr_131
    v_mfma_f32_16x16x32_bf16 v[26:29], v[66:69], v[34:37], 0
    v_mfma_f32_16x16x32_bf16 v[26:29], v[66:69], v[38:41], v[26:29]
    v_mfma_f32_16x16x32_bf16 v[26:29], v[66:69], v[42:45], v[26:29]
    v_mfma_f32_16x16x32_bf16 v[26:29], v[66:69], v[46:49], v[26:29]
    s_branch L_rmf_128
L_rBr_131:
    s_sub_u32 s36, s36, 1
    s_cbranch_scc1 L_bail
    s_add_u32 s3, s3, 1
    global_load_dwordx4 v[10:13], v6, s[22:23] offset:0 sc1
    global_load_dwordx4 v[14:17], v6, s[22:23] offset:128 sc1
    global_load_dwordx4 v[18:21], v6, s[22:23] offset:256 sc1
    global_load_dwordx4 v[22:25], v6, s[22:23] offset:384 sc1
    s_waitcnt vmcnt(0)
    v_xor_b32 v30, s11, v10
    v_bitop3_b32 v30, v14, s11, v30 bitop3:0xbe
    v_bitop3_b32 v30, v18, s11, v30 bitop3:0xbe
    v_bitop3_b32 v30, v22, s11, v30 bitop3:0xbe
    v_and_b32 v30, 1, v30
    v_cmp_ne_u32 vcc, 0, v30
    s_cbranch_vccnz L_rBr_131
    v_mfma_f32_16x16x32_bf16 v[26:29], v[66:69], v[10:13], 0
    v_mfma_f32_16x16x32_bf16 v[26:29], v[66:69], v[14:17], v[26:29]
    v_mfma_f32_16x16x32_bf16 v[26:29], v[66:69], v[18:21], v[26:29]
    v_mfma_f32_16x16x32_bf16 v[26:29], v[66:69], v[22:25], v[26:29]
    s_branch L_rmf_128
L_exit:
    global_store_dwordx4 v75, v[58:61], s[16:17] sc1
    global_store_dwordx2 v76, v[62:63], s[18:19] sc1
    s_waitcnt vmcnt(0) lgkmcnt(0)
    s_branch L_end
L_bail:
    s_mov_b64 exec, 1
    v_mov_b32 v2, 76
    v_mov_b32 v3, 1
    global_atomic_add v2, v3, s[6:7]
    s_waitcnt vmcnt(0)
L_end:
    s_endpgm
L_code_end:
.section .rodata,"a"
.p2align 6
.amdhsa_kernel gated_mix__memory_aug_recurrent_mem_tr__swiglu_ffn__prompt_kernel
  .amdhsa_next_free_vgpr 512
  .amdhsa_next_free_sgpr 102
  .amdhsa_accum_offset 256
  .amdhsa_group_segment_fixed_size 0
  .amdhsa_kernarg_size 120
  .amdhsa_user_sgpr_count 2
  .amdhsa_user_sgpr_kernarg_segment_ptr 1
  .amdhsa_system_sgpr_workgroup_id_x 1
.end_amdhsa_kernel
```
